```python
import torch

def _softmax(x, axis=-1):
    return torch.softmax(x, dim=axis)
def _gelu(x):
    return torch.nn.functional.gelu(x, approximate="tanh")
def _silu(x):
    return torch.nn.functional.silu(x)
def _sigmoid(x):
    return torch.sigmoid(x)
def _layernorm(x, axis=-1, eps=1e-5):
    m = x.mean(dim=axis, keepdim=True)
    v = x.var(dim=axis, keepdim=True, unbiased=False)
    return (x - m) / torch.sqrt(v + eps)
def _scatter_add(tgt, idx, src, axis=0):
    return tgt.clone().index_add_(axis, idx, src)
def _segment_sum(src, seg, n):
    out = torch.zeros((n,) + src.shape[1:], dtype=src.dtype)
    return out.index_add_(0, seg, src)
def _pad(x, pw):
    flat = tuple(v for pair in reversed(pw) for v in pair)
    return torch.nn.functional.pad(x, flat)

kernel_name = 'parallel_sum__softmax_full_mha__geglu_ffn__prompt'

def setup_inputs():

    _w = (lambda a: (lambda t: t.to(torch.bfloat16) if t.is_floating_point() else t)(torch.as_tensor(a)))
    def _A_setup():
        B, S, D = 1, 2048, 640
        return {
            "x": _w((lambda *s: torch.randn(*s, dtype=torch.bfloat16) * 0.05)(B, S, D)),
            "wqkv": _w((lambda *s: torch.randn(*s, dtype=torch.bfloat16) * 0.2)(D, 3 * D)),
            "wo": _w((lambda *s: torch.randn(*s, dtype=torch.bfloat16) * 0.1)(D, D)),
        }
    _A_in = _A_setup()

    def _B_setup():
        B, S, D, F = 1, 2048, 640, 1728
        return {
            "x": _w((lambda *s: torch.randn(*s, dtype=torch.bfloat16) * 0.05)(B, S, D)),
            "w_gate": _w((lambda *s: torch.randn(*s, dtype=torch.bfloat16) * 0.1)(D, F)),
            "w_up": _w((lambda *s: torch.randn(*s, dtype=torch.bfloat16) * 0.1)(D, F)),
            "w_down": _w((lambda *s: torch.randn(*s, dtype=torch.bfloat16) * 0.1)(F, D)),
        }
    _B_in = _B_setup()

    return {
        "A_x": _A_in["x"],
        "A_wqkv": _A_in["wqkv"],
        "A_wo": _A_in["wo"],
        "B_x": _B_in["x"],
        "B_w_gate": _B_in["w_gate"],
        "B_w_up": _B_in["w_up"],
        "B_w_down": _B_in["w_down"],
    }

def reference(A_x, A_wqkv, A_wo, B_x, B_w_gate, B_w_up, B_w_down):
    def _A_ref(x, wqkv, wo):
        B, S, D = x.shape
        H = 32; Dh = D // H
        qkv = (lambda x, *d: x.permute(*d))((x @ wqkv).reshape(B, S, 3, H, Dh), 2, 0, 3, 1, 4)
        q, k, v = qkv[0], qkv[1], qkv[2]
        scale = Dh ** -0.5
        scores = torch.einsum("bhqd,bhkd->bhqk", q, k) * scale
        p = _softmax(scores, axis=-1)
        o = torch.einsum("bhqk,bhkd->bhqd", p, v)
        return (lambda x, *d: x.permute(*d))(o, 0, 2, 1, 3).reshape(B, S, D) @ wo

    def _B_ref(x, w_gate, w_up, w_down):
        return (_gelu(x @ w_gate) * (x @ w_up)) @ w_down

    x = A_x
    xn = _layernorm(x, axis=-1)
    return x + _A_ref(xn, A_wqkv, A_wo) + _B_ref(xn, B_w_gate, B_w_up, B_w_down)
```

```asm
; @launch kernel=k1_kernel grid=(256,1,1) block=(256,1,1) lds=163840
; @launch kernel=k2_kernel grid=(256,1,1) block=(768,1,1) lds=163840
.amdgcn_target "amdgcn-amd-amdhsa--gfx950"
.text
.globl k1_kernel
.p2align 8
.type k1_kernel,@function
k1_kernel:
  s_cmp_ge_u32 s2, 0x100
  s_cbranch_scc1 k1_exit
  s_load_dwordx16 s[4:19], s[0:1], 0
  s_load_dwordx4 s[20:23], s[0:1], 64
  s_cmp_ge_u32 s2, 0xe0
  s_cbranch_scc1 k1_side
  v_and_b32 v236, 63, v0
  v_lshrrev_b32 v246, 6, v0
  s_nop 0
  v_readfirstlane_b32 s40, v246
  s_getpc_b64 s[60:61]
k1_epf_pc:
  s_sub_u32 s60, s60, k1_epf_pc-k1_kernel
  s_subb_u32 s61, s61, 0
  v_and_b32 v2, 3, v0
  s_lshr_b32 s62, s2, 3
  s_lshl_b32 s62, s62, 2
  s_add_u32 s62, s62, s40
  s_mul_i32 s62, s62, 4
  s_and_b32 s62, s62, 0x1ff
  v_add_u32 v1, s62, v2
  v_lshlrev_b32 v1, 7, v1
  v_min_u32 v1, code_end-k1_kernel-4, v1
  global_load_dword v255, v1, s[60:61]
  s_lshr_b32 s70, s40, 1
  s_and_b32 s71, s40, 1
  s_lshl_b32 s41, s40, 12
  v_lshlrev_b32 v218, 4, v236
  s_lshl_b32 s61, s40, 5
  v_lshrrev_b32 v246, 3, v236
  v_add_u32 v246, s61, v246
  v_mul_u32_u24 v246, 0x500, v246
  v_lshrrev_b32 v247, 4, v236
  v_and_b32 v248, 7, v236
  v_xor_b32 v247, v247, v248
  v_lshl_add_u32 v246, v247, 4, v246
  v_add_u32 v140, 0x2000, v246
  v_xor_b32 v141, 64, v246
  v_add_u32 v141, 0x4400, v141
  v_add_u32 v142, 0x6800, v246
  v_xor_b32 v143, 64, v246
  v_add_u32 v143, 0x8c00, v143
  v_bfe_u32 v237, v236, 1, 2
  v_bfe_u32 v238, v236, 4, 1
  v_xor_b32 v237, v237, v238
  v_lshlrev_b32 v237, 5, v237
  v_and_b32 v238, 1, v236
  v_lshl_add_u32 v237, v238, 4, v237
  v_lshrrev_b32 v238, 3, v236
  s_lshl_b32 s60, s40, 4
  v_add_u32 v238, s60, v238
  v_xor_b32 v249, 64, v237
  v_mul_u32_u24 v247, 0xd80, v238
  v_add_u32 v248, v247, v237
  v_add_u32 v214, 0x2000, v248
  v_add_u32 v215, 0x8800, v248
  v_add_u32 v248, v247, v249
  v_add_u32 v216, 0x1800, v248
  v_add_u32 v217, 0x8000, v248
  v_mul_u32_u24 v247, 0xf00, v238
  v_add_u32 v248, v247, v237
  v_add_u32 v240, 0x2000, v248
  v_add_u32 v241, 0x9400, v248
  v_add_u32 v248, v247, v249
  v_add_u32 v242, 0x1880, v248
  v_add_u32 v243, 0x8c80, v248
  s_cmp_ge_u32 s2, 0xe0
  s_cbranch_scc1 k1_side
  s_and_b32 s60, s2, 7
  s_lshr_b32 s61, s2, 3
  s_lshr_b32 s62, s60, 1
  s_mul_i32 s62, s62, 28
  s_add_u32 s62, s62, s61
  s_lshr_b32 s69, s62, 3
  s_mov_b32 s64, 0x76432510
  s_mov_b32 s65, 0xdcba98
  s_lshl_b32 s69, s69, 2
  s_lshr_b64 s[64:65], s[64:65], s69
  s_and_b32 s69, s64, 15
  s_and_b32 s68, s62, 7
  s_and_b32 s60, s60, 1
  s_add_u32 s63, s69, s60
  s_lshl_b32 s63, s63, 1
  s_add_u32 s63, s63, s68
  s_mul_i32 s64, s63, 0x199a
  s_lshr_b32 s64, s64, 16
  s_mul_i32 s64, s64, 10
  s_sub_u32 s73, s63, s64
  s_lshl_b32 s58, s73, 7
  s_lshl_b32 s60, s60, 3
  s_add_u32 s68, s68, s60
  s_mul_i32 s60, s68, 0x28000
  s_sub_u32 s60, s60, 0x2000
  s_ashr_i32 s61, s60, 31
  s_waitcnt lgkmcnt(0)
  s_add_u32 s24, s4, s60
  s_addc_u32 s25, s5, s61
  s_mov_b32 s26, 0x2a000
  s_mov_b32 s27, 0x20000
  s_cmp_lt_u32 s69, 5
  s_cbranch_scc1 k1_qkv
  s_mul_i32 s59, s73, 0x36000
  s_sub_u32 s28, s12, 0x2000
  s_subb_u32 s29, s13, 0
  s_mov_b32 s30, 0x21e000
  s_mov_b32 s31, 0x20000
  s_sub_u32 s32, s14, 0x2000
  s_subb_u32 s33, s15, 0
  s_mov_b32 s34, 0x21e000
  s_mov_b32 s35, 0x20000
  s_sub_u32 s60, s69, 5
  s_mul_i32 s60, s60, 0x180
  s_add_u32 s45, s60, 0
  s_add_u32 s46, s60, 0x80
  s_add_u32 s47, s60, 0x100
  s_add_u32 m0, s41, 0
  s_nop 0
  buffer_load_dwordx4 v140, s[24:27], s58 offen offset:0 lds
  buffer_load_dwordx4 v141, s[24:27], s58 offen offset:1024 lds
  buffer_load_dwordx4 v142, s[24:27], s58 offen offset:2048 lds
  buffer_load_dwordx4 v143, s[24:27], s58 offen offset:3072 lds
  s_add_u32 s58, s58, 0x80
  s_cmp_eq_u32 s58, 0x500
  s_cselect_b32 s58, 0, s58
  s_add_u32 m0, s41, 0x4000
  s_add_u32 s44, s45, s59
  buffer_load_dwordx4 v214, s[28:31], s44 offen offset:0 lds
  buffer_load_dwordx4 v215, s[28:31], s44 offen offset:1024 lds
  s_add_u32 s59, s59, 0x36000
  buffer_load_dwordx4 v216, s[32:35], s44 offen offset:2048 lds
  s_cmp_eq_u32 s59, 0x21c000
  s_cselect_b32 s59, 0, s59
  buffer_load_dwordx4 v217, s[32:35], s44 offen offset:3072 lds
  s_mov_b32 s74, 0x3f803f80
  s_add_u32 m0, s41, 0x8000
  s_mov_b32 s36, s22
  s_mov_b32 s37, s23
  s_mov_b32 s38, 0x10000000
  s_mov_b32 s39, 0x20000
  s_lshl_b32 s72, s68, 2
  s_lshl_b32 s60, s70, 1
  s_add_u32 s72, s72, s60
  v_and_b32 v246, 31, v236
  v_lshlrev_b32 v252, 2, v246
  v_lshrrev_b32 v247, 1, v246
  v_and_b32 v247, 7, v247
  v_lshrrev_b32 v248, 5, v236
  v_xor_b32 v249, s70, v248
  v_mul_u32_u24 v249, 0x500, v249
  v_add_u32 v219, v252, v249
  v_xor_b32 v247, v247, v248
  v_lshlrev_b32 v247, 4, v247
  v_lshl_add_u32 v246, v246, 7, v247
  s_lshl_b32 s60, s70, 13
  v_add_u32 v246, s60, v246
  v_xor_b32 v128, 0, v246
  v_add_u32 v132, 0x10000, v128
  v_add_u32 v136, 0x20000, v128
  v_xor_b32 v129, 32, v246
  v_add_u32 v133, 0x10000, v129
  v_add_u32 v137, 0x20000, v129
  v_xor_b32 v130, 64, v246
  v_add_u32 v134, 0x10000, v130
  v_add_u32 v138, 0x20000, v130
  v_xor_b32 v131, 0x60, v246
  v_add_u32 v135, 0x10000, v131
  v_add_u32 v139, 0x20000, v131
  v_lshrrev_b32 v246, 4, v236
  v_and_b32 v246, 1, v246
  v_lshrrev_b32 v247, 2, v236
  v_and_b32 v247, 3, v247
  v_lshrrev_b32 v248, 5, v236
  v_lshl_add_u32 v248, v248, 3, v247
  v_lshlrev_b32 v248, 7, v248
  v_lshl_add_u32 v248, v246, 11, v248
  v_lshrrev_b32 v247, 1, v247
  v_lshl_add_u32 v247, v246, 1, v247
  s_lshl_b32 s60, s71, 1
  s_add_u32 s60, s60, s70
  v_xor_b32 v247, s60, v247
  v_lshl_add_u32 v248, v247, 5, v248
  v_and_b32 v246, 1, v236
  v_lshlrev_b32 v246, 1, v246
  v_bfe_u32 v247, v236, 1, 1
  v_or_b32 v249, v246, v247
  v_lshl_add_u32 v208, v249, 3, v248
  v_xor_b32 v209, 32, v208
  v_add_u32 v210, 0x10000, v208
  v_add_u32 v211, 0x10000, v209
  v_add_u32 v212, 0x20000, v208
  v_add_u32 v213, 0x20000, v209
  s_mul_i32 s61, s69, 12
  s_add_u32 s60, s60, s61
  s_mul_i32 s54, s60, 0x500
  s_lshl_b32 s62, s73, 7
  s_add_u32 s54, s54, s62
  s_add_u32 s54, s54, 0x1404000
  s_sub_u32 s60, s60, s70
  s_mul_i32 s55, s60, 0x500
  s_add_u32 s55, s55, 0x1404000
  s_mul_i32 s56, s72, 0x500
  s_add_u32 s56, s56, 0x1440000
  s_mul_i32 s60, s71, 5
  s_add_u32 s60, s60, s69
  s_lshl_b32 s60, s60, 8
  s_add_u32 s57, s56, s60
  s_mov_b32 s16, s22
  s_mov_b32 s17, s23
  s_mov_b32 s18, 0x10000000
  s_mov_b32 s19, 0x20000
  s_mov_b32 s8, s20
  s_mov_b32 s9, s21
  s_mov_b32 s10, 0x100
  s_mov_b32 s11, 0x20000
  s_sub_u32 s60, s68, 8
  s_cmp_lt_u32 s60, 6
  s_cselect_b32 s18, 0, 0x10000000
  s_lshr_b32 s62, s69, 1
  s_lshl_b32 s62, s62, 4
  s_lshl_b32 s61, s69, 3
  s_add_u32 s61, s61, s62
  s_add_u32 s61, s61, 8
  s_lshr_b32 s62, s68, 1
  s_mul_i32 s62, s62, 24
  s_lshl_b32 s63, s68, 2
  s_add_u32 s62, s62, s63
  s_cmp_eq_u32 s40, 0
  s_cselect_b32 s63, s61, 0x40000000
  s_cselect_b32 s64, s62, 0x40000000
  s_cselect_b32 s76, 10, 0
  v_mov_b32 v254, 0x40000000
  v_writelane_b32 v254, s63, 0
  v_writelane_b32 v254, s64, 1
  s_add_u32 s63, s63, 4
  v_writelane_b32 v254, s63, 2
  s_cmp_lt_u32 s60, 6
  s_cselect_b32 s61, 0x40000000, s61
  s_cmp_lt_u32 s69, 5
  s_cselect_b32 s62, s62, 0x40000000
  s_cmp_eq_u32 s40, 0
  s_cselect_b32 s61, s61, 0x40000000
  s_cselect_b32 s62, s62, 0x40000000
  v_mov_b32 v253, 0x40000000
  v_writelane_b32 v253, s61, 0
  v_writelane_b32 v253, s62, 1
  s_mul_i32 s61, s72, 0x1b000
  s_lshl_b32 s62, s71, 11
  s_add_u32 s61, s61, s62
  s_add_u32 s61, s61, 0x800000
  s_lshl_b32 s62, s70, 10
  s_xor_b32 s64, s62, 0x400
  s_lshl_b32 s63, s45, 5
  s_add_u32 s63, s63, s61
  s_add_u32 s48, s63, s62
  s_add_u32 s51, s63, s64
  s_lshl_b32 s63, s46, 5
  s_add_u32 s63, s63, s61
  s_add_u32 s49, s63, s62
  s_add_u32 s52, s63, s64
  s_lshl_b32 s63, s47, 5
  s_add_u32 s63, s63, s61
  s_add_u32 s50, s63, s62
  s_add_u32 s53, s63, s64
  buffer_load_dwordx4 v140, s[24:27], s58 offen offset:0 lds
  buffer_load_dwordx4 v141, s[24:27], s58 offen offset:1024 lds
  buffer_load_dwordx4 v142, s[24:27], s58 offen offset:2048 lds
  buffer_load_dwordx4 v143, s[24:27], s58 offen offset:3072 lds
  s_add_u32 s58, s58, 0x80
  s_cmp_eq_u32 s58, 0x500
  s_cselect_b32 s58, 0, s58
  s_add_u32 m0, s41, 0xc000
  s_add_u32 s44, s45, s59
  buffer_load_dwordx4 v214, s[28:31], s44 offen offset:0 lds
  buffer_load_dwordx4 v215, s[28:31], s44 offen offset:1024 lds
  s_add_u32 s59, s59, 0x36000
  buffer_load_dwordx4 v216, s[32:35], s44 offen offset:2048 lds
  s_cmp_eq_u32 s59, 0x21c000
  s_cselect_b32 s59, 0, s59
  buffer_load_dwordx4 v217, s[32:35], s44 offen offset:3072 lds
  s_waitcnt vmcnt(8)
  s_barrier
  ds_read_b64_tr_b16 v[192:193], v208 offset:16384
  ds_read_b64_tr_b16 v[194:195], v208 offset:16896
  ds_read_b128 v[0:3], v128 offset:0
  ds_read_b128 v[4:7], v128 offset:4096
  ds_read_b64_tr_b16 v[196:197], v209 offset:16384
  ds_read_b64_tr_b16 v[198:199], v209 offset:16896
  ds_read_b128 v[8:11], v129 offset:0
  ds_read_b128 v[12:15], v129 offset:4096
  s_waitcnt lgkmcnt(5)
  v_mfma_f32_32x32x16_bf16 v[64:79], v[192:195], v[0:3], 0
  ds_read_b64_tr_b16 v[200:201], v208 offset:20480
  ds_read_b64_tr_b16 v[202:203], v208 offset:20992
  s_add_u32 m0, s41, 0x10000
  s_nop 0
  buffer_load_dwordx4 v140, s[24:27], s58 offen offset:0 lds
  s_waitcnt lgkmcnt(6)
  v_mfma_f32_32x32x16_bf16 v[80:95], v[192:195], v[4:7], 0
  ds_read_b64_tr_b16 v[204:205], v209 offset:20480
  ds_read_b64_tr_b16 v[206:207], v209 offset:20992
  buffer_load_dwordx4 v141, s[24:27], s58 offen offset:1024 lds
  s_waitcnt lgkmcnt(6)
  v_mfma_f32_32x32x16_bf16 v[96:111], v[196:199], v[0:3], 0
  ds_read_b128 v[16:19], v130 offset:0
  v_dot2_f32_bf16 v250, v192, s74, 0
  v_dot2_f32_bf16 v251, v193, s74, 0
  buffer_load_dwordx4 v142, s[24:27], s58 offen offset:2048 lds
  v_mfma_f32_32x32x16_bf16 v[112:127], v[196:199], v[4:7], 0
  ds_read_b128 v[20:23], v130 offset:4096
  v_dot2_f32_bf16 v250, v194, s74, v250
  v_dot2_f32_bf16 v251, v195, s74, v251
  buffer_load_dwordx4 v143, s[24:27], s58 offen offset:3072 lds
  s_add_u32 s58, s58, 0x80
  s_cmp_eq_u32 s58, 0x500
  s_cselect_b32 s58, 0, s58
  s_waitcnt lgkmcnt(4)
  v_mfma_f32_32x32x16_bf16 v[64:79], v[200:203], v[8:11], v[64:79]
  ds_read_b64_tr_b16 v[192:193], v208 offset:24576
  ds_read_b64_tr_b16 v[194:195], v208 offset:25088
  ds_read_b128 v[24:27], v131 offset:0
  s_add_u32 m0, s41, 0x14000
  s_add_u32 s44, s45, s59
  buffer_load_dwordx4 v214, s[28:31], s44 offen offset:0 lds
  v_mfma_f32_32x32x16_bf16 v[80:95], v[200:203], v[12:15], v[80:95]
  ds_read_b64_tr_b16 v[196:197], v209 offset:24576
  ds_read_b64_tr_b16 v[198:199], v209 offset:25088
  ds_read_b128 v[28:31], v131 offset:4096
  buffer_load_dwordx4 v215, s[28:31], s44 offen offset:1024 lds
  s_add_u32 s59, s59, 0x36000
  s_waitcnt lgkmcnt(8)
  v_mfma_f32_32x32x16_bf16 v[96:111], v[204:207], v[8:11], v[96:111]
  v_dot2_f32_bf16 v250, v200, s74, v250
  v_dot2_f32_bf16 v251, v201, s74, v251
  v_dot2_f32_bf16 v250, v202, s74, v250
  v_dot2_f32_bf16 v251, v203, s74, v251
  buffer_load_dwordx4 v216, s[32:35], s44 offen offset:2048 lds
  s_cmp_eq_u32 s59, 0x21c000
  s_cselect_b32 s59, 0, s59
  v_mfma_f32_32x32x16_bf16 v[112:127], v[204:207], v[12:15], v[112:127]
  s_waitcnt vmcnt(7) lgkmcnt(0)
  s_barrier
  v_mfma_f32_32x32x16_bf16 v[64:79], v[192:195], v[16:19], v[64:79]
  ds_read_b64_tr_b16 v[200:201], v208 offset:28672
  ds_read_b64_tr_b16 v[202:203], v208 offset:29184
  buffer_load_dwordx4 v217, s[32:35], s44 offen offset:3072 lds
  v_mfma_f32_32x32x16_bf16 v[80:95], v[192:195], v[20:23], v[80:95]
  ds_read_b64_tr_b16 v[204:205], v209 offset:28672
  ds_read_b64_tr_b16 v[206:207], v209 offset:29184
  s_add_u32 m0, s41, 0x18000
  s_nop 0
  buffer_load_dwordx4 v140, s[24:27], s58 offen offset:0 lds
  v_mfma_f32_32x32x16_bf16 v[96:111], v[196:199], v[16:19], v[96:111]
  ds_read_b128 v[32:35], v128 offset:32768
  v_dot2_f32_bf16 v250, v192, s74, v250
  v_dot2_f32_bf16 v251, v193, s74, v251
  v_mfma_f32_32x32x16_bf16 v[112:127], v[196:199], v[20:23], v[112:127]
  ds_read_b128 v[36:39], v128 offset:36864
  v_dot2_f32_bf16 v250, v194, s74, v250
  v_dot2_f32_bf16 v251, v195, s74, v251
  buffer_load_dwordx4 v141, s[24:27], s58 offen offset:1024 lds
  s_waitcnt lgkmcnt(4)
  v_mfma_f32_32x32x16_bf16 v[64:79], v[200:203], v[24:27], v[64:79]
  ds_read_b64_tr_b16 v[192:193], v208 offset:49152
  ds_read_b64_tr_b16 v[194:195], v208 offset:49664
  v_mfma_f32_32x32x16_bf16 v[80:95], v[200:203], v[28:31], v[80:95]
  ds_read_b64_tr_b16 v[196:197], v209 offset:49152
  ds_read_b64_tr_b16 v[198:199], v209 offset:49664
  buffer_load_dwordx4 v142, s[24:27], s58 offen offset:2048 lds
  s_waitcnt lgkmcnt(6)
  v_mfma_f32_32x32x16_bf16 v[96:111], v[204:207], v[24:27], v[96:111]
  ds_read_b128 v[40:43], v129 offset:32768
  v_dot2_f32_bf16 v250, v200, s74, v250
  v_dot2_f32_bf16 v251, v201, s74, v251
  v_mfma_f32_32x32x16_bf16 v[112:127], v[204:207], v[28:31], v[112:127]
  ds_read_b128 v[44:47], v129 offset:36864
  v_dot2_f32_bf16 v250, v202, s74, v250
  v_dot2_f32_bf16 v251, v203, s74, v251
  buffer_load_dwordx4 v143, s[24:27], s58 offen offset:3072 lds
  s_add_u32 s58, s58, 0x80
  s_cmp_eq_u32 s58, 0x500
  s_cselect_b32 s58, 0, s58
  s_waitcnt lgkmcnt(4)
  v_mfma_f32_32x32x16_bf16 v[64:79], v[192:195], v[32:35], v[64:79]
  ds_read_b64_tr_b16 v[200:201], v208 offset:53248
  ds_read_b64_tr_b16 v[202:203], v208 offset:53760
  v_mfma_f32_32x32x16_bf16 v[80:95], v[192:195], v[36:39], v[80:95]
  ds_read_b64_tr_b16 v[204:205], v209 offset:53248
  ds_read_b64_tr_b16 v[206:207], v209 offset:53760
  s_add_u32 m0, s41, 0x1c000
  s_add_u32 s44, s45, s59
  buffer_load_dwordx4 v214, s[28:31], s44 offen offset:0 lds
  s_waitcnt lgkmcnt(6)
  v_mfma_f32_32x32x16_bf16 v[96:111], v[196:199], v[32:35], v[96:111]
  ds_read_b128 v[48:51], v130 offset:32768
  v_add_f32 v250, v250, v251
  v_mov_b32 v251, v250
  s_nop 0
  s_nop 0
  v_permlane32_swap_b32 v250, v251
  v_add_f32 v250, v250, v251
  buffer_store_dword v250, v252, s[16:19], s54 offen sc1
  v_mfma_f32_32x32x16_bf16 v[112:127], v[196:199], v[36:39], v[112:127]
  ds_read_b128 v[52:55], v130 offset:36864
  buffer_load_dwordx4 v215, s[28:31], s44 offen offset:1024 lds
  s_add_u32 s59, s59, 0x36000
  s_waitcnt lgkmcnt(4)
  v_mfma_f32_32x32x16_bf16 v[64:79], v[200:203], v[40:43], v[64:79]
  ds_read_b64_tr_b16 v[192:193], v208 offset:57344
  ds_read_b64_tr_b16 v[194:195], v208 offset:57856
  ds_read_b128 v[56:59], v131 offset:32768
  v_mfma_f32_32x32x16_bf16 v[80:95], v[200:203], v[44:47], v[80:95]
  ds_read_b64_tr_b16 v[196:197], v209 offset:57344
  ds_read_b64_tr_b16 v[198:199], v209 offset:57856
  ds_read_b128 v[60:63], v131 offset:36864
  buffer_load_dwordx4 v216, s[32:35], s44 offen offset:2048 lds
  s_cmp_eq_u32 s59, 0x21c000
  s_cselect_b32 s59, 0, s59
  s_waitcnt lgkmcnt(8)
  v_mfma_f32_32x32x16_bf16 v[96:111], v[204:207], v[40:43], v[96:111]
  v_mfma_f32_32x32x16_bf16 v[112:127], v[204:207], v[44:47], v[112:127]
  s_waitcnt vmcnt(8) lgkmcnt(0)
  s_barrier
  v_mfma_f32_32x32x16_bf16 v[64:79], v[192:195], v[48:51], v[64:79]
  ds_read_b64_tr_b16 v[200:201], v208 offset:61440
  ds_read_b64_tr_b16 v[202:203], v208 offset:61952
  buffer_load_dwordx4 v217, s[32:35], s44 offen offset:3072 lds
  v_mfma_f32_32x32x16_bf16 v[80:95], v[192:195], v[52:55], v[80:95]
  ds_read_b64_tr_b16 v[204:205], v209 offset:61440
  ds_read_b64_tr_b16 v[206:207], v209 offset:61952
  s_add_u32 m0, s41, 0x20000
  s_nop 0
  buffer_load_dwordx4 v140, s[24:27], s58 offen offset:0 lds
  v_mfma_f32_32x32x16_bf16 v[96:111], v[196:199], v[48:51], v[96:111]
  ds_read_b128 a[0:3], v132 offset:0
  v_mfma_f32_32x32x16_bf16 v[112:127], v[196:199], v[52:55], v[112:127]
  ds_read_b128 a[4:7], v132 offset:4096
  buffer_load_dwordx4 v141, s[24:27], s58 offen offset:1024 lds
  s_waitcnt lgkmcnt(4)
  v_mfma_f32_32x32x16_bf16 v[64:79], v[200:203], v[56:59], v[64:79]
  ds_read_b64_tr_b16 v[192:193], v210 offset:16384
  ds_read_b64_tr_b16 v[194:195], v210 offset:16896
  v_mfma_f32_32x32x16_bf16 v[80:95], v[200:203], v[60:63], v[80:95]
  ds_read_b64_tr_b16 v[196:197], v211 offset:16384
  ds_read_b64_tr_b16 v[198:199], v211 offset:16896
  buffer_load_dwordx4 v142, s[24:27], s58 offen offset:2048 lds
  s_waitcnt lgkmcnt(6)
  v_mfma_f32_32x32x16_bf16 v[96:111], v[204:207], v[56:59], v[96:111]
  ds_read_b128 a[8:11], v133 offset:0
  v_mfma_f32_32x32x16_bf16 v[112:127], v[204:207], v[60:63], v[112:127]
  ds_read_b128 a[12:15], v133 offset:4096
  buffer_load_dwordx4 v143, s[24:27], s58 offen offset:3072 lds
  s_add_u32 s58, s58, 0x80
  s_cmp_eq_u32 s58, 0x500
  s_cselect_b32 s58, 0, s58
  s_waitcnt lgkmcnt(4)
  v_mfma_f32_32x32x16_bf16 v[64:79], v[192:195], a[0:3], v[64:79]
  ds_read_b64_tr_b16 v[200:201], v210 offset:20480
  ds_read_b64_tr_b16 v[202:203], v210 offset:20992
  v_mfma_f32_32x32x16_bf16 v[80:95], v[192:195], a[4:7], v[80:95]
  ds_read_b64_tr_b16 v[204:205], v211 offset:20480
  ds_read_b64_tr_b16 v[206:207], v211 offset:20992
  s_add_u32 m0, s41, 0x24000
  s_add_u32 s44, s45, s59
  buffer_load_dwordx4 v214, s[28:31], s44 offen offset:0 lds
  s_waitcnt lgkmcnt(6)
  v_mfma_f32_32x32x16_bf16 v[96:111], v[196:199], a[0:3], v[96:111]
  ds_read_b128 a[16:19], v134 offset:0
  v_mfma_f32_32x32x16_bf16 v[112:127], v[196:199], a[4:7], v[112:127]
  ds_read_b128 a[20:23], v134 offset:4096
  buffer_load_dwordx4 v215, s[28:31], s44 offen offset:1024 lds
  s_add_u32 s59, s59, 0x36000
  s_waitcnt lgkmcnt(4)
  v_mfma_f32_32x32x16_bf16 v[64:79], v[200:203], a[8:11], v[64:79]
  ds_read_b64_tr_b16 v[192:193], v210 offset:24576
  ds_read_b64_tr_b16 v[194:195], v210 offset:25088
  ds_read_b128 a[24:27], v135 offset:0
  v_mfma_f32_32x32x16_bf16 v[80:95], v[200:203], a[12:15], v[80:95]
  ds_read_b64_tr_b16 v[196:197], v211 offset:24576
  ds_read_b64_tr_b16 v[198:199], v211 offset:25088
  ds_read_b128 a[28:31], v135 offset:4096
  buffer_load_dwordx4 v216, s[32:35], s44 offen offset:2048 lds
  s_cmp_eq_u32 s59, 0x21c000
  s_cselect_b32 s59, 0, s59
  s_waitcnt lgkmcnt(8)
  v_mfma_f32_32x32x16_bf16 v[96:111], v[204:207], a[8:11], v[96:111]
  v_mfma_f32_32x32x16_bf16 v[112:127], v[204:207], a[12:15], v[112:127]
  s_waitcnt vmcnt(7) lgkmcnt(0)
  s_barrier
  v_mfma_f32_32x32x16_bf16 v[64:79], v[192:195], a[16:19], v[64:79]
  ds_read_b64_tr_b16 v[200:201], v210 offset:28672
  ds_read_b64_tr_b16 v[202:203], v210 offset:29184
  v_lshrrev_b32 v255, 4, v218
  v_add_u32 v255, 1, v255
  buffer_atomic_add v255, v253, s[8:11], 0 offen sc1
  buffer_load_dwordx4 v217, s[32:35], s44 offen offset:3072 lds
  v_mfma_f32_32x32x16_bf16 v[80:95], v[192:195], a[20:23], v[80:95]
  ds_read_b64_tr_b16 v[204:205], v211 offset:28672
  ds_read_b64_tr_b16 v[206:207], v211 offset:29184
  s_add_u32 m0, s41, 0
  s_nop 0
  buffer_load_dwordx4 v140, s[24:27], s58 offen offset:0 lds
  v_mfma_f32_32x32x16_bf16 v[96:111], v[196:199], a[16:19], v[96:111]
  ds_read_b128 a[32:35], v132 offset:32768
  v_mfma_f32_32x32x16_bf16 v[112:127], v[196:199], a[20:23], v[112:127]
  ds_read_b128 a[36:39], v132 offset:36864
  buffer_load_dwordx4 v141, s[24:27], s58 offen offset:1024 lds
  s_waitcnt lgkmcnt(4)
  v_mfma_f32_32x32x16_bf16 v[64:79], v[200:203], a[24:27], v[64:79]
  ds_read_b64_tr_b16 v[192:193], v210 offset:49152
  ds_read_b64_tr_b16 v[194:195], v210 offset:49664
  v_mfma_f32_32x32x16_bf16 v[80:95], v[200:203], a[28:31], v[80:95]
  ds_read_b64_tr_b16 v[196:197], v211 offset:49152
  ds_read_b64_tr_b16 v[198:199], v211 offset:49664
  buffer_load_dwordx4 v142, s[24:27], s58 offen offset:2048 lds
  s_waitcnt lgkmcnt(6)
  v_mfma_f32_32x32x16_bf16 v[96:111], v[204:207], a[24:27], v[96:111]
  ds_read_b128 a[40:43], v133 offset:32768
  v_mfma_f32_32x32x16_bf16 v[112:127], v[204:207], a[28:31], v[112:127]
  ds_read_b128 a[44:47], v133 offset:36864
  buffer_load_dwordx4 v143, s[24:27], s58 offen offset:3072 lds
  s_add_u32 s58, s58, 0x80
  s_cmp_eq_u32 s58, 0x500
  s_cselect_b32 s58, 0, s58
  s_waitcnt lgkmcnt(4)
  v_mfma_f32_32x32x16_bf16 v[64:79], v[192:195], a[32:35], v[64:79]
  ds_read_b64_tr_b16 v[200:201], v210 offset:53248
  ds_read_b64_tr_b16 v[202:203], v210 offset:53760
  v_mfma_f32_32x32x16_bf16 v[80:95], v[192:195], a[36:39], v[80:95]
  ds_read_b64_tr_b16 v[204:205], v211 offset:53248
  ds_read_b64_tr_b16 v[206:207], v211 offset:53760
  s_add_u32 m0, s41, 0x4000
  s_add_u32 s44, s45, s59
  buffer_load_dwordx4 v214, s[28:31], s44 offen offset:0 lds
  s_waitcnt lgkmcnt(6)
  v_mfma_f32_32x32x16_bf16 v[96:111], v[196:199], a[32:35], v[96:111]
  ds_read_b128 a[48:51], v134 offset:32768
  v_mfma_f32_32x32x16_bf16 v[112:127], v[196:199], a[36:39], v[112:127]
  ds_read_b128 a[52:55], v134 offset:36864
  buffer_load_dwordx4 v215, s[28:31], s44 offen offset:1024 lds
  s_add_u32 s59, s59, 0x36000
  s_waitcnt lgkmcnt(4)
  v_mfma_f32_32x32x16_bf16 v[64:79], v[200:203], a[40:43], v[64:79]
  ds_read_b64_tr_b16 v[192:193], v210 offset:57344
  ds_read_b64_tr_b16 v[194:195], v210 offset:57856
  ds_read_b128 a[56:59], v135 offset:32768
  v_mfma_f32_32x32x16_bf16 v[80:95], v[200:203], a[44:47], v[80:95]
  ds_read_b64_tr_b16 v[196:197], v211 offset:57344
  ds_read_b64_tr_b16 v[198:199], v211 offset:57856
  ds_read_b128 a[60:63], v135 offset:36864
  buffer_load_dwordx4 v216, s[32:35], s44 offen offset:2048 lds
  s_cmp_eq_u32 s59, 0x21c000
  s_cselect_b32 s59, 0, s59
  s_waitcnt lgkmcnt(8)
  v_mfma_f32_32x32x16_bf16 v[96:111], v[204:207], a[40:43], v[96:111]
  v_mfma_f32_32x32x16_bf16 v[112:127], v[204:207], a[44:47], v[112:127]
  s_waitcnt vmcnt(7) lgkmcnt(0)
  s_barrier
  v_mfma_f32_32x32x16_bf16 v[64:79], v[192:195], a[48:51], v[64:79]
  ds_read_b64_tr_b16 v[200:201], v210 offset:61440
  ds_read_b64_tr_b16 v[202:203], v210 offset:61952
  buffer_load_dwordx4 v217, s[32:35], s44 offen offset:3072 lds
  v_mfma_f32_32x32x16_bf16 v[80:95], v[192:195], a[52:55], v[80:95]
  ds_read_b64_tr_b16 v[204:205], v211 offset:61440
  ds_read_b64_tr_b16 v[206:207], v211 offset:61952
  s_add_u32 m0, s41, 0x8000
  s_nop 0
  buffer_load_dwordx4 v140, s[24:27], s58 offen offset:0 lds
  v_mfma_f32_32x32x16_bf16 v[96:111], v[196:199], a[48:51], v[96:111]
  ds_read_b128 a[64:67], v136 offset:0
  v_mfma_f32_32x32x16_bf16 v[112:127], v[196:199], a[52:55], v[112:127]
  ds_read_b128 a[68:71], v136 offset:4096
  buffer_load_dwordx4 v141, s[24:27], s58 offen offset:1024 lds
  s_waitcnt lgkmcnt(4)
  v_mfma_f32_32x32x16_bf16 v[64:79], v[200:203], a[56:59], v[64:79]
  ds_read_b64_tr_b16 v[192:193], v212 offset:16384
  ds_read_b64_tr_b16 v[194:195], v212 offset:16896
  v_mfma_f32_32x32x16_bf16 v[80:95], v[200:203], a[60:63], v[80:95]
  ds_read_b64_tr_b16 v[196:197], v213 offset:16384
  ds_read_b64_tr_b16 v[198:199], v213 offset:16896
  buffer_load_dwordx4 v142, s[24:27], s58 offen offset:2048 lds
  s_waitcnt lgkmcnt(6)
  v_mfma_f32_32x32x16_bf16 v[96:111], v[204:207], a[56:59], v[96:111]
  ds_read_b128 a[72:75], v137 offset:0
  v_mfma_f32_32x32x16_bf16 v[112:127], v[204:207], a[60:63], v[112:127]
  ds_read_b128 a[76:79], v137 offset:4096
  buffer_load_dwordx4 v143, s[24:27], s58 offen offset:3072 lds
  s_add_u32 s58, s58, 0x80
  s_cmp_eq_u32 s58, 0x500
  s_cselect_b32 s58, 0, s58
  s_waitcnt lgkmcnt(4)
  v_mfma_f32_32x32x16_bf16 v[64:79], v[192:195], a[64:67], v[64:79]
  ds_read_b64_tr_b16 v[200:201], v212 offset:20480
  ds_read_b64_tr_b16 v[202:203], v212 offset:20992
  v_mfma_f32_32x32x16_bf16 v[80:95], v[192:195], a[68:71], v[80:95]
  ds_read_b64_tr_b16 v[204:205], v213 offset:20480
  ds_read_b64_tr_b16 v[206:207], v213 offset:20992
  s_add_u32 m0, s41, 0xc000
  s_add_u32 s44, s45, s59
  buffer_load_dwordx4 v214, s[28:31], s44 offen offset:0 lds
  s_waitcnt lgkmcnt(6)
  v_mfma_f32_32x32x16_bf16 v[96:111], v[196:199], a[64:67], v[96:111]
  ds_read_b128 a[80:83], v138 offset:0
  v_mfma_f32_32x32x16_bf16 v[112:127], v[196:199], a[68:71], v[112:127]
  ds_read_b128 a[84:87], v138 offset:4096
  buffer_load_dwordx4 v215, s[28:31], s44 offen offset:1024 lds
  s_add_u32 s59, s59, 0x36000
  s_waitcnt lgkmcnt(4)
  v_mfma_f32_32x32x16_bf16 v[64:79], v[200:203], a[72:75], v[64:79]
  ds_read_b64_tr_b16 v[192:193], v212 offset:24576
  ds_read_b64_tr_b16 v[194:195], v212 offset:25088
  ds_read_b128 a[88:91], v139 offset:0
  v_mfma_f32_32x32x16_bf16 v[80:95], v[200:203], a[76:79], v[80:95]
  ds_read_b64_tr_b16 v[196:197], v213 offset:24576
  ds_read_b64_tr_b16 v[198:199], v213 offset:25088
  ds_read_b128 a[92:95], v139 offset:4096
  buffer_load_dwordx4 v216, s[32:35], s44 offen offset:2048 lds
  s_cmp_eq_u32 s59, 0x21c000
  s_cselect_b32 s59, 0, s59
  s_waitcnt lgkmcnt(8)
  v_mfma_f32_32x32x16_bf16 v[96:111], v[204:207], a[72:75], v[96:111]
  v_mfma_f32_32x32x16_bf16 v[112:127], v[204:207], a[76:79], v[112:127]
  s_waitcnt vmcnt(7) lgkmcnt(0)
  s_barrier
  v_mfma_f32_32x32x16_bf16 v[64:79], v[192:195], a[80:83], v[64:79]
  ds_read_b64_tr_b16 v[200:201], v212 offset:28672
  ds_read_b64_tr_b16 v[202:203], v212 offset:29184
  buffer_load_dwordx4 v217, s[32:35], s44 offen offset:3072 lds
  v_mfma_f32_32x32x16_bf16 v[80:95], v[192:195], a[84:87], v[80:95]
  ds_read_b64_tr_b16 v[204:205], v213 offset:28672
  ds_read_b64_tr_b16 v[206:207], v213 offset:29184
  s_add_u32 m0, s41, 0x10000
  s_nop 0
  buffer_load_dwordx4 v140, s[24:27], s58 offen offset:0 lds
  v_mfma_f32_32x32x16_bf16 v[96:111], v[196:199], a[80:83], v[96:111]
  ds_read_b128 a[96:99], v128 offset:0
  v_mfma_f32_32x32x16_bf16 v[112:127], v[196:199], a[84:87], v[112:127]
  ds_read_b128 a[100:103], v128 offset:4096
  buffer_load_dwordx4 v141, s[24:27], s58 offen offset:1024 lds
  s_waitcnt lgkmcnt(4)
  v_mfma_f32_32x32x16_bf16 v[64:79], v[200:203], a[88:91], v[64:79]
  ds_read_b64_tr_b16 v[192:193], v208 offset:16384
  ds_read_b64_tr_b16 v[194:195], v208 offset:16896
  v_mfma_f32_32x32x16_bf16 v[80:95], v[200:203], a[92:95], v[80:95]
  ds_read_b64_tr_b16 v[196:197], v209 offset:16384
  ds_read_b64_tr_b16 v[198:199], v209 offset:16896
  buffer_load_dwordx4 v142, s[24:27], s58 offen offset:2048 lds
  s_waitcnt lgkmcnt(6)
  v_mfma_f32_32x32x16_bf16 v[96:111], v[204:207], a[88:91], v[96:111]
  ds_read_b128 a[104:107], v129 offset:0
  v_mfma_f32_32x32x16_bf16 v[112:127], v[204:207], a[92:95], v[112:127]
  ds_read_b128 a[108:111], v129 offset:4096
  buffer_load_dwordx4 v143, s[24:27], s58 offen offset:3072 lds
  s_add_u32 s58, s58, 0x80
  s_cmp_eq_u32 s58, 0x500
  s_cselect_b32 s58, 0, s58
  s_waitcnt lgkmcnt(4)
  v_mfma_f32_32x32x16_bf16 v[64:79], v[192:195], a[96:99], v[64:79]
  ds_read_b64_tr_b16 v[200:201], v208 offset:20480
  ds_read_b64_tr_b16 v[202:203], v208 offset:20992
  v_mfma_f32_32x32x16_bf16 v[80:95], v[192:195], a[100:103], v[80:95]
  ds_read_b64_tr_b16 v[204:205], v209 offset:20480
  ds_read_b64_tr_b16 v[206:207], v209 offset:20992
  s_add_u32 m0, s41, 0x14000
  s_add_u32 s44, s45, s59
  buffer_load_dwordx4 v214, s[28:31], s44 offen offset:0 lds
  s_waitcnt lgkmcnt(6)
  v_mfma_f32_32x32x16_bf16 v[96:111], v[196:199], a[96:99], v[96:111]
  ds_read_b128 a[112:115], v130 offset:0
  v_mfma_f32_32x32x16_bf16 v[112:127], v[196:199], a[100:103], v[112:127]
  ds_read_b128 a[116:119], v130 offset:4096
  buffer_load_dwordx4 v215, s[28:31], s44 offen offset:1024 lds
  s_add_u32 s59, s59, 0x36000
  s_waitcnt lgkmcnt(4)
  v_mfma_f32_32x32x16_bf16 v[64:79], v[200:203], a[104:107], v[64:79]
  ds_read_b64_tr_b16 v[192:193], v208 offset:24576
  ds_read_b64_tr_b16 v[194:195], v208 offset:25088
  ds_read_b128 a[120:123], v131 offset:0
  v_mfma_f32_32x32x16_bf16 v[80:95], v[200:203], a[108:111], v[80:95]
  ds_read_b64_tr_b16 v[196:197], v209 offset:24576
  ds_read_b64_tr_b16 v[198:199], v209 offset:25088
  ds_read_b128 a[124:127], v131 offset:4096
  buffer_load_dwordx4 v216, s[32:35], s44 offen offset:2048 lds
  s_cmp_eq_u32 s59, 0x21c000
  s_cselect_b32 s59, 0, s59
  s_waitcnt lgkmcnt(8)
  v_mfma_f32_32x32x16_bf16 v[96:111], v[204:207], a[104:107], v[96:111]
  v_mfma_f32_32x32x16_bf16 v[112:127], v[204:207], a[108:111], v[112:127]
  s_waitcnt vmcnt(7) lgkmcnt(0)
  s_barrier
  v_mfma_f32_32x32x16_bf16 v[64:79], v[192:195], a[112:115], v[64:79]
  ds_read_b64_tr_b16 v[200:201], v208 offset:28672
  ds_read_b64_tr_b16 v[202:203], v208 offset:29184
  buffer_load_dwordx4 v217, s[32:35], s44 offen offset:3072 lds
  v_mfma_f32_32x32x16_bf16 v[80:95], v[192:195], a[116:119], v[80:95]
  ds_read_b64_tr_b16 v[204:205], v209 offset:28672
  ds_read_b64_tr_b16 v[206:207], v209 offset:29184
  s_add_u32 m0, s41, 0x18000
  s_nop 0
  buffer_load_dwordx4 v140, s[24:27], s58 offen offset:0 lds
  v_mfma_f32_32x32x16_bf16 v[96:111], v[196:199], a[112:115], v[96:111]
  ds_read_b128 a[128:131], v128 offset:32768
  v_mfma_f32_32x32x16_bf16 v[112:127], v[196:199], a[116:119], v[112:127]
  ds_read_b128 a[132:135], v128 offset:36864
  buffer_load_dwordx4 v141, s[24:27], s58 offen offset:1024 lds
  s_waitcnt lgkmcnt(4)
  v_mfma_f32_32x32x16_bf16 v[64:79], v[200:203], a[120:123], v[64:79]
  ds_read_b64_tr_b16 v[192:193], v208 offset:49152
  ds_read_b64_tr_b16 v[194:195], v208 offset:49664
  v_mfma_f32_32x32x16_bf16 v[80:95], v[200:203], a[124:127], v[80:95]
  ds_read_b64_tr_b16 v[196:197], v209 offset:49152
  ds_read_b64_tr_b16 v[198:199], v209 offset:49664
  buffer_load_dwordx4 v142, s[24:27], s58 offen offset:2048 lds
  s_waitcnt lgkmcnt(6)
  v_mfma_f32_32x32x16_bf16 v[96:111], v[204:207], a[120:123], v[96:111]
  ds_read_b128 a[136:139], v129 offset:32768
  v_mfma_f32_32x32x16_bf16 v[112:127], v[204:207], a[124:127], v[112:127]
  ds_read_b128 a[140:143], v129 offset:36864
  buffer_load_dwordx4 v143, s[24:27], s58 offen offset:3072 lds
  s_add_u32 s58, s58, 0x80
  s_cmp_eq_u32 s58, 0x500
  s_cselect_b32 s58, 0, s58
  s_waitcnt lgkmcnt(4)
  v_mfma_f32_32x32x16_bf16 v[64:79], v[192:195], a[128:131], v[64:79]
  ds_read_b64_tr_b16 v[200:201], v208 offset:53248
  ds_read_b64_tr_b16 v[202:203], v208 offset:53760
  v_mfma_f32_32x32x16_bf16 v[80:95], v[192:195], a[132:135], v[80:95]
  ds_read_b64_tr_b16 v[204:205], v209 offset:53248
  ds_read_b64_tr_b16 v[206:207], v209 offset:53760
  s_add_u32 m0, s41, 0x1c000
  s_add_u32 s44, s45, s59
  buffer_load_dwordx4 v214, s[28:31], s44 offen offset:0 lds
  s_waitcnt lgkmcnt(6)
  v_mfma_f32_32x32x16_bf16 v[96:111], v[196:199], a[128:131], v[96:111]
  ds_read_b128 a[144:147], v130 offset:32768
  v_mfma_f32_32x32x16_bf16 v[112:127], v[196:199], a[132:135], v[112:127]
  ds_read_b128 a[148:151], v130 offset:36864
  buffer_load_dwordx4 v215, s[28:31], s44 offen offset:1024 lds
  s_add_u32 s59, s59, 0x36000
  s_waitcnt lgkmcnt(4)
  v_mfma_f32_32x32x16_bf16 v[64:79], v[200:203], a[136:139], v[64:79]
  ds_read_b64_tr_b16 v[192:193], v208 offset:57344
  ds_read_b64_tr_b16 v[194:195], v208 offset:57856
  ds_read_b128 a[152:155], v131 offset:32768
  v_mfma_f32_32x32x16_bf16 v[80:95], v[200:203], a[140:143], v[80:95]
  ds_read_b64_tr_b16 v[196:197], v209 offset:57344
  ds_read_b64_tr_b16 v[198:199], v209 offset:57856
  ds_read_b128 a[156:159], v131 offset:36864
  buffer_load_dwordx4 v216, s[32:35], s44 offen offset:2048 lds
  s_cmp_eq_u32 s59, 0x21c000
  s_cselect_b32 s59, 0, s59
  s_waitcnt lgkmcnt(8)
  v_mfma_f32_32x32x16_bf16 v[96:111], v[204:207], a[136:139], v[96:111]
  v_mfma_f32_32x32x16_bf16 v[112:127], v[204:207], a[140:143], v[112:127]
  s_waitcnt vmcnt(7) lgkmcnt(0)
  s_barrier
  v_mfma_f32_32x32x16_bf16 v[64:79], v[192:195], a[144:147], v[64:79]
  ds_read_b64_tr_b16 v[200:201], v208 offset:61440
  ds_read_b64_tr_b16 v[202:203], v208 offset:61952
  buffer_load_dword v255, v254, s[8:11], 0 offen offset:0 sc1
  buffer_load_dwordx4 v217, s[32:35], s44 offen offset:3072 lds
  v_mfma_f32_32x32x16_bf16 v[80:95], v[192:195], a[148:151], v[80:95]
  ds_read_b64_tr_b16 v[204:205], v209 offset:61440
  ds_read_b64_tr_b16 v[206:207], v209 offset:61952
  s_add_u32 m0, s41, 0x20000
  s_nop 0
  buffer_load_dwordx4 v140, s[24:27], s58 offen offset:0 lds
  v_mfma_f32_32x32x16_bf16 v[96:111], v[196:199], a[144:147], v[96:111]
  ds_read_b128 a[160:163], v132 offset:0
  v_mfma_f32_32x32x16_bf16 v[112:127], v[196:199], a[148:151], v[112:127]
  ds_read_b128 a[164:167], v132 offset:4096
  buffer_load_dwordx4 v141, s[24:27], s58 offen offset:1024 lds
  s_waitcnt lgkmcnt(4)
  v_mfma_f32_32x32x16_bf16 v[64:79], v[200:203], a[152:155], v[64:79]
  ds_read_b64_tr_b16 v[192:193], v210 offset:16384
  ds_read_b64_tr_b16 v[194:195], v210 offset:16896
  v_mfma_f32_32x32x16_bf16 v[80:95], v[200:203], a[156:159], v[80:95]
  ds_read_b64_tr_b16 v[196:197], v211 offset:16384
  ds_read_b64_tr_b16 v[198:199], v211 offset:16896
  buffer_load_dwordx4 v142, s[24:27], s58 offen offset:2048 lds
  s_waitcnt lgkmcnt(6)
  v_mfma_f32_32x32x16_bf16 v[96:111], v[204:207], a[152:155], v[96:111]
  ds_read_b128 a[168:171], v133 offset:0
  v_mfma_f32_32x32x16_bf16 v[112:127], v[204:207], a[156:159], v[112:127]
  ds_read_b128 a[172:175], v133 offset:4096
  buffer_load_dwordx4 v143, s[24:27], s58 offen offset:3072 lds
  s_add_u32 s58, s58, 0x80
  s_cmp_eq_u32 s58, 0x500
  s_cselect_b32 s58, 0, s58
  s_waitcnt lgkmcnt(4)
  v_mfma_f32_32x32x16_bf16 v[64:79], v[192:195], a[160:163], v[64:79]
  ds_read_b64_tr_b16 v[200:201], v210 offset:20480
  ds_read_b64_tr_b16 v[202:203], v210 offset:20992
  v_mfma_f32_32x32x16_bf16 v[80:95], v[192:195], a[164:167], v[80:95]
  ds_read_b64_tr_b16 v[204:205], v211 offset:20480
  ds_read_b64_tr_b16 v[206:207], v211 offset:20992
  s_add_u32 m0, s41, 0x24000
  s_add_u32 s44, s45, s59
  buffer_load_dwordx4 v214, s[28:31], s44 offen offset:0 lds
  s_waitcnt lgkmcnt(6)
  v_mfma_f32_32x32x16_bf16 v[96:111], v[196:199], a[160:163], v[96:111]
  ds_read_b128 a[176:179], v134 offset:0
  v_mfma_f32_32x32x16_bf16 v[112:127], v[196:199], a[164:167], v[112:127]
  ds_read_b128 a[180:183], v134 offset:4096
  buffer_load_dwordx4 v215, s[28:31], s44 offen offset:1024 lds
  s_add_u32 s59, s59, 0x36000
  s_waitcnt lgkmcnt(4)
  v_mfma_f32_32x32x16_bf16 v[64:79], v[200:203], a[168:171], v[64:79]
  ds_read_b64_tr_b16 v[192:193], v210 offset:24576
  ds_read_b64_tr_b16 v[194:195], v210 offset:25088
  ds_read_b128 a[184:187], v135 offset:0
  v_mfma_f32_32x32x16_bf16 v[80:95], v[200:203], a[172:175], v[80:95]
  ds_read_b64_tr_b16 v[196:197], v211 offset:24576
  ds_read_b64_tr_b16 v[198:199], v211 offset:25088
  ds_read_b128 a[188:191], v135 offset:4096
  buffer_load_dwordx4 v216, s[32:35], s44 offen offset:2048 lds
  s_cmp_eq_u32 s59, 0x21c000
  s_cselect_b32 s59, 0, s59
  s_waitcnt lgkmcnt(8)
  v_mfma_f32_32x32x16_bf16 v[96:111], v[204:207], a[168:171], v[96:111]
  v_mfma_f32_32x32x16_bf16 v[112:127], v[204:207], a[172:175], v[112:127]
  s_waitcnt vmcnt(7) lgkmcnt(0)
  s_barrier
  v_mfma_f32_32x32x16_bf16 v[64:79], v[192:195], a[176:179], v[64:79]
  ds_read_b64_tr_b16 v[200:201], v210 offset:28672
  ds_read_b64_tr_b16 v[202:203], v210 offset:29184
  buffer_load_dwordx4 v217, s[32:35], s44 offen offset:3072 lds
  v_mfma_f32_32x32x16_bf16 v[80:95], v[192:195], a[180:183], v[80:95]
  ds_read_b64_tr_b16 v[204:205], v211 offset:28672
  ds_read_b64_tr_b16 v[206:207], v211 offset:29184
  s_add_u32 m0, s41, 0
  s_add_u32 s44, s46, s59
  buffer_load_dwordx4 v214, s[28:31], s44 offen offset:0 lds
  v_mfma_f32_32x32x16_bf16 v[96:111], v[196:199], a[176:179], v[96:111]
  ds_read_b128 a[192:195], v132 offset:32768
  v_mfma_f32_32x32x16_bf16 v[112:127], v[196:199], a[180:183], v[112:127]
  ds_read_b128 a[196:199], v132 offset:36864
  buffer_load_dwordx4 v215, s[28:31], s44 offen offset:1024 lds
  s_add_u32 s59, s59, 0x36000
  s_waitcnt lgkmcnt(4)
  v_mfma_f32_32x32x16_bf16 v[64:79], v[200:203], a[184:187], v[64:79]
  ds_read_b64_tr_b16 v[192:193], v210 offset:49152
  ds_read_b64_tr_b16 v[194:195], v210 offset:49664
  v_mfma_f32_32x32x16_bf16 v[80:95], v[200:203], a[188:191], v[80:95]
  ds_read_b64_tr_b16 v[196:197], v211 offset:49152
  ds_read_b64_tr_b16 v[198:199], v211 offset:49664
  buffer_load_dwordx4 v216, s[32:35], s44 offen offset:2048 lds
  s_cmp_eq_u32 s59, 0x21c000
  s_cselect_b32 s59, 0, s59
  s_waitcnt lgkmcnt(6)
  v_mfma_f32_32x32x16_bf16 v[96:111], v[204:207], a[184:187], v[96:111]
  ds_read_b128 a[200:203], v133 offset:32768
  v_mfma_f32_32x32x16_bf16 v[112:127], v[204:207], a[188:191], v[112:127]
  ds_read_b128 a[204:207], v133 offset:36864
  buffer_load_dwordx4 v217, s[32:35], s44 offen offset:3072 lds
  s_waitcnt lgkmcnt(4)
  v_mfma_f32_32x32x16_bf16 v[64:79], v[192:195], a[192:195], v[64:79]
  ds_read_b64_tr_b16 v[200:201], v210 offset:53248
  ds_read_b64_tr_b16 v[202:203], v210 offset:53760
  v_mfma_f32_32x32x16_bf16 v[80:95], v[192:195], a[196:199], v[80:95]
  ds_read_b64_tr_b16 v[204:205], v211 offset:53248
  ds_read_b64_tr_b16 v[206:207], v211 offset:53760
  s_add_u32 m0, s41, 0x4000
  s_add_u32 s44, s46, s59
  buffer_load_dwordx4 v214, s[28:31], s44 offen offset:0 lds
  s_waitcnt lgkmcnt(6)
  v_mfma_f32_32x32x16_bf16 v[96:111], v[196:199], a[192:195], v[96:111]
  ds_read_b128 a[208:211], v134 offset:32768
  v_mfma_f32_32x32x16_bf16 v[112:127], v[196:199], a[196:199], v[112:127]
  ds_read_b128 a[212:215], v134 offset:36864
  buffer_load_dwordx4 v215, s[28:31], s44 offen offset:1024 lds
  s_add_u32 s59, s59, 0x36000
  s_waitcnt lgkmcnt(4)
  v_mfma_f32_32x32x16_bf16 v[64:79], v[200:203], a[200:203], v[64:79]
  ds_read_b64_tr_b16 v[192:193], v210 offset:57344
  ds_read_b64_tr_b16 v[194:195], v210 offset:57856
  ds_read_b128 a[216:219], v135 offset:32768
  v_mfma_f32_32x32x16_bf16 v[80:95], v[200:203], a[204:207], v[80:95]
  ds_read_b64_tr_b16 v[196:197], v211 offset:57344
  ds_read_b64_tr_b16 v[198:199], v211 offset:57856
  ds_read_b128 a[220:223], v135 offset:36864
  buffer_load_dwordx4 v216, s[32:35], s44 offen offset:2048 lds
  s_cmp_eq_u32 s59, 0x21c000
  s_cselect_b32 s59, 0, s59
  s_waitcnt lgkmcnt(8)
  v_mfma_f32_32x32x16_bf16 v[96:111], v[204:207], a[200:203], v[96:111]
  v_mfma_f32_32x32x16_bf16 v[112:127], v[204:207], a[204:207], v[112:127]
  s_waitcnt vmcnt(7) lgkmcnt(0)
  s_barrier
  v_mfma_f32_32x32x16_bf16 v[64:79], v[192:195], a[208:211], v[64:79]
  ds_read_b64_tr_b16 v[200:201], v210 offset:61440
  ds_read_b64_tr_b16 v[202:203], v210 offset:61952
  buffer_load_dwordx4 v217, s[32:35], s44 offen offset:3072 lds
  v_mfma_f32_32x32x16_bf16 v[80:95], v[192:195], a[212:215], v[80:95]
  ds_read_b64_tr_b16 v[204:205], v211 offset:61440
  ds_read_b64_tr_b16 v[206:207], v211 offset:61952
  s_add_u32 m0, s41, 0x8000
  s_add_u32 s44, s46, s59
  buffer_load_dwordx4 v214, s[28:31], s44 offen offset:0 lds
  v_mfma_f32_32x32x16_bf16 v[96:111], v[196:199], a[208:211], v[96:111]
  ds_read_b128 a[224:227], v136 offset:0
  v_mfma_f32_32x32x16_bf16 v[112:127], v[196:199], a[212:215], v[112:127]
  ds_read_b128 a[228:231], v136 offset:4096
  buffer_load_dwordx4 v215, s[28:31], s44 offen offset:1024 lds
  s_add_u32 s59, s59, 0x36000
  s_waitcnt lgkmcnt(4)
  v_mfma_f32_32x32x16_bf16 v[64:79], v[200:203], a[216:219], v[64:79]
  ds_read_b64_tr_b16 v[192:193], v212 offset:16384
  ds_read_b64_tr_b16 v[194:195], v212 offset:16896
  v_mfma_f32_32x32x16_bf16 v[80:95], v[200:203], a[220:223], v[80:95]
  ds_read_b64_tr_b16 v[196:197], v213 offset:16384
  ds_read_b64_tr_b16 v[198:199], v213 offset:16896
  buffer_load_dwordx4 v216, s[32:35], s44 offen offset:2048 lds
  s_cmp_eq_u32 s59, 0x21c000
  s_cselect_b32 s59, 0, s59
  s_waitcnt lgkmcnt(6)
  v_mfma_f32_32x32x16_bf16 v[96:111], v[204:207], a[216:219], v[96:111]
  ds_read_b128 a[232:235], v137 offset:0
  v_mfma_f32_32x32x16_bf16 v[112:127], v[204:207], a[220:223], v[112:127]
  ds_read_b128 a[236:239], v137 offset:4096
  buffer_load_dwordx4 v217, s[32:35], s44 offen offset:3072 lds
  s_waitcnt lgkmcnt(4)
  v_mfma_f32_32x32x16_bf16 v[64:79], v[192:195], a[224:227], v[64:79]
  ds_read_b64_tr_b16 v[200:201], v212 offset:20480
  ds_read_b64_tr_b16 v[202:203], v212 offset:20992
  v_mfma_f32_32x32x16_bf16 v[80:95], v[192:195], a[228:231], v[80:95]
  ds_read_b64_tr_b16 v[204:205], v213 offset:20480
  ds_read_b64_tr_b16 v[206:207], v213 offset:20992
  s_add_u32 m0, s41, 0xc000
  s_add_u32 s44, s46, s59
  buffer_load_dwordx4 v214, s[28:31], s44 offen offset:0 lds
  s_waitcnt lgkmcnt(6)
  v_mfma_f32_32x32x16_bf16 v[96:111], v[196:199], a[224:227], v[96:111]
  ds_read_b128 a[240:243], v138 offset:0
  v_mfma_f32_32x32x16_bf16 v[112:127], v[196:199], a[228:231], v[112:127]
  ds_read_b128 a[244:247], v138 offset:4096
  buffer_load_dwordx4 v215, s[28:31], s44 offen offset:1024 lds
  s_add_u32 s59, s59, 0x36000
  s_waitcnt lgkmcnt(4)
  v_mfma_f32_32x32x16_bf16 v[64:79], v[200:203], a[232:235], v[64:79]
  ds_read_b64_tr_b16 v[192:193], v212 offset:24576
  ds_read_b64_tr_b16 v[194:195], v212 offset:25088
  v_mfma_f32_32x32x16_bf16 v[80:95], v[200:203], a[236:239], v[80:95]
  ds_read_b64_tr_b16 v[196:197], v213 offset:24576
  ds_read_b64_tr_b16 v[198:199], v213 offset:25088
  buffer_load_dwordx4 v216, s[32:35], s44 offen offset:2048 lds
  s_cmp_eq_u32 s59, 0x21c000
  s_cselect_b32 s59, 0, s59
  s_waitcnt lgkmcnt(6)
  v_mfma_f32_32x32x16_bf16 v[96:111], v[204:207], a[232:235], v[96:111]
  ds_read_b128 a[248:251], v139 offset:0
  v_mfma_f32_32x32x16_bf16 v[112:127], v[204:207], a[236:239], v[112:127]
  ds_read_b128 a[252:255], v139 offset:4096
  buffer_load_dwordx4 v217, s[32:35], s44 offen offset:3072 lds
  s_waitcnt lgkmcnt(4)
  v_mfma_f32_32x32x16_bf16 v[64:79], v[192:195], a[240:243], v[64:79]
  ds_read_b64_tr_b16 v[200:201], v212 offset:28672
  ds_read_b64_tr_b16 v[202:203], v212 offset:29184
  v_mfma_f32_32x32x16_bf16 v[80:95], v[192:195], a[244:247], v[80:95]
  ds_read_b64_tr_b16 v[204:205], v213 offset:28672
  ds_read_b64_tr_b16 v[206:207], v213 offset:29184
  s_add_u32 m0, s41, 0x10000
  s_add_u32 s44, s46, s59
  buffer_load_dwordx4 v214, s[28:31], s44 offen offset:0 lds
  s_waitcnt lgkmcnt(6)
  v_mfma_f32_32x32x16_bf16 v[96:111], v[196:199], a[240:243], v[96:111]
  v_mfma_f32_32x32x16_bf16 v[112:127], v[196:199], a[244:247], v[112:127]
  v_readlane_b32 s100, v255, 0
  v_readlane_b32 s101, v255, 1
  s_nop 0
  s_min_u32 s100, s100, s101
  v_readlane_b32 s101, v255, 2
  s_nop 0
  s_min_u32 s100, s100, s101
  s_cmp_lt_u32 s100, s76
  s_cbranch_scc1 gu_poll0
gu_poll0_d:
  s_waitcnt vmcnt(13) lgkmcnt(0)
  s_barrier
  v_mfma_f32_32x32x16_bf16 v[64:79], v[200:203], a[248:251], v[64:79]
  ds_read_b64_tr_b16 v[192:193], v208 offset:0
  ds_read_b64_tr_b16 v[194:195], v208 offset:512
  v_and_b32 v246, 0x1ff, v218
  v_lshrrev_b32 v246, 1, v246
  v_lshrrev_b32 v247, 9, v218
  v_mul_u32_u24 v247, 0x500, v247
  v_add_u32 v246, v246, v247
  buffer_load_dwordx2 v[226:227], v246, s[36:39], s56 offen offset:0 sc1
  v_mfma_f32_32x32x16_bf16 v[80:95], v[200:203], a[252:255], v[80:95]
  ds_read_b64_tr_b16 v[196:197], v209 offset:0
  ds_read_b64_tr_b16 v[198:199], v209 offset:512
  buffer_load_dwordx2 v[228:229], v246, s[36:39], s56 offen offset:256 sc1
  v_mfma_f32_32x32x16_bf16 v[96:111], v[204:207], a[248:251], v[96:111]
  buffer_load_dwordx2 v[230:231], v246, s[36:39], s56 offen offset:512 sc1
  v_mfma_f32_32x32x16_bf16 v[112:127], v[204:207], a[252:255], v[112:127]
  buffer_load_dwordx2 v[232:233], v246, s[36:39], s56 offen offset:768 sc1
  s_waitcnt lgkmcnt(2)
  v_mfma_f32_32x32x16_bf16 v[128:143], v[192:195], v[0:3], 0
  ds_read_b64_tr_b16 v[200:201], v208 offset:4096
  ds_read_b64_tr_b16 v[202:203], v208 offset:4608
  buffer_load_dwordx2 v[234:235], v246, s[36:39], s56 offen offset:1024 sc1
  v_mfma_f32_32x32x16_bf16 v[144:159], v[192:195], v[4:7], 0
  ds_read_b64_tr_b16 v[204:205], v209 offset:4096
  ds_read_b64_tr_b16 v[206:207], v209 offset:4608
  s_add_u32 s67, s55, 0
  buffer_load_dword v236, v219, s[36:39], s67 offen offset:0 sc1
  s_waitcnt lgkmcnt(4)
  v_mfma_f32_32x32x16_bf16 v[160:175], v[196:199], v[0:3], 0
  buffer_load_dword v237, v219, s[36:39], s67 offen offset:128 sc1
  v_mfma_f32_32x32x16_bf16 v[176:191], v[196:199], v[4:7], 0
  buffer_load_dword v238, v219, s[36:39], s67 offen offset:256 sc1
  s_waitcnt lgkmcnt(2)
  v_mfma_f32_32x32x16_bf16 v[128:143], v[200:203], v[8:11], v[128:143]
  ds_read_b64_tr_b16 v[192:193], v208 offset:8192
  ds_read_b64_tr_b16 v[194:195], v208 offset:8704
  buffer_load_dword v239, v219, s[36:39], s67 offen offset:384 sc1
  v_mfma_f32_32x32x16_bf16 v[144:159], v[200:203], v[12:15], v[144:159]
  ds_read_b64_tr_b16 v[196:197], v209 offset:8192
  ds_read_b64_tr_b16 v[198:199], v209 offset:8704
  buffer_load_dword v240, v219, s[36:39], s67 offen offset:512 sc1
  s_waitcnt lgkmcnt(4)
  v_mfma_f32_32x32x16_bf16 v[160:175], v[204:207], v[8:11], v[160:175]
  buffer_load_dword v241, v219, s[36:39], s67 offen offset:640 sc1
  v_mfma_f32_32x32x16_bf16 v[176:191], v[204:207], v[12:15], v[176:191]
  buffer_load_dword v242, v219, s[36:39], s67 offen offset:768 sc1
  s_waitcnt lgkmcnt(2)
  v_mfma_f32_32x32x16_bf16 v[128:143], v[192:195], v[16:19], v[128:143]
  ds_read_b64_tr_b16 v[200:201], v208 offset:12288
  ds_read_b64_tr_b16 v[202:203], v208 offset:12800
  buffer_load_dword v243, v219, s[36:39], s67 offen offset:896 sc1
  v_mfma_f32_32x32x16_bf16 v[144:159], v[192:195], v[20:23], v[144:159]
  ds_read_b64_tr_b16 v[204:205], v209 offset:12288
  ds_read_b64_tr_b16 v[206:207], v209 offset:12800
  buffer_load_dword v244, v219, s[36:39], s67 offen offset:1024 sc1
  s_waitcnt lgkmcnt(4)
  v_mfma_f32_32x32x16_bf16 v[160:175], v[196:199], v[16:19], v[160:175]
  buffer_load_dword v245, v219, s[36:39], s67 offen offset:1152 sc1
  v_mfma_f32_32x32x16_bf16 v[176:191], v[196:199], v[20:23], v[176:191]
  s_waitcnt vmcnt(24) lgkmcnt(0)
  s_barrier
  v_mfma_f32_32x32x16_bf16 v[128:143], v[200:203], v[24:27], v[128:143]
  ds_read_b64_tr_b16 v[192:193], v208 offset:16384
  ds_read_b64_tr_b16 v[194:195], v208 offset:16896
  buffer_load_dwordx4 v215, s[28:31], s44 offen offset:1024 lds
  s_add_u32 s59, s59, 0x36000
  v_mfma_f32_32x32x16_bf16 v[144:159], v[200:203], v[28:31], v[144:159]
  ds_read_b64_tr_b16 v[196:197], v209 offset:16384
  ds_read_b64_tr_b16 v[198:199], v209 offset:16896
  buffer_load_dwordx4 v216, s[32:35], s44 offen offset:2048 lds
  s_cmp_eq_u32 s59, 0x21c000
  s_cselect_b32 s59, 0, s59
  v_mfma_f32_32x32x16_bf16 v[160:175], v[204:207], v[24:27], v[160:175]
  buffer_load_dwordx4 v217, s[32:35], s44 offen offset:3072 lds
  v_mfma_f32_32x32x16_bf16 v[176:191], v[204:207], v[28:31], v[176:191]
  s_waitcnt lgkmcnt(2)
  v_mfma_f32_32x32x16_bf16 v[128:143], v[192:195], v[32:35], v[128:143]
  ds_read_b64_tr_b16 v[200:201], v208 offset:20480
  ds_read_b64_tr_b16 v[202:203], v208 offset:20992
  s_add_u32 m0, s41, 0x14000
  s_add_u32 s44, s46, s59
  buffer_load_dwordx4 v214, s[28:31], s44 offen offset:0 lds
  v_mfma_f32_32x32x16_bf16 v[144:159], v[192:195], v[36:39], v[144:159]
  ds_read_b64_tr_b16 v[204:205], v209 offset:20480
  ds_read_b64_tr_b16 v[206:207], v209 offset:20992
  s_waitcnt lgkmcnt(4)
  v_mfma_f32_32x32x16_bf16 v[160:175], v[196:199], v[32:35], v[160:175]
  buffer_load_dwordx4 v215, s[28:31], s44 offen offset:1024 lds
  s_add_u32 s59, s59, 0x36000
  v_mfma_f32_32x32x16_bf16 v[176:191], v[196:199], v[36:39], v[176:191]
  s_waitcnt lgkmcnt(2)
  v_mfma_f32_32x32x16_bf16 v[128:143], v[200:203], v[40:43], v[128:143]
  ds_read_b64_tr_b16 v[192:193], v208 offset:24576
  ds_read_b64_tr_b16 v[194:195], v208 offset:25088
  buffer_load_dwordx4 v216, s[32:35], s44 offen offset:2048 lds
  s_cmp_eq_u32 s59, 0x21c000
  s_cselect_b32 s59, 0, s59
  v_mfma_f32_32x32x16_bf16 v[144:159], v[200:203], v[44:47], v[144:159]
  ds_read_b64_tr_b16 v[196:197], v209 offset:24576
  ds_read_b64_tr_b16 v[198:199], v209 offset:25088
  s_waitcnt lgkmcnt(4)
  v_mfma_f32_32x32x16_bf16 v[160:175], v[204:207], v[40:43], v[160:175]
  buffer_load_dwordx4 v217, s[32:35], s44 offen offset:3072 lds
  v_mfma_f32_32x32x16_bf16 v[176:191], v[204:207], v[44:47], v[176:191]
  s_waitcnt lgkmcnt(2)
  v_mfma_f32_32x32x16_bf16 v[128:143], v[192:195], v[48:51], v[128:143]
  ds_read_b64_tr_b16 v[200:201], v208 offset:28672
  ds_read_b64_tr_b16 v[202:203], v208 offset:29184
  s_add_u32 m0, s41, 0x18000
  s_add_u32 s44, s46, s59
  buffer_load_dwordx4 v214, s[28:31], s44 offen offset:0 lds
  v_mfma_f32_32x32x16_bf16 v[144:159], v[192:195], v[52:55], v[144:159]
  ds_read_b64_tr_b16 v[204:205], v209 offset:28672
  ds_read_b64_tr_b16 v[206:207], v209 offset:29184
  s_waitcnt lgkmcnt(4)
  v_mfma_f32_32x32x16_bf16 v[160:175], v[196:199], v[48:51], v[160:175]
  buffer_load_dwordx4 v215, s[28:31], s44 offen offset:1024 lds
  s_add_u32 s59, s59, 0x36000
  v_mfma_f32_32x32x16_bf16 v[176:191], v[196:199], v[52:55], v[176:191]
  s_waitcnt vmcnt(29) lgkmcnt(0)
  s_barrier
  v_mfma_f32_32x32x16_bf16 v[128:143], v[200:203], v[56:59], v[128:143]
  ds_read_b64_tr_b16 v[192:193], v208 offset:32768
  ds_read_b64_tr_b16 v[194:195], v208 offset:33280
  buffer_load_dwordx4 v216, s[32:35], s44 offen offset:2048 lds
  s_cmp_eq_u32 s59, 0x21c000
  s_cselect_b32 s59, 0, s59
  v_mfma_f32_32x32x16_bf16 v[144:159], v[200:203], v[60:63], v[144:159]
  ds_read_b64_tr_b16 v[196:197], v209 offset:32768
  ds_read_b64_tr_b16 v[198:199], v209 offset:33280
  s_waitcnt vmcnt(23)
  v_add_f32 v226, v226, v228
  v_add_f32 v227, v227, v229
  s_waitcnt vmcnt(21)
  v_add_f32 v230, v230, v232
  v_mfma_f32_32x32x16_bf16 v[160:175], v[204:207], v[56:59], v[160:175]
  buffer_load_dwordx4 v217, s[32:35], s44 offen offset:3072 lds
  v_add_f32 v231, v231, v233
  s_waitcnt vmcnt(21)
  v_add_f32 v226, v226, v234
  v_add_f32 v227, v227, v235
  v_add_f32 v226, v226, v230
  v_mfma_f32_32x32x16_bf16 v[176:191], v[204:207], v[60:63], v[176:191]
  v_add_f32 v227, v227, v231
  v_mul_f32 v226, 0xbacccccd, v226
  v_mul_f32 v227, 0x3acccccd, v227
  v_fma_f32 v227, -v226, v226, v227
  v_and_b32 v246, 0xffff0000, v226
  s_waitcnt lgkmcnt(2)
  v_mfma_f32_32x32x16_bf16 v[128:143], v[192:195], a[0:3], v[128:143]
  ds_read_b64_tr_b16 v[200:201], v208 offset:36864
  ds_read_b64_tr_b16 v[202:203], v208 offset:37376
  s_add_u32 m0, s41, 0x1c000
  s_add_u32 s44, s46, s59
  buffer_load_dwordx4 v214, s[28:31], s44 offen offset:0 lds
  v_mfma_f32_32x32x16_bf16 v[144:159], v[192:195], a[4:7], v[144:159]
  ds_read_b64_tr_b16 v[204:205], v209 offset:36864
  ds_read_b64_tr_b16 v[206:207], v209 offset:37376
  v_max_f32 v227, 0, v227
  v_sub_f32 v247, v226, v246
  v_add_f32 v227, 0x3727c5ac, v227
  s_waitcnt lgkmcnt(4)
  v_mfma_f32_32x32x16_bf16 v[160:175], v[196:199], a[0:3], v[160:175]
  buffer_load_dwordx4 v215, s[28:31], s44 offen offset:1024 lds
  s_add_u32 s59, s59, 0x36000
  v_cvt_pk_bf16_f32 v246, v246, v246
  v_rsq_f32 v227, v227
  v_mfma_f32_32x32x16_bf16 v[176:191], v[196:199], a[4:7], v[176:191]
  v_cvt_pk_bf16_f32 v247, v247, 0
  v_mov_b32 v228, v246
  v_mov_b32 v230, 0
  v_mov_b32 v232, 0
  v_mov_b32 v234, v246
  s_waitcnt lgkmcnt(2)
  v_mfma_f32_32x32x16_bf16 v[128:143], v[200:203], a[8:11], v[128:143]
  ds_read_b64_tr_b16 v[192:193], v208 offset:40960
  ds_read_b64_tr_b16 v[194:195], v208 offset:41472
  buffer_load_dwordx4 v216, s[32:35], s44 offen offset:2048 lds
  s_cmp_eq_u32 s59, 0x21c000
  s_cselect_b32 s59, 0, s59
  v_mfma_f32_32x32x16_bf16 v[144:159], v[200:203], a[12:15], v[144:159]
  ds_read_b64_tr_b16 v[196:197], v209 offset:40960
  ds_read_b64_tr_b16 v[198:199], v209 offset:41472
  v_mov_b32 v229, v247
  v_mov_b32 v231, 0
  v_mov_b32 v233, 0
  s_waitcnt lgkmcnt(4)
  v_mfma_f32_32x32x16_bf16 v[160:175], v[204:207], a[8:11], v[160:175]
  buffer_load_dwordx4 v217, s[32:35], s44 offen offset:3072 lds
  v_mov_b32 v235, v247
  v_mul_f32 v222, v227, v227
  v_mul_f32 v221, 0xbdd2d3e8, v227
  v_mul_f32 v220, 0xc0135761, v227
  v_mfma_f32_32x32x16_bf16 v[176:191], v[204:207], a[12:15], v[176:191]
  v_mul_f32 v221, v221, v222
  v_rcp_f32 v222, v222
  v_permlane32_swap_b32 v228, v230
  v_permlane32_swap_b32 v232, v234
  s_waitcnt lgkmcnt(2)
  v_mfma_f32_32x32x16_bf16 v[128:143], v[192:195], a[16:19], v[128:143]
  ds_read_b64_tr_b16 v[200:201], v208 offset:45056
  ds_read_b64_tr_b16 v[202:203], v208 offset:45568
  s_add_u32 m0, s41, 0x20000
  s_add_u32 s44, s46, s59
  buffer_load_dwordx4 v214, s[28:31], s44 offen offset:0 lds
  v_mfma_f32_32x32x16_bf16 v[144:159], v[192:195], a[20:23], v[144:159]
  ds_read_b64_tr_b16 v[204:205], v209 offset:45056
  ds_read_b64_tr_b16 v[206:207], v209 offset:45568
  v_permlane32_swap_b32 v229, v231
  v_permlane32_swap_b32 v233, v235
  v_mov_b32 v223, v220
  s_waitcnt lgkmcnt(4)
  v_mfma_f32_32x32x16_bf16 v[160:175], v[196:199], a[16:19], v[160:175]
  buffer_load_dwordx4 v215, s[28:31], s44 offen offset:1024 lds
  s_add_u32 s59, s59, 0x36000
  v_mov_b32 v224, v221
  v_mov_b32 v225, v222
  s_nop 0
  v_mfma_f32_32x32x16_bf16 v[176:191], v[196:199], a[20:23], v[176:191]
  s_waitcnt lgkmcnt(0)
  s_barrier
  v_mfma_f32_32x32x16_bf16 v[128:143], v[200:203], a[24:27], v[128:143]
  ds_read_b64_tr_b16 v[192:193], v208 offset:49152
  ds_read_b64_tr_b16 v[194:195], v208 offset:49664
  buffer_load_dwordx4 v216, s[32:35], s44 offen offset:2048 lds
  s_cmp_eq_u32 s59, 0x21c000
  s_cselect_b32 s59, 0, s59
  v_mfma_f32_32x32x16_bf16 v[144:159], v[200:203], a[28:31], v[144:159]
  ds_read_b64_tr_b16 v[196:197], v209 offset:49152
  ds_read_b64_tr_b16 v[198:199], v209 offset:49664
  v_permlane32_swap_b32 v220, v223
  v_permlane32_swap_b32 v221, v224
  v_permlane32_swap_b32 v222, v225
  v_mfma_f32_32x32x16_bf16 v[160:175], v[204:207], a[24:27], v[160:175]
  buffer_load_dwordx4 v217, s[32:35], s44 offen offset:3072 lds
  s_waitcnt vmcnt(27)
  v_add_f32 v236, v236, v237
  s_waitcnt vmcnt(25)
  v_add_f32 v238, v238, v239
  s_waitcnt vmcnt(23)
  v_add_f32 v240, v240, v241
  s_waitcnt vmcnt(21)
  v_add_f32 v242, v242, v243
  v_mfma_f32_32x32x16_bf16 v[176:191], v[204:207], a[28:31], v[176:191]
  s_waitcnt vmcnt(19)
  v_add_f32 v244, v244, v245
  v_add_f32 v236, v236, v238
  v_add_f32 v240, v240, v242
  v_add_f32 v236, v236, v244
  v_add_f32 v236, v236, v240
  s_waitcnt lgkmcnt(2)
  v_mfma_f32_32x32x16_bf16 v[128:143], v[192:195], a[32:35], v[128:143]
  ds_read_b64_tr_b16 v[200:201], v208 offset:53248
  ds_read_b64_tr_b16 v[202:203], v208 offset:53760
  s_add_u32 m0, s41, 0x24000
  s_add_u32 s44, s46, s59
  buffer_load_dwordx4 v214, s[28:31], s44 offen offset:0 lds
  v_mfma_f32_32x32x16_bf16 v[144:159], v[192:195], a[36:39], v[144:159]
  ds_read_b64_tr_b16 v[204:205], v209 offset:53248
  ds_read_b64_tr_b16 v[206:207], v209 offset:53760
  v_and_b32 v237, 0xffff0000, v236
  v_sub_f32 v236, v236, v237
  v_cvt_pk_bf16_f32 v226, v237, v236
  s_waitcnt lgkmcnt(4)
  v_mfma_f32_32x32x16_bf16 v[160:175], v[196:199], a[32:35], v[160:175]
  buffer_load_dwordx4 v215, s[28:31], s44 offen offset:1024 lds
  s_add_u32 s59, s59, 0x36000
  v_cvt_pk_bf16_f32 v227, v237, 0
  v_mfma_f32_32x32x16_bf16 v[176:191], v[196:199], a[36:39], v[176:191]
  s_nop 0
  v_mfma_f32_32x32x8_bf16 v[64:79], v[226:227], v[228:229], v[64:79]
  s_waitcnt lgkmcnt(2)
  v_mfma_f32_32x32x16_bf16 v[128:143], v[200:203], a[40:43], v[128:143]
  ds_read_b64_tr_b16 v[192:193], v208 offset:57344
  ds_read_b64_tr_b16 v[194:195], v208 offset:57856
  buffer_load_dwordx4 v216, s[32:35], s44 offen offset:2048 lds
  s_cmp_eq_u32 s59, 0x21c000
  s_cselect_b32 s59, 0, s59
  v_mfma_f32_32x32x16_bf16 v[144:159], v[200:203], a[44:47], v[144:159]
  ds_read_b64_tr_b16 v[196:197], v209 offset:57344
  ds_read_b64_tr_b16 v[198:199], v209 offset:57856
  v_mfma_f32_32x32x8_bf16 v[80:95], v[226:227], v[230:231], v[80:95]
  s_waitcnt lgkmcnt(4)
  v_mfma_f32_32x32x16_bf16 v[160:175], v[204:207], a[40:43], v[160:175]
  buffer_load_dwordx4 v217, s[32:35], s44 offen offset:3072 lds
  v_mfma_f32_32x32x8_bf16 v[96:111], v[226:227], v[232:233], v[96:111]
  v_mfma_f32_32x32x16_bf16 v[176:191], v[204:207], a[44:47], v[176:191]
  v_mfma_f32_32x32x8_bf16 v[112:127], v[226:227], v[234:235], v[112:127]
  v_mul_f32 v246, v64, v64
  v_mul_f32 v247, v65, v65
  s_waitcnt lgkmcnt(2)
  v_mfma_f32_32x32x16_bf16 v[128:143], v[192:195], a[48:51], v[128:143]
  ds_read_b64_tr_b16 v[200:201], v208 offset:61440
  ds_read_b64_tr_b16 v[202:203], v208 offset:61952
  s_add_u32 m0, s41, 0
  s_add_u32 s44, s47, s59
  buffer_load_dwordx4 v214, s[28:31], s44 offen offset:0 lds
  v_mfma_f32_32x32x16_bf16 v[144:159], v[192:195], a[52:55], v[144:159]
  ds_read_b64_tr_b16 v[204:205], v209 offset:61440
  ds_read_b64_tr_b16 v[206:207], v209 offset:61952
  v_mul_f32 v248, v66, v66
  v_mul_f32 v249, v67, v67
  v_fma_f32 v246, v246, v221, v220
  s_waitcnt lgkmcnt(4)
  v_mfma_f32_32x32x16_bf16 v[160:175], v[196:199], a[48:51], v[160:175]
  buffer_load_dwordx4 v215, s[28:31], s44 offen offset:1024 lds
  s_add_u32 s59, s59, 0x36000
  v_fma_f32 v247, v247, v221, v220
  v_fma_f32 v248, v248, v221, v220
  v_fma_f32 v249, v249, v221, v220
  v_mfma_f32_32x32x16_bf16 v[176:191], v[196:199], a[52:55], v[176:191]
  s_waitcnt vmcnt(22) lgkmcnt(0)
  s_barrier
  v_mfma_f32_32x32x16_bf16 v[128:143], v[200:203], a[56:59], v[128:143]
  ds_read_b64_tr_b16 v[192:193], v210 offset:0
  ds_read_b64_tr_b16 v[194:195], v210 offset:512
  buffer_load_dwordx4 v216, s[32:35], s44 offen offset:2048 lds
  s_cmp_eq_u32 s59, 0x21c000
  s_cselect_b32 s59, 0, s59
  v_mfma_f32_32x32x16_bf16 v[144:159], v[200:203], a[60:63], v[144:159]
  ds_read_b64_tr_b16 v[196:197], v211 offset:0
  ds_read_b64_tr_b16 v[198:199], v211 offset:512
  v_mul_f32 v246, v246, v64
  v_mul_f32 v247, v247, v65
  v_mul_f32 v248, v248, v66
  v_mfma_f32_32x32x16_bf16 v[160:175], v[204:207], a[56:59], v[160:175]
  buffer_load_dwordx4 v217, s[32:35], s44 offen offset:3072 lds
  v_mul_f32 v249, v249, v67
  v_exp_f32 v246, v246
  v_mul_f32 v64, v64, v72
  v_mfma_f32_32x32x16_bf16 v[176:191], v[204:207], a[60:63], v[176:191]
  v_exp_f32 v247, v247
  v_mul_f32 v65, v65, v73
  v_exp_f32 v248, v248
  s_waitcnt lgkmcnt(2)
  v_mfma_f32_32x32x16_bf16 v[128:143], v[192:195], a[64:67], v[128:143]
  ds_read_b64_tr_b16 v[200:201], v210 offset:4096
  ds_read_b64_tr_b16 v[202:203], v210 offset:4608
  s_add_u32 m0, s41, 0x4000
  s_add_u32 s44, s47, s59
  buffer_load_dwordx4 v214, s[28:31], s44 offen offset:0 lds
  v_mfma_f32_32x32x16_bf16 v[144:159], v[192:195], a[68:71], v[144:159]
  ds_read_b64_tr_b16 v[204:205], v211 offset:4096
  ds_read_b64_tr_b16 v[206:207], v211 offset:4608
  v_mul_f32 v66, v66, v74
  v_exp_f32 v249, v249
  s_waitcnt lgkmcnt(4)
  v_mfma_f32_32x32x16_bf16 v[160:175], v[196:199], a[64:67], v[160:175]
  buffer_load_dwordx4 v215, s[28:31], s44 offen offset:1024 lds
  s_add_u32 s59, s59, 0x36000
  v_mul_f32 v67, v67, v75
  v_fma_f32 v246, v246, v222, v222
  v_fma_f32 v247, v247, v222, v222
  v_mfma_f32_32x32x16_bf16 v[176:191], v[196:199], a[68:71], v[176:191]
  v_fma_f32 v248, v248, v222, v222
  v_fma_f32 v249, v249, v222, v222
  v_rcp_f32 v246, v246
  s_waitcnt lgkmcnt(2)
  v_mfma_f32_32x32x16_bf16 v[128:143], v[200:203], a[72:75], v[128:143]
  ds_read_b64_tr_b16 v[192:193], v210 offset:8192
  ds_read_b64_tr_b16 v[194:195], v210 offset:8704
  buffer_load_dwordx4 v216, s[32:35], s44 offen offset:2048 lds
  s_cmp_eq_u32 s59, 0x21c000
  s_cselect_b32 s59, 0, s59
  v_mfma_f32_32x32x16_bf16 v[144:159], v[200:203], a[76:79], v[144:159]
  ds_read_b64_tr_b16 v[196:197], v211 offset:8192
  ds_read_b64_tr_b16 v[198:199], v211 offset:8704
  v_rcp_f32 v247, v247
  s_waitcnt lgkmcnt(4)
  v_mfma_f32_32x32x16_bf16 v[160:175], v[204:207], a[72:75], v[160:175]
  buffer_load_dwordx4 v217, s[32:35], s44 offen offset:3072 lds
  v_rcp_f32 v248, v248
  v_rcp_f32 v249, v249
  v_mfma_f32_32x32x16_bf16 v[176:191], v[204:207], a[76:79], v[176:191]
  v_mul_f32 v64, v64, v246
  v_mul_f32 v65, v65, v247
  v_mul_f32 v66, v66, v248
  v_mul_f32 v67, v67, v249
  v_cvt_pk_bf16_f32 v72, v64, v65
  s_waitcnt lgkmcnt(2)
  v_mfma_f32_32x32x16_bf16 v[128:143], v[192:195], a[80:83], v[128:143]
  ds_read_b64_tr_b16 v[200:201], v210 offset:12288
  ds_read_b64_tr_b16 v[202:203], v210 offset:12800
  v_cvt_pk_bf16_f32 v73, v66, v67
  v_mul_f32 v246, v68, v68
  v_mul_f32 v247, v69, v69
  v_mfma_f32_32x32x16_bf16 v[144:159], v[192:195], a[84:87], v[144:159]
  ds_read_b64_tr_b16 v[204:205], v211 offset:12288
  ds_read_b64_tr_b16 v[206:207], v211 offset:12800
  v_mul_f32 v248, v70, v70
  v_mul_f32 v249, v71, v71
  v_fma_f32 v246, v246, v221, v220
  s_waitcnt lgkmcnt(4)
  v_mfma_f32_32x32x16_bf16 v[160:175], v[196:199], a[80:83], v[160:175]
  v_fma_f32 v247, v247, v221, v220
  v_fma_f32 v248, v248, v221, v220
  v_fma_f32 v249, v249, v221, v220
  v_mul_f32 v246, v246, v68
  v_mul_f32 v247, v247, v69
  v_mfma_f32_32x32x16_bf16 v[176:191], v[196:199], a[84:87], v[176:191]
  s_waitcnt vmcnt(24) lgkmcnt(0)
  s_barrier
  v_mfma_f32_32x32x16_bf16 v[128:143], v[200:203], a[88:91], v[128:143]
  ds_read_b64_tr_b16 v[192:193], v210 offset:16384
  ds_read_b64_tr_b16 v[194:195], v210 offset:16896
  v_mul_f32 v248, v248, v70
  v_mul_f32 v249, v249, v71
  v_mfma_f32_32x32x16_bf16 v[144:159], v[200:203], a[92:95], v[144:159]
  ds_read_b64_tr_b16 v[196:197], v211 offset:16384
  ds_read_b64_tr_b16 v[198:199], v211 offset:16896
  v_exp_f32 v246, v246
  v_mul_f32 v68, v68, v76
  v_mfma_f32_32x32x16_bf16 v[160:175], v[204:207], a[88:91], v[160:175]
  v_exp_f32 v247, v247
  v_mul_f32 v69, v69, v77
  v_exp_f32 v248, v248
  v_mfma_f32_32x32x16_bf16 v[176:191], v[204:207], a[92:95], v[176:191]
  v_mul_f32 v70, v70, v78
  v_exp_f32 v249, v249
  v_mul_f32 v71, v71, v79
  v_fma_f32 v246, v246, v222, v222
  s_waitcnt lgkmcnt(2)
  v_mfma_f32_32x32x16_bf16 v[128:143], v[192:195], a[96:99], v[128:143]
  ds_read_b64_tr_b16 v[200:201], v210 offset:20480
  ds_read_b64_tr_b16 v[202:203], v210 offset:20992
  v_fma_f32 v247, v247, v222, v222
  v_fma_f32 v248, v248, v222, v222
  v_fma_f32 v249, v249, v222, v222
  v_mfma_f32_32x32x16_bf16 v[144:159], v[192:195], a[100:103], v[144:159]
  ds_read_b64_tr_b16 v[204:205], v211 offset:20480
  ds_read_b64_tr_b16 v[206:207], v211 offset:20992
  v_rcp_f32 v246, v246
  s_waitcnt lgkmcnt(4)
  v_mfma_f32_32x32x16_bf16 v[160:175], v[196:199], a[96:99], v[160:175]
  v_rcp_f32 v247, v247
  v_rcp_f32 v248, v248
  v_mfma_f32_32x32x16_bf16 v[176:191], v[196:199], a[100:103], v[176:191]
  v_rcp_f32 v249, v249
  v_mul_f32 v68, v68, v246
  v_mul_f32 v69, v69, v247
  v_mul_f32 v70, v70, v248
  s_waitcnt lgkmcnt(2)
  v_mfma_f32_32x32x16_bf16 v[128:143], v[200:203], a[104:107], v[128:143]
  ds_read_b64_tr_b16 v[192:193], v210 offset:24576
  ds_read_b64_tr_b16 v[194:195], v210 offset:25088
  v_mul_f32 v71, v71, v249
  v_cvt_pk_bf16_f32 v74, v68, v69
  v_cvt_pk_bf16_f32 v75, v70, v71
  v_mfma_f32_32x32x16_bf16 v[144:159], v[200:203], a[108:111], v[144:159]
  ds_read_b64_tr_b16 v[196:197], v211 offset:24576
  ds_read_b64_tr_b16 v[198:199], v211 offset:25088
  s_add_u32 s60, s48, 0
  buffer_store_dwordx4 v[72:75], v218, s[36:39], s60 offen sc1
  v_mul_f32 v246, v80, v80
  s_waitcnt lgkmcnt(4)
  v_mfma_f32_32x32x16_bf16 v[160:175], v[204:207], a[104:107], v[160:175]
  v_mul_f32 v247, v81, v81
  v_mul_f32 v248, v82, v82
  v_mul_f32 v249, v83, v83
  v_fma_f32 v246, v246, v224, v223
  v_fma_f32 v247, v247, v224, v223
  v_mfma_f32_32x32x16_bf16 v[176:191], v[204:207], a[108:111], v[176:191]
  v_fma_f32 v248, v248, v224, v223
  v_fma_f32 v249, v249, v224, v223
  v_mul_f32 v246, v246, v80
  v_mul_f32 v247, v247, v81
  v_mul_f32 v248, v248, v82
  s_waitcnt lgkmcnt(2)
  v_mfma_f32_32x32x16_bf16 v[128:143], v[192:195], a[112:115], v[128:143]
  ds_read_b64_tr_b16 v[200:201], v210 offset:28672
  ds_read_b64_tr_b16 v[202:203], v210 offset:29184
  v_mul_f32 v249, v249, v83
  v_exp_f32 v246, v246
  v_mfma_f32_32x32x16_bf16 v[144:159], v[192:195], a[116:119], v[144:159]
  ds_read_b64_tr_b16 v[204:205], v211 offset:28672
  ds_read_b64_tr_b16 v[206:207], v211 offset:29184
  v_mul_f32 v80, v80, v88
  v_exp_f32 v247, v247
  s_waitcnt lgkmcnt(4)
  v_mfma_f32_32x32x16_bf16 v[160:175], v[196:199], a[112:115], v[160:175]
  v_mul_f32 v81, v81, v89
  v_exp_f32 v248, v248
  v_mul_f32 v82, v82, v90
  v_mfma_f32_32x32x16_bf16 v[176:191], v[196:199], a[116:119], v[176:191]
  s_waitcnt vmcnt(21) lgkmcnt(0)
  s_barrier
  v_mfma_f32_32x32x16_bf16 v[128:143], v[200:203], a[120:123], v[128:143]
  ds_read_b64_tr_b16 v[192:193], v210 offset:32768
  ds_read_b64_tr_b16 v[194:195], v210 offset:33280
  s_add_u32 m0, s41, 0x8000
  s_add_u32 s44, s47, s59
  buffer_load_dwordx4 v214, s[28:31], s44 offen offset:0 lds
  v_mfma_f32_32x32x16_bf16 v[144:159], v[200:203], a[124:127], v[144:159]
  ds_read_b64_tr_b16 v[196:197], v211 offset:32768
  ds_read_b64_tr_b16 v[198:199], v211 offset:33280
  buffer_load_dwordx4 v215, s[28:31], s44 offen offset:1024 lds
  s_add_u32 s59, s59, 0x36000
  v_mfma_f32_32x32x16_bf16 v[160:175], v[204:207], a[120:123], v[160:175]
  buffer_load_dwordx4 v216, s[32:35], s44 offen offset:2048 lds
  s_cmp_eq_u32 s59, 0x21c000
  s_cselect_b32 s59, 0, s59
  v_exp_f32 v249, v249
  v_mfma_f32_32x32x16_bf16 v[176:191], v[204:207], a[124:127], v[176:191]
  v_mul_f32 v83, v83, v91
  v_fma_f32 v246, v246, v225, v225
  v_fma_f32 v247, v247, v225, v225
  v_fma_f32 v248, v248, v225, v225
  v_fma_f32 v249, v249, v225, v225
  s_waitcnt lgkmcnt(2)
  v_mfma_f32_32x32x16_bf16 v[128:143], v[192:195], a[128:131], v[128:143]
  ds_read_b64_tr_b16 v[200:201], v210 offset:36864
  ds_read_b64_tr_b16 v[202:203], v210 offset:37376
  buffer_load_dwordx4 v217, s[32:35], s44 offen offset:3072 lds
  v_rcp_f32 v246, v246
  v_mfma_f32_32x32x16_bf16 v[144:159], v[192:195], a[132:135], v[144:159]
  ds_read_b64_tr_b16 v[204:205], v211 offset:36864
  ds_read_b64_tr_b16 v[206:207], v211 offset:37376
  v_rcp_f32 v247, v247
  s_waitcnt lgkmcnt(4)
  v_mfma_f32_32x32x16_bf16 v[160:175], v[196:199], a[128:131], v[160:175]
  s_add_u32 m0, s41, 0xc000
  s_add_u32 s44, s47, s59
  buffer_load_dwordx4 v214, s[28:31], s44 offen offset:0 lds
  v_rcp_f32 v248, v248
  v_mfma_f32_32x32x16_bf16 v[176:191], v[196:199], a[132:135], v[176:191]
  v_rcp_f32 v249, v249
  v_mul_f32 v80, v80, v246
  v_mul_f32 v81, v81, v247
  v_mul_f32 v82, v82, v248
  s_waitcnt lgkmcnt(2)
  v_mfma_f32_32x32x16_bf16 v[128:143], v[200:203], a[136:139], v[128:143]
  ds_read_b64_tr_b16 v[192:193], v210 offset:40960
  ds_read_b64_tr_b16 v[194:195], v210 offset:41472
  buffer_load_dwordx4 v215, s[28:31], s44 offen offset:1024 lds
  s_add_u32 s59, s59, 0x36000
  v_mul_f32 v83, v83, v249
  v_mfma_f32_32x32x16_bf16 v[144:159], v[200:203], a[140:143], v[144:159]
  ds_read_b64_tr_b16 v[196:197], v211 offset:40960
  ds_read_b64_tr_b16 v[198:199], v211 offset:41472
  v_cvt_pk_bf16_f32 v88, v80, v81
  v_cvt_pk_bf16_f32 v89, v82, v83
  v_mul_f32 v246, v84, v84
  s_waitcnt lgkmcnt(4)
  v_mfma_f32_32x32x16_bf16 v[160:175], v[204:207], a[136:139], v[160:175]
  buffer_load_dwordx4 v216, s[32:35], s44 offen offset:2048 lds
  s_cmp_eq_u32 s59, 0x21c000
  s_cselect_b32 s59, 0, s59
  v_mul_f32 v247, v85, v85
  v_mul_f32 v248, v86, v86
  v_mfma_f32_32x32x16_bf16 v[176:191], v[204:207], a[140:143], v[176:191]
  v_mul_f32 v249, v87, v87
  v_fma_f32 v246, v246, v224, v223
  v_fma_f32 v247, v247, v224, v223
  v_fma_f32 v248, v248, v224, v223
  v_fma_f32 v249, v249, v224, v223
  s_waitcnt lgkmcnt(2)
  v_mfma_f32_32x32x16_bf16 v[128:143], v[192:195], a[144:147], v[128:143]
  ds_read_b64_tr_b16 v[200:201], v210 offset:45056
  ds_read_b64_tr_b16 v[202:203], v210 offset:45568
  buffer_load_dwordx4 v217, s[32:35], s44 offen offset:3072 lds
  v_mul_f32 v246, v246, v84
  v_mul_f32 v247, v247, v85
  v_mfma_f32_32x32x16_bf16 v[144:159], v[192:195], a[148:151], v[144:159]
  ds_read_b64_tr_b16 v[204:205], v211 offset:45056
  ds_read_b64_tr_b16 v[206:207], v211 offset:45568
  v_mul_f32 v248, v248, v86
  v_mul_f32 v249, v249, v87
  s_waitcnt lgkmcnt(4)
  v_mfma_f32_32x32x16_bf16 v[160:175], v[196:199], a[144:147], v[160:175]
  v_exp_f32 v246, v246
  v_mul_f32 v84, v84, v92
  v_exp_f32 v247, v247
  v_mfma_f32_32x32x16_bf16 v[176:191], v[196:199], a[148:151], v[176:191]
  s_waitcnt vmcnt(25) lgkmcnt(0)
  s_barrier
  v_mfma_f32_32x32x16_bf16 v[128:143], v[200:203], a[152:155], v[128:143]
  ds_read_b64_tr_b16 v[192:193], v210 offset:49152
  ds_read_b64_tr_b16 v[194:195], v210 offset:49664
  s_add_u32 m0, s41, 0x10000
  s_add_u32 s44, s47, s59
  buffer_load_dwordx4 v214, s[28:31], s44 offen offset:0 lds
  v_mfma_f32_32x32x16_bf16 v[144:159], v[200:203], a[156:159], v[144:159]
  ds_read_b64_tr_b16 v[196:197], v211 offset:49152
  ds_read_b64_tr_b16 v[198:199], v211 offset:49664
  buffer_load_dwordx4 v215, s[28:31], s44 offen offset:1024 lds
  s_add_u32 s59, s59, 0x36000
  v_mul_f32 v85, v85, v93
  v_mfma_f32_32x32x16_bf16 v[160:175], v[204:207], a[152:155], v[160:175]
  buffer_load_dwordx4 v216, s[32:35], s44 offen offset:2048 lds
  s_cmp_eq_u32 s59, 0x21c000
  s_cselect_b32 s59, 0, s59
  v_exp_f32 v248, v248
  v_mfma_f32_32x32x16_bf16 v[176:191], v[204:207], a[156:159], v[176:191]
  v_mul_f32 v86, v86, v94
  v_exp_f32 v249, v249
  v_mul_f32 v87, v87, v95
  v_fma_f32 v246, v246, v225, v225
  s_waitcnt lgkmcnt(2)
  v_mfma_f32_32x32x16_bf16 v[128:143], v[192:195], a[160:163], v[128:143]
  ds_read_b64_tr_b16 v[200:201], v210 offset:53248
  ds_read_b64_tr_b16 v[202:203], v210 offset:53760
  buffer_load_dwordx4 v217, s[32:35], s44 offen offset:3072 lds
  v_fma_f32 v247, v247, v225, v225
  v_fma_f32 v248, v248, v225, v225
  v_mfma_f32_32x32x16_bf16 v[144:159], v[192:195], a[164:167], v[144:159]
  ds_read_b64_tr_b16 v[204:205], v211 offset:53248
  ds_read_b64_tr_b16 v[206:207], v211 offset:53760
  v_fma_f32 v249, v249, v225, v225
  v_rcp_f32 v246, v246
  s_waitcnt lgkmcnt(4)
  v_mfma_f32_32x32x16_bf16 v[160:175], v[196:199], a[160:163], v[160:175]
  s_add_u32 m0, s41, 0x14000
  s_add_u32 s44, s47, s59
  buffer_load_dwordx4 v214, s[28:31], s44 offen offset:0 lds
  v_rcp_f32 v247, v247
  v_mfma_f32_32x32x16_bf16 v[176:191], v[196:199], a[164:167], v[176:191]
  v_rcp_f32 v248, v248
  v_rcp_f32 v249, v249
  v_mul_f32 v84, v84, v246
  s_waitcnt lgkmcnt(2)
  v_mfma_f32_32x32x16_bf16 v[128:143], v[200:203], a[168:171], v[128:143]
  ds_read_b64_tr_b16 v[192:193], v210 offset:57344
  ds_read_b64_tr_b16 v[194:195], v210 offset:57856
  buffer_load_dwordx4 v215, s[28:31], s44 offen offset:1024 lds
  s_add_u32 s59, s59, 0x36000
  v_mul_f32 v85, v85, v247
  v_mfma_f32_32x32x16_bf16 v[144:159], v[200:203], a[172:175], v[144:159]
  ds_read_b64_tr_b16 v[196:197], v211 offset:57344
  ds_read_b64_tr_b16 v[198:199], v211 offset:57856
  v_mul_f32 v86, v86, v248
  v_mul_f32 v87, v87, v249
  v_cvt_pk_bf16_f32 v90, v84, v85
  s_waitcnt lgkmcnt(4)
  v_mfma_f32_32x32x16_bf16 v[160:175], v[204:207], a[168:171], v[160:175]
  buffer_load_dwordx4 v216, s[32:35], s44 offen offset:2048 lds
  s_cmp_eq_u32 s59, 0x21c000
  s_cselect_b32 s59, 0, s59
  v_cvt_pk_bf16_f32 v91, v86, v87
  s_add_u32 s61, s48, 0x1b000
  v_mfma_f32_32x32x16_bf16 v[176:191], v[204:207], a[172:175], v[176:191]
  buffer_store_dwordx4 v[88:91], v218, s[36:39], s61 offen sc1
  v_mul_f32 v246, v96, v96
  v_mul_f32 v247, v97, v97
  v_mul_f32 v248, v98, v98
  v_mul_f32 v249, v99, v99
  s_waitcnt lgkmcnt(2)
  v_mfma_f32_32x32x16_bf16 v[128:143], v[192:195], a[176:179], v[128:143]
  ds_read_b64_tr_b16 v[200:201], v210 offset:61440
  ds_read_b64_tr_b16 v[202:203], v210 offset:61952
  buffer_load_dwordx4 v217, s[32:35], s44 offen offset:3072 lds
  v_fma_f32 v246, v246, v221, v220
  v_fma_f32 v247, v247, v221, v220
  v_mfma_f32_32x32x16_bf16 v[144:159], v[192:195], a[180:183], v[144:159]
  ds_read_b64_tr_b16 v[204:205], v211 offset:61440
  ds_read_b64_tr_b16 v[206:207], v211 offset:61952
  v_fma_f32 v248, v248, v221, v220
  v_fma_f32 v249, v249, v221, v220
  v_mul_f32 v246, v246, v96
  s_waitcnt lgkmcnt(4)
  v_mfma_f32_32x32x16_bf16 v[160:175], v[196:199], a[176:179], v[160:175]
  v_mul_f32 v247, v247, v97
  v_mul_f32 v248, v248, v98
  v_mul_f32 v249, v249, v99
  v_exp_f32 v246, v246
  v_mfma_f32_32x32x16_bf16 v[176:191], v[196:199], a[180:183], v[176:191]
  s_waitcnt vmcnt(30) lgkmcnt(0)
  s_barrier
  v_mfma_f32_32x32x16_bf16 v[128:143], v[200:203], a[184:187], v[128:143]
  ds_read_b64_tr_b16 v[192:193], v212 offset:0
  ds_read_b64_tr_b16 v[194:195], v212 offset:512
  s_add_u32 s67, s55, 0x1400
  buffer_load_dword v238, v219, s[36:39], s67 offen offset:0 sc1
  v_mul_f32 v96, v96, v104
  v_mfma_f32_32x32x16_bf16 v[144:159], v[200:203], a[188:191], v[144:159]
  ds_read_b64_tr_b16 v[196:197], v213 offset:0
  ds_read_b64_tr_b16 v[198:199], v213 offset:512
  buffer_load_dword v239, v219, s[36:39], s67 offen offset:128 sc1
  v_exp_f32 v247, v247
  v_mfma_f32_32x32x16_bf16 v[160:175], v[204:207], a[184:187], v[160:175]
  s_add_u32 m0, s41, 0x18000
  s_add_u32 s44, s47, s59
  buffer_load_dwordx4 v214, s[28:31], s44 offen offset:0 lds
  v_mul_f32 v97, v97, v105
  v_mfma_f32_32x32x16_bf16 v[176:191], v[204:207], a[188:191], v[176:191]
  buffer_load_dwordx4 v215, s[28:31], s44 offen offset:1024 lds
  s_add_u32 s59, s59, 0x36000
  v_exp_f32 v248, v248
  v_mul_f32 v98, v98, v106
  s_waitcnt lgkmcnt(2)
  v_mfma_f32_32x32x16_bf16 v[128:143], v[192:195], a[192:195], v[128:143]
  ds_read_b64_tr_b16 v[200:201], v212 offset:4096
  ds_read_b64_tr_b16 v[202:203], v212 offset:4608
  buffer_load_dwordx4 v216, s[32:35], s44 offen offset:2048 lds
  s_cmp_eq_u32 s59, 0x21c000
  s_cselect_b32 s59, 0, s59
  v_mfma_f32_32x32x16_bf16 v[144:159], v[192:195], a[196:199], v[144:159]
  ds_read_b64_tr_b16 v[204:205], v213 offset:4096
  ds_read_b64_tr_b16 v[206:207], v213 offset:4608
  v_exp_f32 v249, v249
  v_mul_f32 v99, v99, v107
  s_waitcnt lgkmcnt(4)
  v_mfma_f32_32x32x16_bf16 v[160:175], v[196:199], a[192:195], v[160:175]
  buffer_load_dwordx4 v217, s[32:35], s44 offen offset:3072 lds
  v_fma_f32 v246, v246, v222, v222
  v_fma_f32 v247, v247, v222, v222
  v_fma_f32 v248, v248, v222, v222
  v_fma_f32 v249, v249, v222, v222
  v_mfma_f32_32x32x16_bf16 v[176:191], v[196:199], a[196:199], v[176:191]
  v_rcp_f32 v246, v246
  v_rcp_f32 v247, v247
  s_waitcnt lgkmcnt(2)
  v_mfma_f32_32x32x16_bf16 v[128:143], v[200:203], a[200:203], v[128:143]
  ds_read_b64_tr_b16 v[192:193], v212 offset:8192
  ds_read_b64_tr_b16 v[194:195], v212 offset:8704
  s_add_u32 m0, s41, 0x1c000
  s_add_u32 s44, s47, s59
  buffer_load_dwordx4 v214, s[28:31], s44 offen offset:0 lds
  v_mfma_f32_32x32x16_bf16 v[144:159], v[200:203], a[204:207], v[144:159]
  ds_read_b64_tr_b16 v[196:197], v213 offset:8192
  ds_read_b64_tr_b16 v[198:199], v213 offset:8704
  v_rcp_f32 v248, v248
  s_waitcnt lgkmcnt(4)
  v_mfma_f32_32x32x16_bf16 v[160:175], v[204:207], a[200:203], v[160:175]
  buffer_load_dwordx4 v215, s[28:31], s44 offen offset:1024 lds
  s_add_u32 s59, s59, 0x36000
  v_rcp_f32 v249, v249
  v_mul_f32 v96, v96, v246
  v_mfma_f32_32x32x16_bf16 v[176:191], v[204:207], a[204:207], v[176:191]
  v_mul_f32 v97, v97, v247
  v_mul_f32 v98, v98, v248
  v_mul_f32 v99, v99, v249
  v_cvt_pk_bf16_f32 v104, v96, v97
  v_cvt_pk_bf16_f32 v105, v98, v99
  s_waitcnt lgkmcnt(2)
  v_mfma_f32_32x32x16_bf16 v[128:143], v[192:195], a[208:211], v[128:143]
  ds_read_b64_tr_b16 v[200:201], v212 offset:12288
  ds_read_b64_tr_b16 v[202:203], v212 offset:12800
  buffer_load_dwordx4 v216, s[32:35], s44 offen offset:2048 lds
  s_cmp_eq_u32 s59, 0x21c000
  s_cselect_b32 s59, 0, s59
  v_mfma_f32_32x32x16_bf16 v[144:159], v[192:195], a[212:215], v[144:159]
  ds_read_b64_tr_b16 v[204:205], v213 offset:12288
  ds_read_b64_tr_b16 v[206:207], v213 offset:12800
  v_mul_f32 v246, v100, v100
  v_mul_f32 v247, v101, v101
  v_mul_f32 v248, v102, v102
  s_waitcnt lgkmcnt(4)
  v_mfma_f32_32x32x16_bf16 v[160:175], v[196:199], a[208:211], v[160:175]
  buffer_load_dwordx4 v217, s[32:35], s44 offen offset:3072 lds
  v_mul_f32 v249, v103, v103
  v_fma_f32 v246, v246, v221, v220
  v_fma_f32 v247, v247, v221, v220
  v_fma_f32 v248, v248, v221, v220
  v_mfma_f32_32x32x16_bf16 v[176:191], v[196:199], a[212:215], v[176:191]
  s_waitcnt vmcnt(36) lgkmcnt(0)
  s_barrier
  v_mfma_f32_32x32x16_bf16 v[128:143], v[200:203], a[216:219], v[128:143]
  ds_read_b64_tr_b16 v[192:193], v212 offset:16384
  ds_read_b64_tr_b16 v[194:195], v212 offset:16896
  s_add_u32 m0, s41, 0x20000
  s_add_u32 s44, s47, s59
  buffer_load_dwordx4 v214, s[28:31], s44 offen offset:0 lds
  v_mfma_f32_32x32x16_bf16 v[144:159], v[200:203], a[220:223], v[144:159]
  ds_read_b64_tr_b16 v[196:197], v213 offset:16384
  ds_read_b64_tr_b16 v[198:199], v213 offset:16896
  v_fma_f32 v249, v249, v221, v220
  v_mul_f32 v246, v246, v100
  v_mul_f32 v247, v247, v101
  v_mfma_f32_32x32x16_bf16 v[160:175], v[204:207], a[216:219], v[160:175]
  buffer_load_dwordx4 v215, s[28:31], s44 offen offset:1024 lds
  s_add_u32 s59, s59, 0x36000
  v_mul_f32 v248, v248, v102
  v_mul_f32 v249, v249, v103
  v_mfma_f32_32x32x16_bf16 v[176:191], v[204:207], a[220:223], v[176:191]
  v_exp_f32 v246, v246
  v_mul_f32 v100, v100, v108
  v_exp_f32 v247, v247
  s_waitcnt lgkmcnt(2)
  v_mfma_f32_32x32x16_bf16 v[128:143], v[192:195], a[224:227], v[128:143]
  ds_read_b64_tr_b16 v[200:201], v212 offset:20480
  ds_read_b64_tr_b16 v[202:203], v212 offset:20992
  buffer_load_dwordx4 v216, s[32:35], s44 offen offset:2048 lds
  s_cmp_eq_u32 s59, 0x21c000
  s_cselect_b32 s59, 0, s59
  v_mfma_f32_32x32x16_bf16 v[144:159], v[192:195], a[228:231], v[144:159]
  ds_read_b64_tr_b16 v[204:205], v213 offset:20480
  ds_read_b64_tr_b16 v[206:207], v213 offset:20992
  v_mul_f32 v101, v101, v109
  v_exp_f32 v248, v248
  s_waitcnt lgkmcnt(4)
  v_mfma_f32_32x32x16_bf16 v[160:175], v[196:199], a[224:227], v[160:175]
  buffer_load_dwordx4 v217, s[32:35], s44 offen offset:3072 lds
  v_mul_f32 v102, v102, v110
  v_exp_f32 v249, v249
  v_mul_f32 v103, v103, v111
  v_mfma_f32_32x32x16_bf16 v[176:191], v[196:199], a[228:231], v[176:191]
  v_fma_f32 v246, v246, v222, v222
  v_fma_f32 v247, v247, v222, v222
  v_fma_f32 v248, v248, v222, v222
  v_fma_f32 v249, v249, v222, v222
  s_waitcnt lgkmcnt(2)
  v_mfma_f32_32x32x16_bf16 v[128:143], v[200:203], a[232:235], v[128:143]
  ds_read_b64_tr_b16 v[192:193], v212 offset:24576
  ds_read_b64_tr_b16 v[194:195], v212 offset:25088
  v_rcp_f32 v246, v246
  v_mfma_f32_32x32x16_bf16 v[144:159], v[200:203], a[236:239], v[144:159]
  ds_read_b64_tr_b16 v[196:197], v213 offset:24576
  ds_read_b64_tr_b16 v[198:199], v213 offset:25088
  v_rcp_f32 v247, v247
  s_waitcnt lgkmcnt(4)
  v_mfma_f32_32x32x16_bf16 v[160:175], v[204:207], a[232:235], v[160:175]
  v_rcp_f32 v248, v248
  v_rcp_f32 v249, v249
  v_mul_f32 v100, v100, v246
  v_mfma_f32_32x32x16_bf16 v[176:191], v[204:207], a[236:239], v[176:191]
  v_mul_f32 v101, v101, v247
  v_mul_f32 v102, v102, v248
  v_mul_f32 v103, v103, v249
  v_cvt_pk_bf16_f32 v106, v100, v101
  v_cvt_pk_bf16_f32 v107, v102, v103
  s_waitcnt lgkmcnt(2)
  v_mfma_f32_32x32x16_bf16 v[128:143], v[192:195], a[240:243], v[128:143]
  ds_read_b64_tr_b16 v[200:201], v212 offset:28672
  ds_read_b64_tr_b16 v[202:203], v212 offset:29184
  s_add_u32 s62, s51, 0
  buffer_store_dwordx4 v[104:107], v218, s[36:39], s62 offen sc1
  v_mul_f32 v246, v112, v112
  v_mfma_f32_32x32x16_bf16 v[144:159], v[192:195], a[244:247], v[144:159]
  ds_read_b64_tr_b16 v[204:205], v213 offset:28672
  ds_read_b64_tr_b16 v[206:207], v213 offset:29184
  v_mul_f32 v247, v113, v113
  v_mul_f32 v248, v114, v114
  v_mul_f32 v249, v115, v115
  s_waitcnt lgkmcnt(4)
  v_mfma_f32_32x32x16_bf16 v[160:175], v[196:199], a[240:243], v[160:175]
  v_fma_f32 v246, v246, v224, v223
  v_fma_f32 v247, v247, v224, v223
  v_fma_f32 v248, v248, v224, v223
  v_fma_f32 v249, v249, v224, v223
  v_mul_f32 v246, v246, v112
  v_mfma_f32_32x32x16_bf16 v[176:191], v[196:199], a[244:247], v[176:191]
  s_waitcnt vmcnt(37) lgkmcnt(0)
  s_barrier
  v_mfma_f32_32x32x16_bf16 v[128:143], v[200:203], a[248:251], v[128:143]
  ds_read_b64_tr_b16 v[192:193], v208 offset:0
  ds_read_b64_tr_b16 v[194:195], v208 offset:512
  s_add_u32 m0, s41, 0x24000
  s_add_u32 s44, s47, s59
  buffer_load_dwordx4 v214, s[28:31], s44 offen offset:0 lds
  v_mfma_f32_32x32x16_bf16 v[144:159], v[200:203], a[252:255], v[144:159]
  ds_read_b64_tr_b16 v[196:197], v208 offset:4096
  ds_read_b64_tr_b16 v[198:199], v208 offset:4608
  buffer_load_dwordx4 v215, s[28:31], s44 offen offset:1024 lds
  s_add_u32 s59, s59, 0x36000
  v_mul_f32 v247, v247, v113
  v_mfma_f32_32x32x16_bf16 v[160:175], v[204:207], a[248:251], v[160:175]
  buffer_load_dwordx4 v216, s[32:35], s44 offen offset:2048 lds
  s_cmp_eq_u32 s59, 0x21c000
  s_cselect_b32 s59, 0, s59
  v_mul_f32 v248, v248, v114
  v_mul_f32 v249, v249, v115
  v_mfma_f32_32x32x16_bf16 v[176:191], v[204:207], a[252:255], v[176:191]
  v_exp_f32 v246, v246
  v_mul_f32 v112, v112, v120
  v_exp_f32 v247, v247
  v_mul_f32 v113, v113, v121
  v_exp_f32 v248, v248
  v_mul_f32 v114, v114, v122
  v_exp_f32 v249, v249
  v_mul_f32 v115, v115, v123
  v_fma_f32 v246, v246, v225, v225
  v_fma_f32 v247, v247, v225, v225
  v_fma_f32 v248, v248, v225, v225
  v_fma_f32 v249, v249, v225, v225
  v_rcp_f32 v246, v246
  v_rcp_f32 v247, v247
  v_rcp_f32 v248, v248
  v_rcp_f32 v249, v249
  v_mul_f32 v112, v112, v246
  v_mul_f32 v113, v113, v247
  v_mul_f32 v114, v114, v248
  v_mul_f32 v115, v115, v249
  v_cvt_pk_bf16_f32 v120, v112, v113
  v_cvt_pk_bf16_f32 v121, v114, v115
  v_mul_f32 v246, v116, v116
  v_mul_f32 v247, v117, v117
  v_mul_f32 v248, v118, v118
  v_mul_f32 v249, v119, v119
  v_fma_f32 v246, v246, v224, v223
  v_fma_f32 v247, v247, v224, v223
  v_fma_f32 v248, v248, v224, v223
  v_fma_f32 v249, v249, v224, v223
  v_mul_f32 v246, v246, v116
  v_mul_f32 v247, v247, v117
  v_mul_f32 v248, v248, v118
  v_mul_f32 v249, v249, v119
  v_exp_f32 v246, v246
  v_mul_f32 v116, v116, v124
  v_exp_f32 v247, v247
  v_mul_f32 v117, v117, v125
  v_exp_f32 v248, v248
  v_mul_f32 v118, v118, v126
  v_exp_f32 v249, v249
  v_mul_f32 v119, v119, v127
  v_fma_f32 v246, v246, v225, v225
  v_fma_f32 v247, v247, v225, v225
  v_fma_f32 v248, v248, v225, v225
  v_fma_f32 v249, v249, v225, v225
  v_rcp_f32 v246, v246
  v_rcp_f32 v247, v247
  v_rcp_f32 v248, v248
  v_rcp_f32 v249, v249
  v_mul_f32 v116, v116, v246
  v_mul_f32 v117, v117, v247
  v_mul_f32 v118, v118, v248
  v_mul_f32 v119, v119, v249
  v_cvt_pk_bf16_f32 v122, v116, v117
  v_cvt_pk_bf16_f32 v123, v118, v119
  s_add_u32 s63, s51, 0x1b000
  buffer_store_dwordx4 v[120:123], v218, s[36:39], s63 offen sc1
  s_waitcnt lgkmcnt(2)
  v_mfma_f32_32x32x16_bf16 v[64:79], v[192:195], v[0:3], 0
  ds_read_b64_tr_b16 v[200:201], v208 offset:8192
  ds_read_b64_tr_b16 v[202:203], v208 offset:8704
  buffer_load_dwordx4 v217, s[32:35], s44 offen offset:3072 lds
  v_mfma_f32_32x32x16_bf16 v[80:95], v[192:195], v[4:7], 0
  ds_read_b64_tr_b16 v[204:205], v208 offset:12288
  ds_read_b64_tr_b16 v[206:207], v208 offset:12800
  s_waitcnt lgkmcnt(4)
  v_mfma_f32_32x32x16_bf16 v[64:79], v[196:199], v[8:11], v[64:79]
  v_mfma_f32_32x32x16_bf16 v[80:95], v[196:199], v[12:15], v[80:95]
  s_waitcnt vmcnt(18)
  v_max_u32 v226, v238, v239
  v_cmp_eq_u32 vcc, -1, v226
  s_nop 0
  s_cmp_lg_u64 vcc, 0
  s_cbranch_scc1 gu_cs1
gu_cs1_d:
  s_waitcnt lgkmcnt(0)
  s_barrier
  v_mfma_f32_32x32x16_bf16 v[64:79], v[200:203], v[16:19], v[64:79]
  ds_read_b64_tr_b16 v[192:193], v208 offset:16384
  ds_read_b64_tr_b16 v[194:195], v208 offset:16896
  v_add_f32 v238, v238, v239
  v_and_b32 v239, 0xffff0000, v238
  v_sub_f32 v238, v238, v239
  v_mfma_f32_32x32x16_bf16 v[80:95], v[200:203], v[20:23], v[80:95]
  ds_read_b64_tr_b16 v[196:197], v208 offset:20480
  ds_read_b64_tr_b16 v[198:199], v208 offset:20992
  v_cvt_pk_bf16_f32 v226, v239, v238
  v_cvt_pk_bf16_f32 v227, v239, 0
  v_mfma_f32_32x32x16_bf16 v[64:79], v[204:207], v[24:27], v[64:79]
  s_nop 0
  v_mfma_f32_32x32x8_bf16 v[128:143], v[226:227], v[228:229], v[128:143]
  v_mfma_f32_32x32x16_bf16 v[80:95], v[204:207], v[28:31], v[80:95]
  v_mfma_f32_32x32x8_bf16 v[144:159], v[226:227], v[230:231], v[144:159]
  s_waitcnt lgkmcnt(2)
  v_mfma_f32_32x32x16_bf16 v[64:79], v[192:195], v[32:35], v[64:79]
  ds_read_b64_tr_b16 v[200:201], v208 offset:24576
  ds_read_b64_tr_b16 v[202:203], v208 offset:25088
  v_mfma_f32_32x32x8_bf16 v[160:175], v[226:227], v[232:233], v[160:175]
  v_mfma_f32_32x32x16_bf16 v[80:95], v[192:195], v[36:39], v[80:95]
  ds_read_b64_tr_b16 v[204:205], v208 offset:28672
  ds_read_b64_tr_b16 v[206:207], v208 offset:29184
  v_mfma_f32_32x32x8_bf16 v[176:191], v[226:227], v[234:235], v[176:191]
  s_waitcnt lgkmcnt(4)
  v_mfma_f32_32x32x16_bf16 v[64:79], v[196:199], v[40:43], v[64:79]
  v_mul_f32 v246, v128, v128
  v_mul_f32 v247, v129, v129
  v_mul_f32 v248, v130, v130
  v_mul_f32 v249, v131, v131
  v_fma_f32 v246, v246, v221, v220
  v_mfma_f32_32x32x16_bf16 v[80:95], v[196:199], v[44:47], v[80:95]
  s_waitcnt lgkmcnt(0)
  s_barrier
  v_mfma_f32_32x32x16_bf16 v[64:79], v[200:203], v[48:51], v[64:79]
  ds_read_b64_tr_b16 v[192:193], v208 offset:32768
  ds_read_b64_tr_b16 v[194:195], v208 offset:33280
  v_fma_f32 v247, v247, v221, v220
  v_fma_f32 v248, v248, v221, v220
  v_fma_f32 v249, v249, v221, v220
  v_mfma_f32_32x32x16_bf16 v[80:95], v[200:203], v[52:55], v[80:95]
  ds_read_b64_tr_b16 v[196:197], v208 offset:36864
  ds_read_b64_tr_b16 v[198:199], v208 offset:37376
  v_mul_f32 v246, v246, v128
  v_mul_f32 v247, v247, v129
  v_mul_f32 v248, v248, v130
  v_mfma_f32_32x32x16_bf16 v[64:79], v[204:207], v[56:59], v[64:79]
  v_mul_f32 v249, v249, v131
  v_exp_f32 v246, v246
  v_mul_f32 v128, v128, v136
  v_mfma_f32_32x32x16_bf16 v[80:95], v[204:207], v[60:63], v[80:95]
  v_exp_f32 v247, v247
  v_mul_f32 v129, v129, v137
  v_exp_f32 v248, v248
  s_waitcnt lgkmcnt(2)
  v_mfma_f32_32x32x16_bf16 v[64:79], v[192:195], a[0:3], v[64:79]
  ds_read_b64_tr_b16 v[200:201], v208 offset:40960
  ds_read_b64_tr_b16 v[202:203], v208 offset:41472
  v_mul_f32 v130, v130, v138
  v_exp_f32 v249, v249
  v_mfma_f32_32x32x16_bf16 v[80:95], v[192:195], a[4:7], v[80:95]
  ds_read_b64_tr_b16 v[204:205], v208 offset:45056
  ds_read_b64_tr_b16 v[206:207], v208 offset:45568
  v_mul_f32 v131, v131, v139
  v_fma_f32 v246, v246, v222, v222
  v_fma_f32 v247, v247, v222, v222
  s_waitcnt lgkmcnt(4)
  v_mfma_f32_32x32x16_bf16 v[64:79], v[196:199], a[8:11], v[64:79]
  v_fma_f32 v248, v248, v222, v222
  v_fma_f32 v249, v249, v222, v222
  v_rcp_f32 v246, v246
  v_mfma_f32_32x32x16_bf16 v[80:95], v[196:199], a[12:15], v[80:95]
  s_waitcnt lgkmcnt(0)
  s_barrier
  v_mfma_f32_32x32x16_bf16 v[64:79], v[200:203], a[16:19], v[64:79]
  ds_read_b64_tr_b16 v[192:193], v208 offset:49152
  ds_read_b64_tr_b16 v[194:195], v208 offset:49664
  v_rcp_f32 v247, v247
  v_mfma_f32_32x32x16_bf16 v[80:95], v[200:203], a[20:23], v[80:95]
  ds_read_b64_tr_b16 v[196:197], v208 offset:53248
  ds_read_b64_tr_b16 v[198:199], v208 offset:53760
  v_rcp_f32 v248, v248
  v_mfma_f32_32x32x16_bf16 v[64:79], v[204:207], a[24:27], v[64:79]
  v_rcp_f32 v249, v249
  v_mul_f32 v128, v128, v246
  v_mul_f32 v129, v129, v247
  v_mul_f32 v130, v130, v248
  v_mfma_f32_32x32x16_bf16 v[80:95], v[204:207], a[28:31], v[80:95]
  v_mul_f32 v131, v131, v249
  v_cvt_pk_bf16_f32 v136, v128, v129
  v_cvt_pk_bf16_f32 v137, v130, v131
  v_mul_f32 v246, v132, v132
  v_mul_f32 v247, v133, v133
  s_waitcnt lgkmcnt(2)
  v_mfma_f32_32x32x16_bf16 v[64:79], v[192:195], a[32:35], v[64:79]
  ds_read_b64_tr_b16 v[200:201], v208 offset:57344
  ds_read_b64_tr_b16 v[202:203], v208 offset:57856
  v_mul_f32 v248, v134, v134
  v_mul_f32 v249, v135, v135
  v_fma_f32 v246, v246, v221, v220
  v_mfma_f32_32x32x16_bf16 v[80:95], v[192:195], a[36:39], v[80:95]
  ds_read_b64_tr_b16 v[204:205], v208 offset:61440
  ds_read_b64_tr_b16 v[206:207], v208 offset:61952
  v_fma_f32 v247, v247, v221, v220
  v_fma_f32 v248, v248, v221, v220
  v_fma_f32 v249, v249, v221, v220
  s_waitcnt lgkmcnt(4)
  v_mfma_f32_32x32x16_bf16 v[64:79], v[196:199], a[40:43], v[64:79]
  v_mul_f32 v246, v246, v132
  v_mul_f32 v247, v247, v133
  v_mul_f32 v248, v248, v134
  v_mul_f32 v249, v249, v135
  v_mfma_f32_32x32x16_bf16 v[80:95], v[196:199], a[44:47], v[80:95]
  s_waitcnt lgkmcnt(0)
  s_barrier
  v_mfma_f32_32x32x16_bf16 v[64:79], v[200:203], a[48:51], v[64:79]
  ds_read_b64_tr_b16 v[192:193], v210 offset:0
  ds_read_b64_tr_b16 v[194:195], v210 offset:512
  v_exp_f32 v246, v246
  v_mul_f32 v132, v132, v140
  v_mfma_f32_32x32x16_bf16 v[80:95], v[200:203], a[52:55], v[80:95]
  ds_read_b64_tr_b16 v[196:197], v210 offset:4096
  ds_read_b64_tr_b16 v[198:199], v210 offset:4608
  v_exp_f32 v247, v247
  v_mul_f32 v133, v133, v141
  v_mfma_f32_32x32x16_bf16 v[64:79], v[204:207], a[56:59], v[64:79]
  v_exp_f32 v248, v248
  v_mul_f32 v134, v134, v142
  v_exp_f32 v249, v249
  v_mfma_f32_32x32x16_bf16 v[80:95], v[204:207], a[60:63], v[80:95]
  v_mul_f32 v135, v135, v143
  v_fma_f32 v246, v246, v222, v222
  v_fma_f32 v247, v247, v222, v222
  v_fma_f32 v248, v248, v222, v222
  v_fma_f32 v249, v249, v222, v222
  s_waitcnt lgkmcnt(2)
  v_mfma_f32_32x32x16_bf16 v[64:79], v[192:195], a[64:67], v[64:79]
  ds_read_b64_tr_b16 v[200:201], v210 offset:8192
  ds_read_b64_tr_b16 v[202:203], v210 offset:8704
  v_rcp_f32 v246, v246
  v_mfma_f32_32x32x16_bf16 v[80:95], v[192:195], a[68:71], v[80:95]
  ds_read_b64_tr_b16 v[204:205], v210 offset:12288
  ds_read_b64_tr_b16 v[206:207], v210 offset:12800
  v_rcp_f32 v247, v247
  s_waitcnt lgkmcnt(4)
  v_mfma_f32_32x32x16_bf16 v[64:79], v[196:199], a[72:75], v[64:79]
  v_rcp_f32 v248, v248
  v_rcp_f32 v249, v249
  v_mul_f32 v132, v132, v246
  v_mfma_f32_32x32x16_bf16 v[80:95], v[196:199], a[76:79], v[80:95]
  s_waitcnt lgkmcnt(0)
  s_barrier
  v_mfma_f32_32x32x16_bf16 v[64:79], v[200:203], a[80:83], v[64:79]
  ds_read_b64_tr_b16 v[192:193], v210 offset:16384
  ds_read_b64_tr_b16 v[194:195], v210 offset:16896
  s_add_u32 s67, s55, 0x2800
  buffer_load_dword v240, v219, s[36:39], s67 offen offset:0 sc1
  v_mul_f32 v133, v133, v247
  v_mfma_f32_32x32x16_bf16 v[80:95], v[200:203], a[84:87], v[80:95]
  ds_read_b64_tr_b16 v[196:197], v210 offset:20480
  ds_read_b64_tr_b16 v[198:199], v210 offset:20992
  buffer_load_dword v241, v219, s[36:39], s67 offen offset:128 sc1
  v_mul_f32 v134, v134, v248
  v_mul_f32 v135, v135, v249
  v_mfma_f32_32x32x16_bf16 v[64:79], v[204:207], a[88:91], v[64:79]
  v_cvt_pk_bf16_f32 v138, v132, v133
  v_cvt_pk_bf16_f32 v139, v134, v135
  s_add_u32 s60, s49, 0
  buffer_store_dwordx4 v[136:139], v218, s[36:39], s60 offen sc1
  v_mul_f32 v246, v144, v144
  v_mfma_f32_32x32x16_bf16 v[80:95], v[204:207], a[92:95], v[80:95]
  v_mul_f32 v247, v145, v145
  v_mul_f32 v248, v146, v146
  v_mul_f32 v249, v147, v147
  v_fma_f32 v246, v246, v224, v223
  v_fma_f32 v247, v247, v224, v223
  s_waitcnt lgkmcnt(2)
  v_mfma_f32_32x32x16_bf16 v[64:79], v[192:195], a[96:99], v[64:79]
  ds_read_b64_tr_b16 v[200:201], v210 offset:24576
  ds_read_b64_tr_b16 v[202:203], v210 offset:25088
  v_fma_f32 v248, v248, v224, v223
  v_fma_f32 v249, v249, v224, v223
  v_mul_f32 v246, v246, v144
  v_mfma_f32_32x32x16_bf16 v[80:95], v[192:195], a[100:103], v[80:95]
  ds_read_b64_tr_b16 v[204:205], v210 offset:28672
  ds_read_b64_tr_b16 v[206:207], v210 offset:29184
  v_mul_f32 v247, v247, v145
  v_mul_f32 v248, v248, v146
  v_mul_f32 v249, v249, v147
  s_waitcnt lgkmcnt(4)
  v_mfma_f32_32x32x16_bf16 v[64:79], v[196:199], a[104:107], v[64:79]
  v_exp_f32 v246, v246
  v_mul_f32 v144, v144, v152
  v_exp_f32 v247, v247
  v_mfma_f32_32x32x16_bf16 v[80:95], v[196:199], a[108:111], v[80:95]
  s_waitcnt vmcnt(17) lgkmcnt(0)
  s_barrier
  v_mfma_f32_32x32x16_bf16 v[64:79], v[200:203], a[112:115], v[64:79]
  ds_read_b64_tr_b16 v[192:193], v210 offset:32768
  ds_read_b64_tr_b16 v[194:195], v210 offset:33280
  v_mul_f32 v145, v145, v153
  v_exp_f32 v248, v248
  v_mfma_f32_32x32x16_bf16 v[80:95], v[200:203], a[116:119], v[80:95]
  ds_read_b64_tr_b16 v[196:197], v210 offset:36864
  ds_read_b64_tr_b16 v[198:199], v210 offset:37376
  v_mul_f32 v146, v146, v154
  v_exp_f32 v249, v249
  v_mfma_f32_32x32x16_bf16 v[64:79], v[204:207], a[120:123], v[64:79]
  v_mul_f32 v147, v147, v155
  v_fma_f32 v246, v246, v225, v225
  v_fma_f32 v247, v247, v225, v225
  v_fma_f32 v248, v248, v225, v225
  v_fma_f32 v249, v249, v225, v225
  v_mfma_f32_32x32x16_bf16 v[80:95], v[204:207], a[124:127], v[80:95]
  v_rcp_f32 v246, v246
  v_rcp_f32 v247, v247
  s_waitcnt lgkmcnt(2)
  v_mfma_f32_32x32x16_bf16 v[64:79], v[192:195], a[128:131], v[64:79]
  ds_read_b64_tr_b16 v[200:201], v210 offset:40960
  ds_read_b64_tr_b16 v[202:203], v210 offset:41472
  v_rcp_f32 v248, v248
  v_mfma_f32_32x32x16_bf16 v[80:95], v[192:195], a[132:135], v[80:95]
  ds_read_b64_tr_b16 v[204:205], v210 offset:45056
  ds_read_b64_tr_b16 v[206:207], v210 offset:45568
  v_rcp_f32 v249, v249
  v_mul_f32 v144, v144, v246
  s_waitcnt lgkmcnt(4)
  v_mfma_f32_32x32x16_bf16 v[64:79], v[196:199], a[136:139], v[64:79]
  v_mul_f32 v145, v145, v247
  v_mul_f32 v146, v146, v248
  v_mul_f32 v147, v147, v249
  v_cvt_pk_bf16_f32 v152, v144, v145
  v_cvt_pk_bf16_f32 v153, v146, v147
  v_mfma_f32_32x32x16_bf16 v[80:95], v[196:199], a[140:143], v[80:95]
  s_waitcnt vmcnt(1)
  v_max_u32 v226, v240, v241
  v_cmp_eq_u32 vcc, -1, v226
  s_nop 0
  s_cmp_lg_u64 vcc, 0
  s_cbranch_scc1 gu_cs2
gu_cs2_d:
  s_waitcnt lgkmcnt(0)
  s_barrier
  v_mfma_f32_32x32x16_bf16 v[64:79], v[200:203], a[144:147], v[64:79]
  ds_read_b64_tr_b16 v[192:193], v210 offset:49152
  ds_read_b64_tr_b16 v[194:195], v210 offset:49664
  v_add_f32 v240, v240, v241
  v_and_b32 v241, 0xffff0000, v240
  v_sub_f32 v240, v240, v241
  v_mfma_f32_32x32x16_bf16 v[80:95], v[200:203], a[148:151], v[80:95]
  ds_read_b64_tr_b16 v[196:197], v210 offset:53248
  ds_read_b64_tr_b16 v[198:199], v210 offset:53760
  v_cvt_pk_bf16_f32 v226, v241, v240
  v_cvt_pk_bf16_f32 v227, v241, 0
  v_mul_f32 v246, v148, v148
  v_mfma_f32_32x32x16_bf16 v[64:79], v[204:207], a[152:155], v[64:79]
  v_mfma_f32_32x32x8_bf16 v[64:79], v[226:227], v[228:229], v[64:79]
  v_mul_f32 v247, v149, v149
  v_mul_f32 v248, v150, v150
  v_mfma_f32_32x32x16_bf16 v[80:95], v[204:207], a[156:159], v[80:95]
  v_mfma_f32_32x32x8_bf16 v[80:95], v[226:227], v[230:231], v[80:95]
  v_mul_f32 v249, v151, v151
  v_fma_f32 v246, v246, v224, v223
  s_waitcnt lgkmcnt(2)
  v_mfma_f32_32x32x16_bf16 v[64:79], v[192:195], a[160:163], v[64:79]
  ds_read_b64_tr_b16 v[200:201], v210 offset:57344
  ds_read_b64_tr_b16 v[202:203], v210 offset:57856
  v_fma_f32 v247, v247, v224, v223
  v_fma_f32 v248, v248, v224, v223
  v_fma_f32 v249, v249, v224, v223
  v_mfma_f32_32x32x16_bf16 v[80:95], v[192:195], a[164:167], v[80:95]
  ds_read_b64_tr_b16 v[204:205], v210 offset:61440
  ds_read_b64_tr_b16 v[206:207], v210 offset:61952
  v_mul_f32 v246, v246, v148
  v_mul_f32 v247, v247, v149
  v_mul_f32 v248, v248, v150
  s_waitcnt lgkmcnt(4)
  v_mfma_f32_32x32x16_bf16 v[64:79], v[196:199], a[168:171], v[64:79]
  v_mul_f32 v249, v249, v151
  v_exp_f32 v246, v246
  v_mul_f32 v148, v148, v156
  v_mfma_f32_32x32x16_bf16 v[80:95], v[196:199], a[172:175], v[80:95]
  s_waitcnt lgkmcnt(0)
  s_barrier
  v_mfma_f32_32x32x16_bf16 v[64:79], v[200:203], a[176:179], v[64:79]
  ds_read_b64_tr_b16 v[192:193], v212 offset:0
  ds_read_b64_tr_b16 v[194:195], v212 offset:512
  v_exp_f32 v247, v247
  v_mul_f32 v149, v149, v157
  v_mfma_f32_32x32x16_bf16 v[80:95], v[200:203], a[180:183], v[80:95]
  ds_read_b64_tr_b16 v[196:197], v212 offset:4096
  ds_read_b64_tr_b16 v[198:199], v212 offset:4608
  v_exp_f32 v248, v248
  v_mul_f32 v150, v150, v158
  v_mfma_f32_32x32x16_bf16 v[64:79], v[204:207], a[184:187], v[64:79]
  v_exp_f32 v249, v249
  v_mul_f32 v151, v151, v159
  v_fma_f32 v246, v246, v225, v225
  v_fma_f32 v247, v247, v225, v225
  v_mfma_f32_32x32x16_bf16 v[80:95], v[204:207], a[188:191], v[80:95]
  v_fma_f32 v248, v248, v225, v225
  v_fma_f32 v249, v249, v225, v225
  v_rcp_f32 v246, v246
  s_waitcnt lgkmcnt(2)
  v_mfma_f32_32x32x16_bf16 v[64:79], v[192:195], a[192:195], v[64:79]
  ds_read_b64_tr_b16 v[200:201], v212 offset:8192
  ds_read_b64_tr_b16 v[202:203], v212 offset:8704
  v_rcp_f32 v247, v247
  v_mfma_f32_32x32x16_bf16 v[80:95], v[192:195], a[196:199], v[80:95]
  ds_read_b64_tr_b16 v[204:205], v212 offset:12288
  ds_read_b64_tr_b16 v[206:207], v212 offset:12800
  v_rcp_f32 v248, v248
  s_waitcnt lgkmcnt(4)
  v_mfma_f32_32x32x16_bf16 v[64:79], v[196:199], a[200:203], v[64:79]
  v_rcp_f32 v249, v249
  v_mul_f32 v148, v148, v246
  v_mul_f32 v149, v149, v247
  v_mul_f32 v150, v150, v248
  v_mfma_f32_32x32x16_bf16 v[80:95], v[196:199], a[204:207], v[80:95]
  s_waitcnt lgkmcnt(0)
  s_barrier
  v_mfma_f32_32x32x16_bf16 v[64:79], v[200:203], a[208:211], v[64:79]
  ds_read_b64_tr_b16 v[192:193], v212 offset:16384
  ds_read_b64_tr_b16 v[194:195], v212 offset:16896
  v_mul_f32 v151, v151, v249
  v_cvt_pk_bf16_f32 v154, v148, v149
  v_cvt_pk_bf16_f32 v155, v150, v151
  v_mfma_f32_32x32x16_bf16 v[80:95], v[200:203], a[212:215], v[80:95]
  ds_read_b64_tr_b16 v[196:197], v212 offset:20480
  ds_read_b64_tr_b16 v[198:199], v212 offset:20992
  s_add_u32 s61, s49, 0x1b000
  buffer_store_dwordx4 v[152:155], v218, s[36:39], s61 offen sc1
  v_mul_f32 v246, v160, v160
  v_mfma_f32_32x32x16_bf16 v[64:79], v[204:207], a[216:219], v[64:79]
  v_mul_f32 v247, v161, v161
  v_mul_f32 v248, v162, v162
  v_mul_f32 v249, v163, v163
  v_fma_f32 v246, v246, v221, v220
  v_fma_f32 v247, v247, v221, v220
  v_mfma_f32_32x32x16_bf16 v[80:95], v[204:207], a[220:223], v[80:95]
  v_fma_f32 v248, v248, v221, v220
  v_fma_f32 v249, v249, v221, v220
  v_mul_f32 v246, v246, v160
  v_mul_f32 v247, v247, v161
  v_mul_f32 v248, v248, v162
  s_waitcnt lgkmcnt(2)
  v_mfma_f32_32x32x16_bf16 v[64:79], v[192:195], a[224:227], v[64:79]
  ds_read_b64_tr_b16 v[200:201], v212 offset:24576
  ds_read_b64_tr_b16 v[202:203], v212 offset:25088
  v_mul_f32 v249, v249, v163
  v_exp_f32 v246, v246
  v_mfma_f32_32x32x16_bf16 v[80:95], v[192:195], a[228:231], v[80:95]
  ds_read_b64_tr_b16 v[204:205], v212 offset:28672
  ds_read_b64_tr_b16 v[206:207], v212 offset:29184
  v_mul_f32 v160, v160, v168
  v_exp_f32 v247, v247
  s_waitcnt lgkmcnt(4)
  v_mfma_f32_32x32x16_bf16 v[64:79], v[196:199], a[232:235], v[64:79]
  v_mul_f32 v161, v161, v169
  v_exp_f32 v248, v248
  v_mul_f32 v162, v162, v170
  v_mfma_f32_32x32x16_bf16 v[80:95], v[196:199], a[236:239], v[80:95]
  v_exp_f32 v249, v249
  v_mul_f32 v163, v163, v171
  v_fma_f32 v246, v246, v222, v222
  v_fma_f32 v247, v247, v222, v222
  s_waitcnt lgkmcnt(2)
  v_mfma_f32_32x32x16_bf16 v[64:79], v[200:203], a[240:243], v[64:79]
  ds_read_b64_tr_b16 v[192:193], v209 offset:0
  ds_read_b64_tr_b16 v[194:195], v209 offset:512
  v_fma_f32 v248, v248, v222, v222
  v_fma_f32 v249, v249, v222, v222
  v_mfma_f32_32x32x16_bf16 v[80:95], v[200:203], a[244:247], v[80:95]
  ds_read_b64_tr_b16 v[196:197], v209 offset:4096
  ds_read_b64_tr_b16 v[198:199], v209 offset:4608
  v_rcp_f32 v246, v246
  s_waitcnt lgkmcnt(4)
  v_mfma_f32_32x32x16_bf16 v[64:79], v[204:207], a[248:251], v[64:79]
  v_rcp_f32 v247, v247
  v_rcp_f32 v248, v248
  v_mfma_f32_32x32x16_bf16 v[80:95], v[204:207], a[252:255], v[80:95]
  v_rcp_f32 v249, v249
  v_mul_f32 v160, v160, v246
  v_mul_f32 v161, v161, v247
  v_mul_f32 v162, v162, v248
  s_waitcnt lgkmcnt(2)
  v_mfma_f32_32x32x16_bf16 v[96:111], v[192:195], v[0:3], 0
  ds_read_b64_tr_b16 v[200:201], v209 offset:8192
  ds_read_b64_tr_b16 v[202:203], v209 offset:8704
  v_mul_f32 v163, v163, v249
  v_cvt_pk_bf16_f32 v168, v160, v161
  v_cvt_pk_bf16_f32 v169, v162, v163
  v_mfma_f32_32x32x16_bf16 v[112:127], v[192:195], v[4:7], 0
  ds_read_b64_tr_b16 v[204:205], v209 offset:12288
  ds_read_b64_tr_b16 v[206:207], v209 offset:12800
  v_mul_f32 v246, v164, v164
  v_mul_f32 v247, v165, v165
  v_mul_f32 v248, v166, v166
  s_waitcnt lgkmcnt(4)
  v_mfma_f32_32x32x16_bf16 v[96:111], v[196:199], v[8:11], v[96:111]
  v_mul_f32 v249, v167, v167
  v_fma_f32 v246, v246, v221, v220
  v_fma_f32 v247, v247, v221, v220
  v_fma_f32 v248, v248, v221, v220
  v_fma_f32 v249, v249, v221, v220
  v_mfma_f32_32x32x16_bf16 v[112:127], v[196:199], v[12:15], v[112:127]
  v_mul_f32 v246, v246, v164
  v_mul_f32 v247, v247, v165
  v_mul_f32 v248, v248, v166
  v_mul_f32 v249, v249, v167
  s_waitcnt lgkmcnt(2)
  v_mfma_f32_32x32x16_bf16 v[96:111], v[200:203], v[16:19], v[96:111]
  ds_read_b64_tr_b16 v[192:193], v209 offset:16384
  ds_read_b64_tr_b16 v[194:195], v209 offset:16896
  v_mfma_f32_32x32x8_bf16 v[96:111], v[226:227], v[232:233], v[96:111]
  v_mfma_f32_32x32x16_bf16 v[112:127], v[200:203], v[20:23], v[112:127]
  ds_read_b64_tr_b16 v[196:197], v209 offset:20480
  ds_read_b64_tr_b16 v[198:199], v209 offset:20992
  v_mfma_f32_32x32x8_bf16 v[112:127], v[226:227], v[234:235], v[112:127]
  s_waitcnt lgkmcnt(4)
  v_mfma_f32_32x32x16_bf16 v[96:111], v[204:207], v[24:27], v[96:111]
  v_exp_f32 v246, v246
  v_mul_f32 v164, v164, v172
  v_exp_f32 v247, v247
  v_mfma_f32_32x32x16_bf16 v[112:127], v[204:207], v[28:31], v[112:127]
  v_mul_f32 v165, v165, v173
  v_exp_f32 v248, v248
  v_mul_f32 v166, v166, v174
  s_waitcnt lgkmcnt(2)
  v_mfma_f32_32x32x16_bf16 v[96:111], v[192:195], v[32:35], v[96:111]
  ds_read_b64_tr_b16 v[200:201], v209 offset:24576
  ds_read_b64_tr_b16 v[202:203], v209 offset:25088
  v_exp_f32 v249, v249
  v_mul_f32 v167, v167, v175
  v_mfma_f32_32x32x16_bf16 v[112:127], v[192:195], v[36:39], v[112:127]
  ds_read_b64_tr_b16 v[204:205], v209 offset:28672
  ds_read_b64_tr_b16 v[206:207], v209 offset:29184
  v_fma_f32 v246, v246, v222, v222
  v_fma_f32 v247, v247, v222, v222
  v_fma_f32 v248, v248, v222, v222
  s_waitcnt lgkmcnt(4)
  v_mfma_f32_32x32x16_bf16 v[96:111], v[196:199], v[40:43], v[96:111]
  v_fma_f32 v249, v249, v222, v222
  v_rcp_f32 v246, v246
  v_rcp_f32 v247, v247
  v_mfma_f32_32x32x16_bf16 v[112:127], v[196:199], v[44:47], v[112:127]
  v_rcp_f32 v248, v248
  v_rcp_f32 v249, v249
  v_mul_f32 v164, v164, v246
  s_waitcnt lgkmcnt(2)
  v_mfma_f32_32x32x16_bf16 v[96:111], v[200:203], v[48:51], v[96:111]
  ds_read_b64_tr_b16 v[192:193], v209 offset:32768
  ds_read_b64_tr_b16 v[194:195], v209 offset:33280
  v_mul_f32 v165, v165, v247
  v_mul_f32 v166, v166, v248
  v_mul_f32 v167, v167, v249
  v_mfma_f32_32x32x16_bf16 v[112:127], v[200:203], v[52:55], v[112:127]
  ds_read_b64_tr_b16 v[196:197], v209 offset:36864
  ds_read_b64_tr_b16 v[198:199], v209 offset:37376
  v_cvt_pk_bf16_f32 v170, v164, v165
  v_cvt_pk_bf16_f32 v171, v166, v167
  s_add_u32 s62, s52, 0
  s_waitcnt lgkmcnt(4)
  v_mfma_f32_32x32x16_bf16 v[96:111], v[204:207], v[56:59], v[96:111]
  buffer_store_dwordx4 v[168:171], v218, s[36:39], s62 offen sc1
  v_mul_f32 v246, v176, v176
  v_mul_f32 v247, v177, v177
  v_mul_f32 v248, v178, v178
  v_mul_f32 v249, v179, v179
  v_mfma_f32_32x32x16_bf16 v[112:127], v[204:207], v[60:63], v[112:127]
  v_fma_f32 v246, v246, v224, v223
  v_fma_f32 v247, v247, v224, v223
  v_fma_f32 v248, v248, v224, v223
  v_fma_f32 v249, v249, v224, v223
  v_mul_f32 v246, v246, v176
  s_waitcnt lgkmcnt(2)
  v_mfma_f32_32x32x16_bf16 v[96:111], v[192:195], a[0:3], v[96:111]
  ds_read_b64_tr_b16 v[200:201], v209 offset:40960
  ds_read_b64_tr_b16 v[202:203], v209 offset:41472
  v_mul_f32 v247, v247, v177
  v_mul_f32 v248, v248, v178
  v_mul_f32 v249, v249, v179
  v_mfma_f32_32x32x16_bf16 v[112:127], v[192:195], a[4:7], v[112:127]
  ds_read_b64_tr_b16 v[204:205], v209 offset:45056
  ds_read_b64_tr_b16 v[206:207], v209 offset:45568
  v_exp_f32 v246, v246
  v_mul_f32 v176, v176, v184
  s_waitcnt lgkmcnt(4)
  v_mfma_f32_32x32x16_bf16 v[96:111], v[196:199], a[8:11], v[96:111]
  v_exp_f32 v247, v247
  v_mul_f32 v177, v177, v185
  v_exp_f32 v248, v248
  v_mfma_f32_32x32x16_bf16 v[112:127], v[196:199], a[12:15], v[112:127]
  v_mul_f32 v178, v178, v186
  v_exp_f32 v249, v249
  v_mul_f32 v179, v179, v187
  v_fma_f32 v246, v246, v225, v225
  s_waitcnt lgkmcnt(2)
  v_mfma_f32_32x32x16_bf16 v[96:111], v[200:203], a[16:19], v[96:111]
  ds_read_b64_tr_b16 v[192:193], v209 offset:49152
  ds_read_b64_tr_b16 v[194:195], v209 offset:49664
  v_fma_f32 v247, v247, v225, v225
  v_fma_f32 v248, v248, v225, v225
  v_fma_f32 v249, v249, v225, v225
  v_mfma_f32_32x32x16_bf16 v[112:127], v[200:203], a[20:23], v[112:127]
  ds_read_b64_tr_b16 v[196:197], v209 offset:53248
  ds_read_b64_tr_b16 v[198:199], v209 offset:53760
  v_rcp_f32 v246, v246
  s_waitcnt lgkmcnt(4)
  v_mfma_f32_32x32x16_bf16 v[96:111], v[204:207], a[24:27], v[96:111]
  v_rcp_f32 v247, v247
  v_rcp_f32 v248, v248
  v_mfma_f32_32x32x16_bf16 v[112:127], v[204:207], a[28:31], v[112:127]
  v_rcp_f32 v249, v249
  v_mul_f32 v176, v176, v246
  v_mul_f32 v177, v177, v247
  v_mul_f32 v178, v178, v248
  s_waitcnt lgkmcnt(2)
  v_mfma_f32_32x32x16_bf16 v[96:111], v[192:195], a[32:35], v[96:111]
  ds_read_b64_tr_b16 v[200:201], v209 offset:57344
  ds_read_b64_tr_b16 v[202:203], v209 offset:57856
  v_mul_f32 v179, v179, v249
  v_cvt_pk_bf16_f32 v184, v176, v177
  v_cvt_pk_bf16_f32 v185, v178, v179
  v_mfma_f32_32x32x16_bf16 v[112:127], v[192:195], a[36:39], v[112:127]
  ds_read_b64_tr_b16 v[204:205], v209 offset:61440
  ds_read_b64_tr_b16 v[206:207], v209 offset:61952
  v_mul_f32 v246, v180, v180
  v_mul_f32 v247, v181, v181
  v_mul_f32 v248, v182, v182
  s_waitcnt lgkmcnt(4)
  v_mfma_f32_32x32x16_bf16 v[96:111], v[196:199], a[40:43], v[96:111]
  v_mul_f32 v249, v183, v183
  v_fma_f32 v246, v246, v224, v223
  v_fma_f32 v247, v247, v224, v223
  v_fma_f32 v248, v248, v224, v223
  v_fma_f32 v249, v249, v224, v223
  v_mfma_f32_32x32x16_bf16 v[112:127], v[196:199], a[44:47], v[112:127]
  v_mul_f32 v246, v246, v180
  v_mul_f32 v247, v247, v181
  v_mul_f32 v248, v248, v182
  v_mul_f32 v249, v249, v183
  s_waitcnt lgkmcnt(2)
  v_mfma_f32_32x32x16_bf16 v[96:111], v[200:203], a[48:51], v[96:111]
  ds_read_b64_tr_b16 v[192:193], v211 offset:0
  ds_read_b64_tr_b16 v[194:195], v211 offset:512
  v_exp_f32 v246, v246
  v_mul_f32 v180, v180, v188
  v_mfma_f32_32x32x16_bf16 v[112:127], v[200:203], a[52:55], v[112:127]
  ds_read_b64_tr_b16 v[196:197], v211 offset:4096
  ds_read_b64_tr_b16 v[198:199], v211 offset:4608
  v_exp_f32 v247, v247
  v_mul_f32 v181, v181, v189
  s_waitcnt lgkmcnt(4)
  v_mfma_f32_32x32x16_bf16 v[96:111], v[204:207], a[56:59], v[96:111]
  v_exp_f32 v248, v248
  v_mul_f32 v182, v182, v190
  v_exp_f32 v249, v249
  v_mfma_f32_32x32x16_bf16 v[112:127], v[204:207], a[60:63], v[112:127]
  v_mul_f32 v183, v183, v191
  v_fma_f32 v246, v246, v225, v225
  v_fma_f32 v247, v247, v225, v225
  v_fma_f32 v248, v248, v225, v225
  v_fma_f32 v249, v249, v225, v225
  s_waitcnt lgkmcnt(2)
  v_mfma_f32_32x32x16_bf16 v[96:111], v[192:195], a[64:67], v[96:111]
  ds_read_b64_tr_b16 v[200:201], v211 offset:8192
  ds_read_b64_tr_b16 v[202:203], v211 offset:8704
  v_rcp_f32 v246, v246
  v_mfma_f32_32x32x16_bf16 v[112:127], v[192:195], a[68:71], v[112:127]
  ds_read_b64_tr_b16 v[204:205], v211 offset:12288
  ds_read_b64_tr_b16 v[206:207], v211 offset:12800
  v_rcp_f32 v247, v247
  s_waitcnt lgkmcnt(4)
  v_mfma_f32_32x32x16_bf16 v[96:111], v[196:199], a[72:75], v[96:111]
  v_rcp_f32 v248, v248
  v_rcp_f32 v249, v249
  v_mul_f32 v180, v180, v246
  v_mfma_f32_32x32x16_bf16 v[112:127], v[196:199], a[76:79], v[112:127]
  v_mul_f32 v181, v181, v247
  v_mul_f32 v182, v182, v248
  v_mul_f32 v183, v183, v249
  v_cvt_pk_bf16_f32 v186, v180, v181
  v_cvt_pk_bf16_f32 v187, v182, v183
  s_waitcnt lgkmcnt(2)
  v_mfma_f32_32x32x16_bf16 v[96:111], v[200:203], a[80:83], v[96:111]
  ds_read_b64_tr_b16 v[192:193], v211 offset:16384
  ds_read_b64_tr_b16 v[194:195], v211 offset:16896
  s_add_u32 s63, s52, 0x1b000
  buffer_store_dwordx4 v[184:187], v218, s[36:39], s63 offen sc1
  v_mul_f32 v246, v64, v64
  v_mfma_f32_32x32x16_bf16 v[112:127], v[200:203], a[84:87], v[112:127]
  ds_read_b64_tr_b16 v[196:197], v211 offset:20480
  ds_read_b64_tr_b16 v[198:199], v211 offset:20992
  v_mul_f32 v247, v65, v65
  v_mul_f32 v248, v66, v66
  v_mul_f32 v249, v67, v67
  s_waitcnt lgkmcnt(4)
  v_mfma_f32_32x32x16_bf16 v[96:111], v[204:207], a[88:91], v[96:111]
  v_fma_f32 v246, v246, v221, v220
  v_fma_f32 v247, v247, v221, v220
  v_fma_f32 v248, v248, v221, v220
  v_fma_f32 v249, v249, v221, v220
  v_mul_f32 v246, v246, v64
  v_mfma_f32_32x32x16_bf16 v[112:127], v[204:207], a[92:95], v[112:127]
  v_mul_f32 v247, v247, v65
  v_mul_f32 v248, v248, v66
  v_mul_f32 v249, v249, v67
  v_exp_f32 v246, v246
  s_waitcnt lgkmcnt(2)
  v_mfma_f32_32x32x16_bf16 v[96:111], v[192:195], a[96:99], v[96:111]
  ds_read_b64_tr_b16 v[200:201], v211 offset:24576
  ds_read_b64_tr_b16 v[202:203], v211 offset:25088
  v_mul_f32 v64, v64, v72
  v_exp_f32 v247, v247
  v_mfma_f32_32x32x16_bf16 v[112:127], v[192:195], a[100:103], v[112:127]
  ds_read_b64_tr_b16 v[204:205], v211 offset:28672
  ds_read_b64_tr_b16 v[206:207], v211 offset:29184
  v_mul_f32 v65, v65, v73
  v_exp_f32 v248, v248
  s_waitcnt lgkmcnt(4)
  v_mfma_f32_32x32x16_bf16 v[96:111], v[196:199], a[104:107], v[96:111]
  v_mul_f32 v66, v66, v74
  v_exp_f32 v249, v249
  v_mul_f32 v67, v67, v75
  v_fma_f32 v246, v246, v222, v222
  v_mfma_f32_32x32x16_bf16 v[112:127], v[196:199], a[108:111], v[112:127]
  v_fma_f32 v247, v247, v222, v222
  v_fma_f32 v248, v248, v222, v222
  v_fma_f32 v249, v249, v222, v222
  v_rcp_f32 v246, v246
  s_waitcnt lgkmcnt(2)
  v_mfma_f32_32x32x16_bf16 v[96:111], v[200:203], a[112:115], v[96:111]
  ds_read_b64_tr_b16 v[192:193], v211 offset:32768
  ds_read_b64_tr_b16 v[194:195], v211 offset:33280
  v_rcp_f32 v247, v247
  v_mfma_f32_32x32x16_bf16 v[112:127], v[200:203], a[116:119], v[112:127]
  ds_read_b64_tr_b16 v[196:197], v211 offset:36864
  ds_read_b64_tr_b16 v[198:199], v211 offset:37376
  v_rcp_f32 v248, v248
  s_waitcnt lgkmcnt(4)
  v_mfma_f32_32x32x16_bf16 v[96:111], v[204:207], a[120:123], v[96:111]
  v_rcp_f32 v249, v249
  v_mul_f32 v64, v64, v246
  v_mul_f32 v65, v65, v247
  v_mul_f32 v66, v66, v248
  v_mfma_f32_32x32x16_bf16 v[112:127], v[204:207], a[124:127], v[112:127]
  v_mul_f32 v67, v67, v249
  v_cvt_pk_bf16_f32 v72, v64, v65
  v_cvt_pk_bf16_f32 v73, v66, v67
  v_mul_f32 v246, v68, v68
  v_mul_f32 v247, v69, v69
  s_waitcnt lgkmcnt(2)
  v_mfma_f32_32x32x16_bf16 v[96:111], v[192:195], a[128:131], v[96:111]
  ds_read_b64_tr_b16 v[200:201], v211 offset:40960
  ds_read_b64_tr_b16 v[202:203], v211 offset:41472
  v_mul_f32 v248, v70, v70
  v_mul_f32 v249, v71, v71
  v_fma_f32 v246, v246, v221, v220
  v_mfma_f32_32x32x16_bf16 v[112:127], v[192:195], a[132:135], v[112:127]
  ds_read_b64_tr_b16 v[204:205], v211 offset:45056
  ds_read_b64_tr_b16 v[206:207], v211 offset:45568
  v_fma_f32 v247, v247, v221, v220
  v_fma_f32 v248, v248, v221, v220
  v_fma_f32 v249, v249, v221, v220
  s_waitcnt lgkmcnt(4)
  v_mfma_f32_32x32x16_bf16 v[96:111], v[196:199], a[136:139], v[96:111]
  v_mul_f32 v246, v246, v68
  v_mul_f32 v247, v247, v69
  v_mul_f32 v248, v248, v70
  v_mul_f32 v249, v249, v71
  v_mfma_f32_32x32x16_bf16 v[112:127], v[196:199], a[140:143], v[112:127]
  v_exp_f32 v246, v246
  v_mul_f32 v68, v68, v76
  v_exp_f32 v247, v247
  s_waitcnt lgkmcnt(2)
  v_mfma_f32_32x32x16_bf16 v[96:111], v[200:203], a[144:147], v[96:111]
  ds_read_b64_tr_b16 v[192:193], v211 offset:49152
  ds_read_b64_tr_b16 v[194:195], v211 offset:49664
  v_mul_f32 v69, v69, v77
  v_exp_f32 v248, v248
  v_mfma_f32_32x32x16_bf16 v[112:127], v[200:203], a[148:151], v[112:127]
  ds_read_b64_tr_b16 v[196:197], v211 offset:53248
  ds_read_b64_tr_b16 v[198:199], v211 offset:53760
  v_mul_f32 v70, v70, v78
  v_exp_f32 v249, v249
  s_waitcnt lgkmcnt(4)
  v_mfma_f32_32x32x16_bf16 v[96:111], v[204:207], a[152:155], v[96:111]
  v_mul_f32 v71, v71, v79
  v_fma_f32 v246, v246, v222, v222
  v_fma_f32 v247, v247, v222, v222
  v_fma_f32 v248, v248, v222, v222
  v_fma_f32 v249, v249, v222, v222
  v_mfma_f32_32x32x16_bf16 v[112:127], v[204:207], a[156:159], v[112:127]
  v_rcp_f32 v246, v246
  v_rcp_f32 v247, v247
  s_waitcnt lgkmcnt(2)
  v_mfma_f32_32x32x16_bf16 v[96:111], v[192:195], a[160:163], v[96:111]
  ds_read_b64_tr_b16 v[200:201], v211 offset:57344
  ds_read_b64_tr_b16 v[202:203], v211 offset:57856
  v_rcp_f32 v248, v248
  v_mfma_f32_32x32x16_bf16 v[112:127], v[192:195], a[164:167], v[112:127]
  ds_read_b64_tr_b16 v[204:205], v211 offset:61440
  ds_read_b64_tr_b16 v[206:207], v211 offset:61952
  v_rcp_f32 v249, v249
  v_mul_f32 v68, v68, v246
  s_waitcnt lgkmcnt(4)
  v_mfma_f32_32x32x16_bf16 v[96:111], v[196:199], a[168:171], v[96:111]
  v_mul_f32 v69, v69, v247
  v_mul_f32 v70, v70, v248
  v_mul_f32 v71, v71, v249
  v_cvt_pk_bf16_f32 v74, v68, v69
  v_cvt_pk_bf16_f32 v75, v70, v71
  v_mfma_f32_32x32x16_bf16 v[112:127], v[196:199], a[172:175], v[112:127]
  s_add_u32 s60, s50, 0
  buffer_store_dwordx4 v[72:75], v218, s[36:39], s60 offen sc1
  v_mul_f32 v246, v80, v80
  v_mul_f32 v247, v81, v81
  v_mul_f32 v248, v82, v82
  s_waitcnt lgkmcnt(2)
  v_mfma_f32_32x32x16_bf16 v[96:111], v[200:203], a[176:179], v[96:111]
  ds_read_b64_tr_b16 v[192:193], v213 offset:0
  ds_read_b64_tr_b16 v[194:195], v213 offset:512
  v_mul_f32 v249, v83, v83
  v_fma_f32 v246, v246, v224, v223
  v_fma_f32 v247, v247, v224, v223
  v_mfma_f32_32x32x16_bf16 v[112:127], v[200:203], a[180:183], v[112:127]
  ds_read_b64_tr_b16 v[196:197], v213 offset:4096
  ds_read_b64_tr_b16 v[198:199], v213 offset:4608
  v_fma_f32 v248, v248, v224, v223
  v_fma_f32 v249, v249, v224, v223
  v_mul_f32 v246, v246, v80
  s_waitcnt lgkmcnt(4)
  v_mfma_f32_32x32x16_bf16 v[96:111], v[204:207], a[184:187], v[96:111]
  v_mul_f32 v247, v247, v81
  v_mul_f32 v248, v248, v82
  v_mul_f32 v249, v249, v83
  v_exp_f32 v246, v246
  v_mfma_f32_32x32x16_bf16 v[112:127], v[204:207], a[188:191], v[112:127]
  v_mul_f32 v80, v80, v88
  v_exp_f32 v247, v247
  v_mul_f32 v81, v81, v89
  s_waitcnt lgkmcnt(2)
  v_mfma_f32_32x32x16_bf16 v[96:111], v[192:195], a[192:195], v[96:111]
  ds_read_b64_tr_b16 v[200:201], v213 offset:8192
  ds_read_b64_tr_b16 v[202:203], v213 offset:8704
  v_exp_f32 v248, v248
  v_mul_f32 v82, v82, v90
  v_mfma_f32_32x32x16_bf16 v[112:127], v[192:195], a[196:199], v[112:127]
  ds_read_b64_tr_b16 v[204:205], v213 offset:12288
  ds_read_b64_tr_b16 v[206:207], v213 offset:12800
  v_exp_f32 v249, v249
  v_mul_f32 v83, v83, v91
  s_waitcnt lgkmcnt(4)
  v_mfma_f32_32x32x16_bf16 v[96:111], v[196:199], a[200:203], v[96:111]
  v_fma_f32 v246, v246, v225, v225
  v_fma_f32 v247, v247, v225, v225
  v_fma_f32 v248, v248, v225, v225
  v_fma_f32 v249, v249, v225, v225
  v_mfma_f32_32x32x16_bf16 v[112:127], v[196:199], a[204:207], v[112:127]
  v_rcp_f32 v246, v246
  v_rcp_f32 v247, v247
  s_waitcnt lgkmcnt(2)
  v_mfma_f32_32x32x16_bf16 v[96:111], v[200:203], a[208:211], v[96:111]
  ds_read_b64_tr_b16 v[192:193], v213 offset:16384
  ds_read_b64_tr_b16 v[194:195], v213 offset:16896
  v_rcp_f32 v248, v248
  v_mfma_f32_32x32x16_bf16 v[112:127], v[200:203], a[212:215], v[112:127]
  ds_read_b64_tr_b16 v[196:197], v213 offset:20480
  ds_read_b64_tr_b16 v[198:199], v213 offset:20992
  v_rcp_f32 v249, v249
  v_mul_f32 v80, v80, v246
  s_waitcnt lgkmcnt(4)
  v_mfma_f32_32x32x16_bf16 v[96:111], v[204:207], a[216:219], v[96:111]
  v_mul_f32 v81, v81, v247
  v_mul_f32 v82, v82, v248
  v_mul_f32 v83, v83, v249
  v_cvt_pk_bf16_f32 v88, v80, v81
  v_cvt_pk_bf16_f32 v89, v82, v83
  v_mfma_f32_32x32x16_bf16 v[112:127], v[204:207], a[220:223], v[112:127]
  v_mul_f32 v246, v84, v84
  v_mul_f32 v247, v85, v85
  v_mul_f32 v248, v86, v86
  v_mul_f32 v249, v87, v87
  v_fma_f32 v246, v246, v224, v223
  s_waitcnt lgkmcnt(2)
  v_mfma_f32_32x32x16_bf16 v[96:111], v[192:195], a[224:227], v[96:111]
  ds_read_b64_tr_b16 v[200:201], v213 offset:24576
  ds_read_b64_tr_b16 v[202:203], v213 offset:25088
  v_fma_f32 v247, v247, v224, v223
  v_fma_f32 v248, v248, v224, v223
  v_fma_f32 v249, v249, v224, v223
  v_mfma_f32_32x32x16_bf16 v[112:127], v[192:195], a[228:231], v[112:127]
  ds_read_b64_tr_b16 v[204:205], v213 offset:28672
  ds_read_b64_tr_b16 v[206:207], v213 offset:29184
  v_mul_f32 v246, v246, v84
  v_mul_f32 v247, v247, v85
  v_mul_f32 v248, v248, v86
  s_waitcnt lgkmcnt(4)
  v_mfma_f32_32x32x16_bf16 v[96:111], v[196:199], a[232:235], v[96:111]
  v_mul_f32 v249, v249, v87
  v_exp_f32 v246, v246
  v_mul_f32 v84, v84, v92
  v_mfma_f32_32x32x16_bf16 v[112:127], v[196:199], a[236:239], v[112:127]
  v_exp_f32 v247, v247
  v_mul_f32 v85, v85, v93
  v_exp_f32 v248, v248
  s_waitcnt lgkmcnt(2)
  v_mfma_f32_32x32x16_bf16 v[96:111], v[200:203], a[240:243], v[96:111]
  v_mul_f32 v86, v86, v94
  v_exp_f32 v249, v249
  v_mul_f32 v87, v87, v95
  v_fma_f32 v246, v246, v225, v225
  v_mfma_f32_32x32x16_bf16 v[112:127], v[200:203], a[244:247], v[112:127]
  v_fma_f32 v247, v247, v225, v225
  v_fma_f32 v248, v248, v225, v225
  v_fma_f32 v249, v249, v225, v225
  v_rcp_f32 v246, v246
  s_waitcnt lgkmcnt(0)
  v_mfma_f32_32x32x16_bf16 v[96:111], v[204:207], a[248:251], v[96:111]
  v_rcp_f32 v247, v247
  v_rcp_f32 v248, v248
  v_mfma_f32_32x32x16_bf16 v[112:127], v[204:207], a[252:255], v[112:127]
  v_rcp_f32 v249, v249
  v_mul_f32 v84, v84, v246
  v_mul_f32 v85, v85, v247
  v_mul_f32 v86, v86, v248
  v_mul_f32 v87, v87, v249
  v_cvt_pk_bf16_f32 v90, v84, v85
  v_cvt_pk_bf16_f32 v91, v86, v87
  s_add_u32 s61, s50, 0x1b000
  buffer_store_dwordx4 v[88:91], v218, s[36:39], s61 offen sc1
  v_pk_mul_f32 v[192:193], v[96:97], v[96:97]
  v_pk_mul_f32 v[194:195], v[98:99], v[98:99]
  v_pk_mul_f32 v[196:197], v[100:101], v[100:101]
  v_pk_mul_f32 v[198:199], v[102:103], v[102:103]
  v_pk_fma_f32 v[192:193], v[192:193], v[220:221], v[220:221] op_sel:[0,1,0] op_sel_hi:[1,1,0]
  v_pk_fma_f32 v[194:195], v[194:195], v[220:221], v[220:221] op_sel:[0,1,0] op_sel_hi:[1,1,0]
  v_pk_fma_f32 v[196:197], v[196:197], v[220:221], v[220:221] op_sel:[0,1,0] op_sel_hi:[1,1,0]
  v_pk_fma_f32 v[198:199], v[198:199], v[220:221], v[220:221] op_sel:[0,1,0] op_sel_hi:[1,1,0]
  v_pk_mul_f32 v[192:193], v[192:193], v[96:97]
  v_pk_mul_f32 v[194:195], v[194:195], v[98:99]
  v_pk_mul_f32 v[196:197], v[196:197], v[100:101]
  v_pk_mul_f32 v[198:199], v[198:199], v[102:103]
  v_exp_f32 v192, v192
  v_exp_f32 v193, v193
  v_pk_mul_f32 v[96:97], v[96:97], v[104:105]
  v_exp_f32 v194, v194
  v_exp_f32 v195, v195
  v_pk_mul_f32 v[98:99], v[98:99], v[106:107]
  v_exp_f32 v196, v196
  v_exp_f32 v197, v197
  v_pk_mul_f32 v[100:101], v[100:101], v[108:109]
  v_exp_f32 v198, v198
  v_exp_f32 v199, v199
  v_pk_mul_f32 v[102:103], v[102:103], v[110:111]
  v_pk_fma_f32 v[192:193], v[192:193], v[222:223], v[222:223] op_sel:[0,0,0] op_sel_hi:[1,0,0]
  v_pk_fma_f32 v[194:195], v[194:195], v[222:223], v[222:223] op_sel:[0,0,0] op_sel_hi:[1,0,0]
  v_pk_fma_f32 v[196:197], v[196:197], v[222:223], v[222:223] op_sel:[0,0,0] op_sel_hi:[1,0,0]
  v_pk_fma_f32 v[198:199], v[198:199], v[222:223], v[222:223] op_sel:[0,0,0] op_sel_hi:[1,0,0]
  v_rcp_f32 v192, v192
  v_rcp_f32 v193, v193
  v_rcp_f32 v194, v194
  v_rcp_f32 v195, v195
  v_rcp_f32 v196, v196
  v_rcp_f32 v197, v197
  v_rcp_f32 v198, v198
  v_rcp_f32 v199, v199
  v_pk_mul_f32 v[96:97], v[96:97], v[192:193]
  v_pk_mul_f32 v[98:99], v[98:99], v[194:195]
  v_pk_mul_f32 v[100:101], v[100:101], v[196:197]
  v_pk_mul_f32 v[102:103], v[102:103], v[198:199]
  v_cvt_pk_bf16_f32 v104, v96, v97
  v_cvt_pk_bf16_f32 v105, v98, v99
  v_cvt_pk_bf16_f32 v106, v100, v101
  v_cvt_pk_bf16_f32 v107, v102, v103
  s_add_u32 s62, s53, 0
  buffer_store_dwordx4 v[104:107], v218, s[36:39], s62 offen sc1
  v_pk_mul_f32 v[200:201], v[112:113], v[112:113]
  v_pk_mul_f32 v[202:203], v[114:115], v[114:115]
  v_pk_mul_f32 v[204:205], v[116:117], v[116:117]
  v_pk_mul_f32 v[206:207], v[118:119], v[118:119]
  v_pk_fma_f32 v[200:201], v[200:201], v[224:225], v[222:223] op_sel:[0,0,1] op_sel_hi:[1,0,1]
  v_pk_fma_f32 v[202:203], v[202:203], v[224:225], v[222:223] op_sel:[0,0,1] op_sel_hi:[1,0,1]
  v_pk_fma_f32 v[204:205], v[204:205], v[224:225], v[222:223] op_sel:[0,0,1] op_sel_hi:[1,0,1]
  v_pk_fma_f32 v[206:207], v[206:207], v[224:225], v[222:223] op_sel:[0,0,1] op_sel_hi:[1,0,1]
  v_pk_mul_f32 v[200:201], v[200:201], v[112:113]
  v_pk_mul_f32 v[202:203], v[202:203], v[114:115]
  v_pk_mul_f32 v[204:205], v[204:205], v[116:117]
  v_pk_mul_f32 v[206:207], v[206:207], v[118:119]
  v_exp_f32 v200, v200
  v_exp_f32 v201, v201
  v_pk_mul_f32 v[112:113], v[112:113], v[120:121]
  v_exp_f32 v202, v202
  v_exp_f32 v203, v203
  v_pk_mul_f32 v[114:115], v[114:115], v[122:123]
  v_exp_f32 v204, v204
  v_exp_f32 v205, v205
  v_pk_mul_f32 v[116:117], v[116:117], v[124:125]
  v_exp_f32 v206, v206
  v_exp_f32 v207, v207
  v_pk_mul_f32 v[118:119], v[118:119], v[126:127]
  v_pk_fma_f32 v[200:201], v[200:201], v[224:225], v[224:225] op_sel:[0,1,1] op_sel_hi:[1,1,1]
  v_pk_fma_f32 v[202:203], v[202:203], v[224:225], v[224:225] op_sel:[0,1,1] op_sel_hi:[1,1,1]
  v_pk_fma_f32 v[204:205], v[204:205], v[224:225], v[224:225] op_sel:[0,1,1] op_sel_hi:[1,1,1]
  v_pk_fma_f32 v[206:207], v[206:207], v[224:225], v[224:225] op_sel:[0,1,1] op_sel_hi:[1,1,1]
  v_rcp_f32 v200, v200
  v_rcp_f32 v201, v201
  v_rcp_f32 v202, v202
  v_rcp_f32 v203, v203
  v_rcp_f32 v204, v204
  v_rcp_f32 v205, v205
  v_rcp_f32 v206, v206
  v_rcp_f32 v207, v207
  v_pk_mul_f32 v[112:113], v[112:113], v[200:201]
  v_pk_mul_f32 v[114:115], v[114:115], v[202:203]
  v_pk_mul_f32 v[116:117], v[116:117], v[204:205]
  v_pk_mul_f32 v[118:119], v[118:119], v[206:207]
  v_cvt_pk_bf16_f32 v120, v112, v113
  v_cvt_pk_bf16_f32 v121, v114, v115
  v_cvt_pk_bf16_f32 v122, v116, v117
  v_cvt_pk_bf16_f32 v123, v118, v119
  s_add_u32 s63, s53, 0x1b000
  buffer_store_dwordx4 v[120:123], v218, s[36:39], s63 offen sc1
  s_endpgm
gu_poll0:
  s_mov_b32 s66, 0x4000
gu_poll0_l:
  s_sleep 8
  buffer_load_dword v255, v254, s[8:11], 0 offen offset:0 sc1
  s_waitcnt vmcnt(0)
  v_readlane_b32 s100, v255, 0
  v_readlane_b32 s101, v255, 1
  s_nop 0
  s_min_u32 s100, s100, s101
  v_readlane_b32 s101, v255, 2
  s_nop 0
  s_min_u32 s100, s100, s101
  s_sub_u32 s66, s66, 1
  s_cbranch_scc1 gu_poll0_d
  s_cmp_lt_u32 s100, 10
  s_cbranch_scc1 gu_poll0_l
  s_branch gu_poll0_d
gu_cs1:
  s_mov_b32 s66, 0x4000
gu_cs1_l:
  s_sleep 4
  s_add_u32 s67, s55, 0x1400
  buffer_load_dword v238, v219, s[36:39], s67 offen offset:0 sc1
  buffer_load_dword v239, v219, s[36:39], s67 offen offset:128 sc1
  s_waitcnt vmcnt(0)
  s_sub_u32 s66, s66, 1
  s_cbranch_scc1 gu_cs1_d
  v_max_u32 v226, v238, v239
  v_cmp_eq_u32 vcc, -1, v226
  s_nop 0
  s_cmp_lg_u64 vcc, 0
  s_cbranch_scc1 gu_cs1_l
  s_branch gu_cs1_d
gu_cs2:
  s_mov_b32 s66, 0x4000
gu_cs2_l:
  s_sleep 4
  s_add_u32 s67, s55, 0x2800
  buffer_load_dword v240, v219, s[36:39], s67 offen offset:0 sc1
  buffer_load_dword v241, v219, s[36:39], s67 offen offset:128 sc1
  s_waitcnt vmcnt(0)
  s_sub_u32 s66, s66, 1
  s_cbranch_scc1 gu_cs2_d
  v_max_u32 v226, v240, v241
  v_cmp_eq_u32 vcc, -1, v226
  s_nop 0
  s_cmp_lg_u64 vcc, 0
  s_cbranch_scc1 gu_cs2_l
  s_branch gu_cs2_d
k1_qkv:
  s_mul_i32 s59, s73, 0x3c000
  s_sub_u32 s28, s6, 0x2000
  s_subb_u32 s29, s7, 0
  s_mov_b32 s30, 0x25a000
  s_mov_b32 s31, 0x20000
  v_mov_b32 v214, v240
  v_mov_b32 v215, v241
  v_mov_b32 v216, v242
  v_mov_b32 v217, v243
  s_lshl_b32 s45, s69, 9
  s_add_u32 s46, s45, 0x100
  s_lshl_b32 s47, s69, 8
  s_add_u32 s47, s47, 0xa00
  s_add_u32 m0, s41, 0
  s_nop 0
  buffer_load_dwordx4 v140, s[24:27], s58 offen offset:0 lds
  buffer_load_dwordx4 v141, s[24:27], s58 offen offset:1024 lds
  buffer_load_dwordx4 v142, s[24:27], s58 offen offset:2048 lds
  buffer_load_dwordx4 v143, s[24:27], s58 offen offset:3072 lds
  s_add_u32 s58, s58, 0x80
  s_cmp_eq_u32 s58, 0x500
  s_cselect_b32 s58, 0, s58
  s_add_u32 m0, s41, 0x4000
  s_add_u32 s44, s45, s59
  buffer_load_dwordx4 v214, s[28:31], s44 offen offset:0 lds
  buffer_load_dwordx4 v215, s[28:31], s44 offen offset:1024 lds
  s_add_u32 s59, s59, 0x3c000
  buffer_load_dwordx4 v216, s[28:31], s44 offen offset:2048 lds
  s_cmp_eq_u32 s59, 0x258000
  s_cselect_b32 s59, 0, s59
  buffer_load_dwordx4 v217, s[28:31], s44 offen offset:3072 lds
  s_mov_b32 s36, s22
  s_mov_b32 s37, s23
  s_mov_b32 s38, 0x10000000
  s_mov_b32 s39, 0x20000
  s_lshl_b32 s72, s68, 2
  s_lshl_b32 s60, s70, 1
  s_add_u32 s72, s72, s60
  v_and_b32 v246, 31, v236
  v_lshlrev_b32 v252, 2, v246
  v_lshrrev_b32 v247, 1, v246
  v_and_b32 v247, 7, v247
  v_lshrrev_b32 v248, 5, v236
  v_xor_b32 v249, s70, v248
  v_mul_u32_u24 v249, 0x500, v249
  v_add_u32 v219, v252, v249
  v_xor_b32 v247, v247, v248
  v_lshlrev_b32 v247, 4, v247
  v_lshl_add_u32 v246, v246, 7, v247
  s_lshl_b32 s60, s70, 13
  v_add_u32 v246, s60, v246
  v_xor_b32 v128, 0, v246
  v_add_u32 v132, 0x10000, v128
  v_add_u32 v136, 0x20000, v128
  v_xor_b32 v129, 32, v246
  v_add_u32 v133, 0x10000, v129
  v_add_u32 v137, 0x20000, v129
  v_xor_b32 v130, 64, v246
  v_add_u32 v134, 0x10000, v130
  v_add_u32 v138, 0x20000, v130
  v_xor_b32 v131, 0x60, v246
  v_add_u32 v135, 0x10000, v131
  v_add_u32 v139, 0x20000, v131
  v_lshrrev_b32 v246, 4, v236
  v_and_b32 v246, 1, v246
  v_lshrrev_b32 v247, 2, v236
  v_and_b32 v247, 3, v247
  v_lshrrev_b32 v248, 5, v236
  v_lshl_add_u32 v248, v248, 3, v247
  v_lshlrev_b32 v248, 7, v248
  v_lshl_add_u32 v248, v246, 11, v248
  v_lshrrev_b32 v247, 1, v247
  v_lshl_add_u32 v247, v246, 1, v247
  s_lshl_b32 s60, s71, 1
  s_add_u32 s60, s60, s70
  v_xor_b32 v247, s60, v247
  v_lshl_add_u32 v248, v247, 5, v248
  v_and_b32 v246, 1, v236
  v_lshlrev_b32 v246, 1, v246
  v_bfe_u32 v247, v236, 1, 1
  v_or_b32 v249, v246, v247
  v_lshl_add_u32 v208, v249, 3, v248
  v_xor_b32 v209, 32, v208
  v_add_u32 v210, 0x10000, v208
  v_add_u32 v211, 0x10000, v209
  v_add_u32 v212, 0x20000, v208
  v_add_u32 v213, 0x20000, v209
  s_mul_i32 s61, s69, 12
  s_add_u32 s60, s60, s61
  s_mul_i32 s54, s60, 0x500
  s_lshl_b32 s62, s73, 7
  s_add_u32 s54, s54, s62
  s_add_u32 s54, s54, 0x1404000
  s_sub_u32 s60, s60, s70
  s_mul_i32 s55, s60, 0x500
  s_add_u32 s55, s55, 0x1404000
  s_mul_i32 s56, s72, 0x500
  s_add_u32 s56, s56, 0x1440000
  s_mul_i32 s60, s71, 5
  s_add_u32 s60, s60, s69
  s_lshl_b32 s60, s60, 8
  s_add_u32 s57, s56, s60
  s_mov_b32 s16, s22
  s_mov_b32 s17, s23
  s_mov_b32 s18, 0x10000000
  s_mov_b32 s19, 0x20000
  s_mov_b32 s8, s20
  s_mov_b32 s9, s21
  s_mov_b32 s10, 0x100
  s_mov_b32 s11, 0x20000
  s_sub_u32 s60, s68, 8
  s_cmp_lt_u32 s60, 6
  s_cselect_b32 s18, 0, 0x10000000
  s_lshr_b32 s62, s69, 1
  s_lshl_b32 s62, s62, 4
  s_lshl_b32 s61, s69, 3
  s_add_u32 s61, s61, s62
  s_add_u32 s61, s61, 8
  s_lshr_b32 s62, s68, 1
  s_mul_i32 s62, s62, 24
  s_lshl_b32 s63, s68, 2
  s_add_u32 s62, s62, s63
  s_cmp_eq_u32 s40, 0
  s_cselect_b32 s63, s61, 0x40000000
  s_cselect_b32 s64, s62, 0x40000000
  s_cselect_b32 s76, 10, 0
  v_mov_b32 v254, 0x40000000
  v_writelane_b32 v254, s63, 0
  v_writelane_b32 v254, s64, 1
  s_add_u32 s63, s63, 4
  v_writelane_b32 v254, s63, 2
  s_cmp_lt_u32 s60, 6
  s_cselect_b32 s61, 0x40000000, s61
  s_cmp_lt_u32 s69, 5
  s_cselect_b32 s62, s62, 0x40000000
  s_cmp_eq_u32 s40, 0
  s_cselect_b32 s61, s61, 0x40000000
  s_cselect_b32 s62, s62, 0x40000000
  v_mov_b32 v253, 0x40000000
  v_writelane_b32 v253, s61, 0
  v_writelane_b32 v253, s62, 1
  s_mul_i32 s64, s72, 0x14000
  s_lshl_b32 s65, s71, 11
  s_add_u32 s64, s64, s65
  s_lshl_b32 s62, s70, 10
  s_xor_b32 s63, s62, 0x400
  s_lshl_b32 s65, s45, 5
  s_add_u32 s65, s65, s64
  s_add_u32 s48, s65, s62
  s_add_u32 s51, s65, s63
  s_cmp_lt_u32 s45, 0x500
  s_cselect_b32 s78, 0x3ea52b5c, 0x3f800000
  s_lshl_b32 s65, s46, 5
  s_add_u32 s65, s65, s64
  s_add_u32 s49, s65, s62
  s_add_u32 s52, s65, s63
  s_cmp_lt_u32 s46, 0x500
  s_cselect_b32 s79, 0x3ea52b5c, 0x3f800000
  s_mul_i32 s64, s72, 0xa000
  s_lshl_b32 s65, s69, 11
  s_add_u32 s64, s64, s65
  s_lshl_b32 s65, s71, 9
  s_add_u32 s64, s64, s65
  s_add_u32 s64, s64, 0x500000
  s_lshl_b32 s62, s70, 8
  s_xor_b32 s63, s62, 0x100
  s_add_u32 s50, s64, s62
  s_add_u32 s53, s64, s63
  v_bfe_u32 v248, v236, 2, 1
  v_lshlrev_b32 v248, 1, v248
  v_bfe_u32 v249, v236, 3, 1
  v_or_b32 v248, v248, v249
  v_and_b32 v249, 3, v236
  v_lshl_add_u32 v248, v248, 2, v249
  v_bfe_u32 v249, v236, 4, 1
  v_lshl_add_u32 v248, v249, 6, v248
  v_lshrrev_b32 v249, 5, v236
  v_lshlrev_b32 v251, 4, v249
  v_mul_u32_u24 v249, 0x2800, v249
  v_lshl_add_u32 v250, v248, 4, v249
  s_mov_b32 s74, 0x3f803f80
  s_add_u32 m0, s41, 0x8000
  s_nop 0
  buffer_load_dwordx4 v140, s[24:27], s58 offen offset:0 lds
  buffer_load_dwordx4 v141, s[24:27], s58 offen offset:1024 lds
  buffer_load_dwordx4 v142, s[24:27], s58 offen offset:2048 lds
  buffer_load_dwordx4 v143, s[24:27], s58 offen offset:3072 lds
  s_add_u32 s58, s58, 0x80
  s_cmp_eq_u32 s58, 0x500
  s_cselect_b32 s58, 0, s58
  s_add_u32 m0, s41, 0xc000
  s_add_u32 s44, s45, s59
  buffer_load_dwordx4 v214, s[28:31], s44 offen offset:0 lds
  buffer_load_dwordx4 v215, s[28:31], s44 offen offset:1024 lds
  s_add_u32 s59, s59, 0x3c000
  buffer_load_dwordx4 v216, s[28:31], s44 offen offset:2048 lds
  s_cmp_eq_u32 s59, 0x258000
  s_cselect_b32 s59, 0, s59
  buffer_load_dwordx4 v217, s[28:31], s44 offen offset:3072 lds
  s_waitcnt vmcnt(8)
  s_barrier
  ds_read_b64_tr_b16 v[192:193], v208 offset:16384
  ds_read_b64_tr_b16 v[194:195], v208 offset:16896
  ds_read_b128 v[0:3], v128 offset:0
  ds_read_b128 v[4:7], v128 offset:4096
  ds_read_b64_tr_b16 v[196:197], v209 offset:16384
  ds_read_b64_tr_b16 v[198:199], v209 offset:16896
  ds_read_b128 v[8:11], v129 offset:0
  ds_read_b128 v[12:15], v129 offset:4096
  s_waitcnt lgkmcnt(5)
  v_mfma_f32_32x32x16_bf16 v[64:79], v[192:195], v[0:3], 0
  ds_read_b64_tr_b16 v[200:201], v208 offset:20480
  ds_read_b64_tr_b16 v[202:203], v208 offset:20992
  s_add_u32 m0, s41, 0x10000
  s_nop 0
  buffer_load_dwordx4 v140, s[24:27], s58 offen offset:0 lds
  s_waitcnt lgkmcnt(6)
  v_mfma_f32_32x32x16_bf16 v[80:95], v[192:195], v[4:7], 0
  ds_read_b64_tr_b16 v[204:205], v209 offset:20480
  ds_read_b64_tr_b16 v[206:207], v209 offset:20992
  buffer_load_dwordx4 v141, s[24:27], s58 offen offset:1024 lds
  s_waitcnt lgkmcnt(6)
  v_mfma_f32_32x32x16_bf16 v[96:111], v[196:199], v[0:3], 0
  ds_read_b128 v[16:19], v130 offset:0
  v_dot2_f32_bf16 v222, v192, s74, 0
  v_dot2_f32_bf16 v225, v193, s74, 0
  buffer_load_dwordx4 v142, s[24:27], s58 offen offset:2048 lds
  v_mfma_f32_32x32x16_bf16 v[112:127], v[196:199], v[4:7], 0
  ds_read_b128 v[20:23], v130 offset:4096
  v_dot2_f32_bf16 v222, v194, s74, v222
  v_dot2_f32_bf16 v225, v195, s74, v225
  buffer_load_dwordx4 v143, s[24:27], s58 offen offset:3072 lds
  s_add_u32 s58, s58, 0x80
  s_cmp_eq_u32 s58, 0x500
  s_cselect_b32 s58, 0, s58
  s_waitcnt lgkmcnt(4)
  v_mfma_f32_32x32x16_bf16 v[64:79], v[200:203], v[8:11], v[64:79]
  ds_read_b64_tr_b16 v[192:193], v208 offset:24576
  ds_read_b64_tr_b16 v[194:195], v208 offset:25088
  ds_read_b128 v[24:27], v131 offset:0
  s_add_u32 m0, s41, 0x14000
  s_add_u32 s44, s45, s59
  buffer_load_dwordx4 v214, s[28:31], s44 offen offset:0 lds
  v_mfma_f32_32x32x16_bf16 v[80:95], v[200:203], v[12:15], v[80:95]
  ds_read_b64_tr_b16 v[196:197], v209 offset:24576
  ds_read_b64_tr_b16 v[198:199], v209 offset:25088
  ds_read_b128 v[28:31], v131 offset:4096
  buffer_load_dwordx4 v215, s[28:31], s44 offen offset:1024 lds
  s_add_u32 s59, s59, 0x3c000
  s_waitcnt lgkmcnt(8)
  v_mfma_f32_32x32x16_bf16 v[96:111], v[204:207], v[8:11], v[96:111]
  v_dot2_f32_bf16 v222, v200, s74, v222
  v_dot2_f32_bf16 v225, v201, s74, v225
  v_dot2_f32_bf16 v222, v202, s74, v222
  v_dot2_f32_bf16 v225, v203, s74, v225
  buffer_load_dwordx4 v216, s[28:31], s44 offen offset:2048 lds
  s_cmp_eq_u32 s59, 0x258000
  s_cselect_b32 s59, 0, s59
  v_mfma_f32_32x32x16_bf16 v[112:127], v[204:207], v[12:15], v[112:127]
  s_waitcnt vmcnt(7) lgkmcnt(0)
  s_barrier
  v_mfma_f32_32x32x16_bf16 v[64:79], v[192:195], v[16:19], v[64:79]
  ds_read_b64_tr_b16 v[200:201], v208 offset:28672
  ds_read_b64_tr_b16 v[202:203], v208 offset:29184
  buffer_load_dwordx4 v217, s[28:31], s44 offen offset:3072 lds
  v_mfma_f32_32x32x16_bf16 v[80:95], v[192:195], v[20:23], v[80:95]
  ds_read_b64_tr_b16 v[204:205], v209 offset:28672
  ds_read_b64_tr_b16 v[206:207], v209 offset:29184
  s_add_u32 m0, s41, 0x18000
  s_nop 0
  buffer_load_dwordx4 v140, s[24:27], s58 offen offset:0 lds
  v_mfma_f32_32x32x16_bf16 v[96:111], v[196:199], v[16:19], v[96:111]
  ds_read_b128 v[32:35], v128 offset:32768
  v_dot2_f32_bf16 v222, v192, s74, v222
  v_dot2_f32_bf16 v225, v193, s74, v225
  v_mfma_f32_32x32x16_bf16 v[112:127], v[196:199], v[20:23], v[112:127]
  ds_read_b128 v[36:39], v128 offset:36864
  v_dot2_f32_bf16 v222, v194, s74, v222
  v_dot2_f32_bf16 v225, v195, s74, v225
  buffer_load_dwordx4 v141, s[24:27], s58 offen offset:1024 lds
  s_waitcnt lgkmcnt(4)
  v_mfma_f32_32x32x16_bf16 v[64:79], v[200:203], v[24:27], v[64:79]
  ds_read_b64_tr_b16 v[192:193], v208 offset:49152
  ds_read_b64_tr_b16 v[194:195], v208 offset:49664
  v_mfma_f32_32x32x16_bf16 v[80:95], v[200:203], v[28:31], v[80:95]
  ds_read_b64_tr_b16 v[196:197], v209 offset:49152
  ds_read_b64_tr_b16 v[198:199], v209 offset:49664
  buffer_load_dwordx4 v142, s[24:27], s58 offen offset:2048 lds
  s_waitcnt lgkmcnt(6)
  v_mfma_f32_32x32x16_bf16 v[96:111], v[204:207], v[24:27], v[96:111]
  ds_read_b128 v[40:43], v129 offset:32768
  v_dot2_f32_bf16 v222, v200, s74, v222
  v_dot2_f32_bf16 v225, v201, s74, v225
  v_mfma_f32_32x32x16_bf16 v[112:127], v[204:207], v[28:31], v[112:127]
  ds_read_b128 v[44:47], v129 offset:36864
  v_dot2_f32_bf16 v222, v202, s74, v222
  v_dot2_f32_bf16 v225, v203, s74, v225
  buffer_load_dwordx4 v143, s[24:27], s58 offen offset:3072 lds
  s_add_u32 s58, s58, 0x80
  s_cmp_eq_u32 s58, 0x500
  s_cselect_b32 s58, 0, s58
  s_waitcnt lgkmcnt(4)
  v_mfma_f32_32x32x16_bf16 v[64:79], v[192:195], v[32:35], v[64:79]
  ds_read_b64_tr_b16 v[200:201], v208 offset:53248
  ds_read_b64_tr_b16 v[202:203], v208 offset:53760
  v_mfma_f32_32x32x16_bf16 v[80:95], v[192:195], v[36:39], v[80:95]
  ds_read_b64_tr_b16 v[204:205], v209 offset:53248
  ds_read_b64_tr_b16 v[206:207], v209 offset:53760
  s_add_u32 m0, s41, 0x1c000
  s_add_u32 s44, s45, s59
  buffer_load_dwordx4 v214, s[28:31], s44 offen offset:0 lds
  s_waitcnt lgkmcnt(6)
  v_mfma_f32_32x32x16_bf16 v[96:111], v[196:199], v[32:35], v[96:111]
  ds_read_b128 v[48:51], v130 offset:32768
  v_add_f32 v222, v222, v225
  v_mov_b32 v225, v222
  s_nop 0
  s_nop 0
  v_permlane32_swap_b32 v222, v225
  v_add_f32 v222, v222, v225
  buffer_store_dword v222, v252, s[16:19], s54 offen sc1
  v_mfma_f32_32x32x16_bf16 v[112:127], v[196:199], v[36:39], v[112:127]
  ds_read_b128 v[52:55], v130 offset:36864
  buffer_load_dwordx4 v215, s[28:31], s44 offen offset:1024 lds
  s_add_u32 s59, s59, 0x3c000
  s_waitcnt lgkmcnt(4)
  v_mfma_f32_32x32x16_bf16 v[64:79], v[200:203], v[40:43], v[64:79]
  ds_read_b64_tr_b16 v[192:193], v208 offset:57344
  ds_read_b64_tr_b16 v[194:195], v208 offset:57856
  ds_read_b128 v[56:59], v131 offset:32768
  v_mfma_f32_32x32x16_bf16 v[80:95], v[200:203], v[44:47], v[80:95]
  ds_read_b64_tr_b16 v[196:197], v209 offset:57344
  ds_read_b64_tr_b16 v[198:199], v209 offset:57856
  ds_read_b128 v[60:63], v131 offset:36864
  buffer_load_dwordx4 v216, s[28:31], s44 offen offset:2048 lds
  s_cmp_eq_u32 s59, 0x258000
  s_cselect_b32 s59, 0, s59
  s_waitcnt lgkmcnt(8)
  v_mfma_f32_32x32x16_bf16 v[96:111], v[204:207], v[40:43], v[96:111]
  v_mfma_f32_32x32x16_bf16 v[112:127], v[204:207], v[44:47], v[112:127]
  s_waitcnt lgkmcnt(0)
  s_cmp_eq_u32 s71, 1
  s_cbranch_scc1 k1_tok1
  v_dot2_f32_bf16 v236, v0, s74, 0
  v_dot2_f32_bf16 v238, v0, v0, 0
  v_dot2_f32_bf16 v237, v1, s74, 0
  v_dot2_f32_bf16 v239, v1, v1, 0
  v_dot2_f32_bf16 v236, v2, s74, v236
  v_dot2_f32_bf16 v238, v2, v2, v238
  v_dot2_f32_bf16 v237, v3, s74, v237
  v_dot2_f32_bf16 v239, v3, v3, v239
  v_dot2_f32_bf16 v236, v8, s74, v236
  v_dot2_f32_bf16 v238, v8, v8, v238
  v_dot2_f32_bf16 v237, v9, s74, v237
  v_dot2_f32_bf16 v239, v9, v9, v239
  v_dot2_f32_bf16 v236, v10, s74, v236
  v_dot2_f32_bf16 v238, v10, v10, v238
  v_dot2_f32_bf16 v237, v11, s74, v237
  v_dot2_f32_bf16 v239, v11, v11, v239
  v_dot2_f32_bf16 v236, v16, s74, v236
  v_dot2_f32_bf16 v238, v16, v16, v238
  v_dot2_f32_bf16 v237, v17, s74, v237
  v_dot2_f32_bf16 v239, v17, v17, v239
  v_dot2_f32_bf16 v236, v18, s74, v236
  v_dot2_f32_bf16 v238, v18, v18, v238
  v_dot2_f32_bf16 v237, v19, s74, v237
  v_dot2_f32_bf16 v239, v19, v19, v239
  v_dot2_f32_bf16 v236, v24, s74, v236
  v_dot2_f32_bf16 v238, v24, v24, v238
  v_dot2_f32_bf16 v237, v25, s74, v237
  v_dot2_f32_bf16 v239, v25, v25, v239
  v_dot2_f32_bf16 v236, v26, s74, v236
  v_dot2_f32_bf16 v238, v26, v26, v238
  v_dot2_f32_bf16 v237, v27, s74, v237
  v_dot2_f32_bf16 v239, v27, v27, v239
  v_dot2_f32_bf16 v236, v32, s74, v236
  v_dot2_f32_bf16 v238, v32, v32, v238
  v_dot2_f32_bf16 v237, v33, s74, v237
  v_dot2_f32_bf16 v239, v33, v33, v239
  v_dot2_f32_bf16 v236, v34, s74, v236
  v_dot2_f32_bf16 v238, v34, v34, v238
  v_dot2_f32_bf16 v237, v35, s74, v237
  v_dot2_f32_bf16 v239, v35, v35, v239
  v_dot2_f32_bf16 v236, v40, s74, v236
  v_dot2_f32_bf16 v238, v40, v40, v238
  v_dot2_f32_bf16 v237, v41, s74, v237
  v_dot2_f32_bf16 v239, v41, v41, v239
  v_dot2_f32_bf16 v236, v42, s74, v236
  v_dot2_f32_bf16 v238, v42, v42, v238
  v_dot2_f32_bf16 v237, v43, s74, v237
  v_dot2_f32_bf16 v239, v43, v43, v239
  v_dot2_f32_bf16 v236, v48, s74, v236
  v_dot2_f32_bf16 v238, v48, v48, v238
  v_dot2_f32_bf16 v237, v49, s74, v237
  v_dot2_f32_bf16 v239, v49, v49, v239
  v_dot2_f32_bf16 v236, v50, s74, v236
  v_dot2_f32_bf16 v238, v50, v50, v238
  v_dot2_f32_bf16 v237, v51, s74, v237
  v_dot2_f32_bf16 v239, v51, v51, v239
  v_dot2_f32_bf16 v236, v56, s74, v236
  v_dot2_f32_bf16 v238, v56, v56, v238
  v_dot2_f32_bf16 v237, v57, s74, v237
  v_dot2_f32_bf16 v239, v57, v57, v239
  v_dot2_f32_bf16 v236, v58, s74, v236
  v_dot2_f32_bf16 v238, v58, v58, v238
  v_dot2_f32_bf16 v237, v59, s74, v237
  v_dot2_f32_bf16 v239, v59, v59, v239
  s_branch k1_tokd
k1_tok1:
  v_dot2_f32_bf16 v236, v4, s74, 0
  v_dot2_f32_bf16 v238, v4, v4, 0
  v_dot2_f32_bf16 v237, v5, s74, 0
  v_dot2_f32_bf16 v239, v5, v5, 0
  v_dot2_f32_bf16 v236, v6, s74, v236
  v_dot2_f32_bf16 v238, v6, v6, v238
  v_dot2_f32_bf16 v237, v7, s74, v237
  v_dot2_f32_bf16 v239, v7, v7, v239
  v_dot2_f32_bf16 v236, v12, s74, v236
  v_dot2_f32_bf16 v238, v12, v12, v238
  v_dot2_f32_bf16 v237, v13, s74, v237
  v_dot2_f32_bf16 v239, v13, v13, v239
  v_dot2_f32_bf16 v236, v14, s74, v236
  v_dot2_f32_bf16 v238, v14, v14, v238
  v_dot2_f32_bf16 v237, v15, s74, v237
  v_dot2_f32_bf16 v239, v15, v15, v239
  v_dot2_f32_bf16 v236, v20, s74, v236
  v_dot2_f32_bf16 v238, v20, v20, v238
  v_dot2_f32_bf16 v237, v21, s74, v237
  v_dot2_f32_bf16 v239, v21, v21, v239
  v_dot2_f32_bf16 v236, v22, s74, v236
  v_dot2_f32_bf16 v238, v22, v22, v238
  v_dot2_f32_bf16 v237, v23, s74, v237
  v_dot2_f32_bf16 v239, v23, v23, v239
  v_dot2_f32_bf16 v236, v28, s74, v236
  v_dot2_f32_bf16 v238, v28, v28, v238
  v_dot2_f32_bf16 v237, v29, s74, v237
  v_dot2_f32_bf16 v239, v29, v29, v239
  v_dot2_f32_bf16 v236, v30, s74, v236
  v_dot2_f32_bf16 v238, v30, v30, v238
  v_dot2_f32_bf16 v237, v31, s74, v237
  v_dot2_f32_bf16 v239, v31, v31, v239
  v_dot2_f32_bf16 v236, v36, s74, v236
  v_dot2_f32_bf16 v238, v36, v36, v238
  v_dot2_f32_bf16 v237, v37, s74, v237
  v_dot2_f32_bf16 v239, v37, v37, v239
  v_dot2_f32_bf16 v236, v38, s74, v236
  v_dot2_f32_bf16 v238, v38, v38, v238
  v_dot2_f32_bf16 v237, v39, s74, v237
  v_dot2_f32_bf16 v239, v39, v39, v239
  v_dot2_f32_bf16 v236, v44, s74, v236
  v_dot2_f32_bf16 v238, v44, v44, v238
  v_dot2_f32_bf16 v237, v45, s74, v237
  v_dot2_f32_bf16 v239, v45, v45, v239
  v_dot2_f32_bf16 v236, v46, s74, v236
  v_dot2_f32_bf16 v238, v46, v46, v238
  v_dot2_f32_bf16 v237, v47, s74, v237
  v_dot2_f32_bf16 v239, v47, v47, v239
  v_dot2_f32_bf16 v236, v52, s74, v236
  v_dot2_f32_bf16 v238, v52, v52, v238
  v_dot2_f32_bf16 v237, v53, s74, v237
  v_dot2_f32_bf16 v239, v53, v53, v239
  v_dot2_f32_bf16 v236, v54, s74, v236
  v_dot2_f32_bf16 v238, v54, v54, v238
  v_dot2_f32_bf16 v237, v55, s74, v237
  v_dot2_f32_bf16 v239, v55, v55, v239
  v_dot2_f32_bf16 v236, v60, s74, v236
  v_dot2_f32_bf16 v238, v60, v60, v238
  v_dot2_f32_bf16 v237, v61, s74, v237
  v_dot2_f32_bf16 v239, v61, v61, v239
  v_dot2_f32_bf16 v236, v62, s74, v236
  v_dot2_f32_bf16 v238, v62, v62, v238
  v_dot2_f32_bf16 v237, v63, s74, v237
  v_dot2_f32_bf16 v239, v63, v63, v239
k1_tokd:
  s_nop 2
  v_add_f32 v236, v236, v237
  v_add_f32 v238, v238, v239
  v_lshrrev_b32 v237, 7, v218
  v_and_b32 v237, 4, v237
  v_permlane32_swap_b32 v236, v238
  v_lshl_add_u32 v237, v252, 1, v237
  v_add_f32 v236, v236, v238
  buffer_store_dword v236, v237, s[36:39], s57 offen sc1
  s_waitcnt vmcnt(9) lgkmcnt(0)
  s_barrier
  v_mfma_f32_32x32x16_bf16 v[64:79], v[192:195], v[48:51], v[64:79]
  ds_read_b64_tr_b16 v[200:201], v208 offset:61440
  ds_read_b64_tr_b16 v[202:203], v208 offset:61952
  buffer_load_dwordx4 v217, s[28:31], s44 offen offset:3072 lds
  v_mfma_f32_32x32x16_bf16 v[80:95], v[192:195], v[52:55], v[80:95]
  ds_read_b64_tr_b16 v[204:205], v209 offset:61440
  ds_read_b64_tr_b16 v[206:207], v209 offset:61952
  s_add_u32 m0, s41, 0x20000
  s_nop 0
  buffer_load_dwordx4 v140, s[24:27], s58 offen offset:0 lds
  v_mfma_f32_32x32x16_bf16 v[96:111], v[196:199], v[48:51], v[96:111]
  ds_read_b128 a[0:3], v132 offset:0
  v_mfma_f32_32x32x16_bf16 v[112:127], v[196:199], v[52:55], v[112:127]
  ds_read_b128 a[4:7], v132 offset:4096
  buffer_load_dwordx4 v141, s[24:27], s58 offen offset:1024 lds
  s_waitcnt lgkmcnt(4)
  v_mfma_f32_32x32x16_bf16 v[64:79], v[200:203], v[56:59], v[64:79]
  ds_read_b64_tr_b16 v[192:193], v210 offset:16384
  ds_read_b64_tr_b16 v[194:195], v210 offset:16896
  v_mfma_f32_32x32x16_bf16 v[80:95], v[200:203], v[60:63], v[80:95]
  ds_read_b64_tr_b16 v[196:197], v211 offset:16384
  ds_read_b64_tr_b16 v[198:199], v211 offset:16896
  buffer_load_dwordx4 v142, s[24:27], s58 offen offset:2048 lds
  s_waitcnt lgkmcnt(6)
  v_mfma_f32_32x32x16_bf16 v[96:111], v[204:207], v[56:59], v[96:111]
  ds_read_b128 a[8:11], v133 offset:0
  v_mfma_f32_32x32x16_bf16 v[112:127], v[204:207], v[60:63], v[112:127]
  ds_read_b128 a[12:15], v133 offset:4096
  buffer_load_dwordx4 v143, s[24:27], s58 offen offset:3072 lds
  s_add_u32 s58, s58, 0x80
  s_cmp_eq_u32 s58, 0x500
  s_cselect_b32 s58, 0, s58
  s_waitcnt lgkmcnt(4)
  v_mfma_f32_32x32x16_bf16 v[64:79], v[192:195], a[0:3], v[64:79]
  ds_read_b64_tr_b16 v[200:201], v210 offset:20480
  ds_read_b64_tr_b16 v[202:203], v210 offset:20992
  v_mfma_f32_32x32x16_bf16 v[80:95], v[192:195], a[4:7], v[80:95]
  ds_read_b64_tr_b16 v[204:205], v211 offset:20480
  ds_read_b64_tr_b16 v[206:207], v211 offset:20992
  s_add_u32 m0, s41, 0x24000
  s_add_u32 s44, s45, s59
  buffer_load_dwordx4 v214, s[28:31], s44 offen offset:0 lds
  s_waitcnt lgkmcnt(6)
  v_mfma_f32_32x32x16_bf16 v[96:111], v[196:199], a[0:3], v[96:111]
  ds_read_b128 a[16:19], v134 offset:0
  v_mfma_f32_32x32x16_bf16 v[112:127], v[196:199], a[4:7], v[112:127]
  ds_read_b128 a[20:23], v134 offset:4096
  buffer_load_dwordx4 v215, s[28:31], s44 offen offset:1024 lds
  s_add_u32 s59, s59, 0x3c000
  s_waitcnt lgkmcnt(4)
  v_mfma_f32_32x32x16_bf16 v[64:79], v[200:203], a[8:11], v[64:79]
  ds_read_b64_tr_b16 v[192:193], v210 offset:24576
  ds_read_b64_tr_b16 v[194:195], v210 offset:25088
  ds_read_b128 a[24:27], v135 offset:0
  v_mfma_f32_32x32x16_bf16 v[80:95], v[200:203], a[12:15], v[80:95]
  ds_read_b64_tr_b16 v[196:197], v211 offset:24576
  ds_read_b64_tr_b16 v[198:199], v211 offset:25088
  ds_read_b128 a[28:31], v135 offset:4096
  buffer_load_dwordx4 v216, s[28:31], s44 offen offset:2048 lds
  s_cmp_eq_u32 s59, 0x258000
  s_cselect_b32 s59, 0, s59
  s_waitcnt lgkmcnt(8)
  v_mfma_f32_32x32x16_bf16 v[96:111], v[204:207], a[8:11], v[96:111]
  v_mfma_f32_32x32x16_bf16 v[112:127], v[204:207], a[12:15], v[112:127]
  s_waitcnt vmcnt(7) lgkmcnt(0)
  s_barrier
  v_mfma_f32_32x32x16_bf16 v[64:79], v[192:195], a[16:19], v[64:79]
  ds_read_b64_tr_b16 v[200:201], v210 offset:28672
  ds_read_b64_tr_b16 v[202:203], v210 offset:29184
  v_lshrrev_b32 v255, 4, v218
  v_add_u32 v255, 1, v255
  buffer_atomic_add v255, v253, s[8:11], 0 offen sc1
  buffer_load_dwordx4 v217, s[28:31], s44 offen offset:3072 lds
  v_mfma_f32_32x32x16_bf16 v[80:95], v[192:195], a[20:23], v[80:95]
  ds_read_b64_tr_b16 v[204:205], v211 offset:28672
  ds_read_b64_tr_b16 v[206:207], v211 offset:29184
  s_add_u32 m0, s41, 0
  s_nop 0
  buffer_load_dwordx4 v140, s[24:27], s58 offen offset:0 lds
  v_mfma_f32_32x32x16_bf16 v[96:111], v[196:199], a[16:19], v[96:111]
  ds_read_b128 a[32:35], v132 offset:32768
  v_mfma_f32_32x32x16_bf16 v[112:127], v[196:199], a[20:23], v[112:127]
  ds_read_b128 a[36:39], v132 offset:36864
  buffer_load_dwordx4 v141, s[24:27], s58 offen offset:1024 lds
  s_waitcnt lgkmcnt(4)
  v_mfma_f32_32x32x16_bf16 v[64:79], v[200:203], a[24:27], v[64:79]
  ds_read_b64_tr_b16 v[192:193], v210 offset:49152
  ds_read_b64_tr_b16 v[194:195], v210 offset:49664
  v_mfma_f32_32x32x16_bf16 v[80:95], v[200:203], a[28:31], v[80:95]
  ds_read_b64_tr_b16 v[196:197], v211 offset:49152
  ds_read_b64_tr_b16 v[198:199], v211 offset:49664
  buffer_load_dwordx4 v142, s[24:27], s58 offen offset:2048 lds
  s_waitcnt lgkmcnt(6)
  v_mfma_f32_32x32x16_bf16 v[96:111], v[204:207], a[24:27], v[96:111]
  ds_read_b128 a[40:43], v133 offset:32768
  v_mfma_f32_32x32x16_bf16 v[112:127], v[204:207], a[28:31], v[112:127]
  ds_read_b128 a[44:47], v133 offset:36864
  buffer_load_dwordx4 v143, s[24:27], s58 offen offset:3072 lds
  s_add_u32 s58, s58, 0x80
  s_cmp_eq_u32 s58, 0x500
  s_cselect_b32 s58, 0, s58
  s_waitcnt lgkmcnt(4)
  v_mfma_f32_32x32x16_bf16 v[64:79], v[192:195], a[32:35], v[64:79]
  ds_read_b64_tr_b16 v[200:201], v210 offset:53248
  ds_read_b64_tr_b16 v[202:203], v210 offset:53760
  v_mfma_f32_32x32x16_bf16 v[80:95], v[192:195], a[36:39], v[80:95]
  ds_read_b64_tr_b16 v[204:205], v211 offset:53248
  ds_read_b64_tr_b16 v[206:207], v211 offset:53760
  s_add_u32 m0, s41, 0x4000
  s_add_u32 s44, s45, s59
  buffer_load_dwordx4 v214, s[28:31], s44 offen offset:0 lds
  s_waitcnt lgkmcnt(6)
  v_mfma_f32_32x32x16_bf16 v[96:111], v[196:199], a[32:35], v[96:111]
  ds_read_b128 a[48:51], v134 offset:32768
  v_mfma_f32_32x32x16_bf16 v[112:127], v[196:199], a[36:39], v[112:127]
  ds_read_b128 a[52:55], v134 offset:36864
  buffer_load_dwordx4 v215, s[28:31], s44 offen offset:1024 lds
  s_add_u32 s59, s59, 0x3c000
  s_waitcnt lgkmcnt(4)
  v_mfma_f32_32x32x16_bf16 v[64:79], v[200:203], a[40:43], v[64:79]
  ds_read_b64_tr_b16 v[192:193], v210 offset:57344
  ds_read_b64_tr_b16 v[194:195], v210 offset:57856
  ds_read_b128 a[56:59], v135 offset:32768
  v_mfma_f32_32x32x16_bf16 v[80:95], v[200:203], a[44:47], v[80:95]
  ds_read_b64_tr_b16 v[196:197], v211 offset:57344
  ds_read_b64_tr_b16 v[198:199], v211 offset:57856
  ds_read_b128 a[60:63], v135 offset:36864
  buffer_load_dwordx4 v216, s[28:31], s44 offen offset:2048 lds
  s_cmp_eq_u32 s59, 0x258000
  s_cselect_b32 s59, 0, s59
  s_waitcnt lgkmcnt(8)
  v_mfma_f32_32x32x16_bf16 v[96:111], v[204:207], a[40:43], v[96:111]
  v_mfma_f32_32x32x16_bf16 v[112:127], v[204:207], a[44:47], v[112:127]
  s_waitcnt vmcnt(7) lgkmcnt(0)
  s_barrier
  v_mfma_f32_32x32x16_bf16 v[64:79], v[192:195], a[48:51], v[64:79]
  ds_read_b64_tr_b16 v[200:201], v210 offset:61440
  ds_read_b64_tr_b16 v[202:203], v210 offset:61952
  buffer_load_dwordx4 v217, s[28:31], s44 offen offset:3072 lds
  v_mfma_f32_32x32x16_bf16 v[80:95], v[192:195], a[52:55], v[80:95]
  ds_read_b64_tr_b16 v[204:205], v211 offset:61440
  ds_read_b64_tr_b16 v[206:207], v211 offset:61952
  s_add_u32 m0, s41, 0x8000
  s_nop 0
  buffer_load_dwordx4 v140, s[24:27], s58 offen offset:0 lds
  v_mfma_f32_32x32x16_bf16 v[96:111], v[196:199], a[48:51], v[96:111]
  ds_read_b128 a[64:67], v136 offset:0
  v_mfma_f32_32x32x16_bf16 v[112:127], v[196:199], a[52:55], v[112:127]
  ds_read_b128 a[68:71], v136 offset:4096
  buffer_load_dwordx4 v141, s[24:27], s58 offen offset:1024 lds
  s_waitcnt lgkmcnt(4)
  v_mfma_f32_32x32x16_bf16 v[64:79], v[200:203], a[56:59], v[64:79]
  ds_read_b64_tr_b16 v[192:193], v212 offset:16384
  ds_read_b64_tr_b16 v[194:195], v212 offset:16896
  v_mfma_f32_32x32x16_bf16 v[80:95], v[200:203], a[60:63], v[80:95]
  ds_read_b64_tr_b16 v[196:197], v213 offset:16384
  ds_read_b64_tr_b16 v[198:199], v213 offset:16896
  buffer_load_dwordx4 v142, s[24:27], s58 offen offset:2048 lds
  s_waitcnt lgkmcnt(6)
  v_mfma_f32_32x32x16_bf16 v[96:111], v[204:207], a[56:59], v[96:111]
  ds_read_b128 a[72:75], v137 offset:0
  v_mfma_f32_32x32x16_bf16 v[112:127], v[204:207], a[60:63], v[112:127]
  ds_read_b128 a[76:79], v137 offset:4096
  buffer_load_dwordx4 v143, s[24:27], s58 offen offset:3072 lds
  s_add_u32 s58, s58, 0x80
  s_cmp_eq_u32 s58, 0x500
  s_cselect_b32 s58, 0, s58
  s_waitcnt lgkmcnt(4)
  v_mfma_f32_32x32x16_bf16 v[64:79], v[192:195], a[64:67], v[64:79]
  ds_read_b64_tr_b16 v[200:201], v212 offset:20480
  ds_read_b64_tr_b16 v[202:203], v212 offset:20992
  v_mfma_f32_32x32x16_bf16 v[80:95], v[192:195], a[68:71], v[80:95]
  ds_read_b64_tr_b16 v[204:205], v213 offset:20480
  ds_read_b64_tr_b16 v[206:207], v213 offset:20992
  s_add_u32 m0, s41, 0xc000
  s_add_u32 s44, s45, s59
  buffer_load_dwordx4 v214, s[28:31], s44 offen offset:0 lds
  s_waitcnt lgkmcnt(6)
  v_mfma_f32_32x32x16_bf16 v[96:111], v[196:199], a[64:67], v[96:111]
  ds_read_b128 a[80:83], v138 offset:0
  v_mfma_f32_32x32x16_bf16 v[112:127], v[196:199], a[68:71], v[112:127]
  ds_read_b128 a[84:87], v138 offset:4096
  buffer_load_dwordx4 v215, s[28:31], s44 offen offset:1024 lds
  s_add_u32 s59, s59, 0x3c000
  s_waitcnt lgkmcnt(4)
  v_mfma_f32_32x32x16_bf16 v[64:79], v[200:203], a[72:75], v[64:79]
  ds_read_b64_tr_b16 v[192:193], v212 offset:24576
  ds_read_b64_tr_b16 v[194:195], v212 offset:25088
  ds_read_b128 a[88:91], v139 offset:0
  v_mfma_f32_32x32x16_bf16 v[80:95], v[200:203], a[76:79], v[80:95]
  ds_read_b64_tr_b16 v[196:197], v213 offset:24576
  ds_read_b64_tr_b16 v[198:199], v213 offset:25088
  ds_read_b128 a[92:95], v139 offset:4096
  buffer_load_dwordx4 v216, s[28:31], s44 offen offset:2048 lds
  s_cmp_eq_u32 s59, 0x258000
  s_cselect_b32 s59, 0, s59
  s_waitcnt lgkmcnt(8)
  v_mfma_f32_32x32x16_bf16 v[96:111], v[204:207], a[72:75], v[96:111]
  v_mfma_f32_32x32x16_bf16 v[112:127], v[204:207], a[76:79], v[112:127]
  s_waitcnt vmcnt(7) lgkmcnt(0)
  s_barrier
  v_mfma_f32_32x32x16_bf16 v[64:79], v[192:195], a[80:83], v[64:79]
  ds_read_b64_tr_b16 v[200:201], v212 offset:28672
  ds_read_b64_tr_b16 v[202:203], v212 offset:29184
  buffer_load_dwordx4 v217, s[28:31], s44 offen offset:3072 lds
  v_mfma_f32_32x32x16_bf16 v[80:95], v[192:195], a[84:87], v[80:95]
  ds_read_b64_tr_b16 v[204:205], v213 offset:28672
  ds_read_b64_tr_b16 v[206:207], v213 offset:29184
  s_add_u32 m0, s41, 0x10000
  s_nop 0
  buffer_load_dwordx4 v140, s[24:27], s58 offen offset:0 lds
  v_mfma_f32_32x32x16_bf16 v[96:111], v[196:199], a[80:83], v[96:111]
  ds_read_b128 a[96:99], v128 offset:0
  v_mfma_f32_32x32x16_bf16 v[112:127], v[196:199], a[84:87], v[112:127]
  ds_read_b128 a[100:103], v128 offset:4096
  buffer_load_dwordx4 v141, s[24:27], s58 offen offset:1024 lds
  s_waitcnt lgkmcnt(4)
  v_mfma_f32_32x32x16_bf16 v[64:79], v[200:203], a[88:91], v[64:79]
  ds_read_b64_tr_b16 v[192:193], v208 offset:16384
  ds_read_b64_tr_b16 v[194:195], v208 offset:16896
  v_mfma_f32_32x32x16_bf16 v[80:95], v[200:203], a[92:95], v[80:95]
  ds_read_b64_tr_b16 v[196:197], v209 offset:16384
  ds_read_b64_tr_b16 v[198:199], v209 offset:16896
  buffer_load_dwordx4 v142, s[24:27], s58 offen offset:2048 lds
  s_waitcnt lgkmcnt(6)
  v_mfma_f32_32x32x16_bf16 v[96:111], v[204:207], a[88:91], v[96:111]
  ds_read_b128 a[104:107], v129 offset:0
  v_mfma_f32_32x32x16_bf16 v[112:127], v[204:207], a[92:95], v[112:127]
  ds_read_b128 a[108:111], v129 offset:4096
  buffer_load_dwordx4 v143, s[24:27], s58 offen offset:3072 lds
  s_add_u32 s58, s58, 0x80
  s_cmp_eq_u32 s58, 0x500
  s_cselect_b32 s58, 0, s58
  s_waitcnt lgkmcnt(4)
  v_mfma_f32_32x32x16_bf16 v[64:79], v[192:195], a[96:99], v[64:79]
  ds_read_b64_tr_b16 v[200:201], v208 offset:20480
  ds_read_b64_tr_b16 v[202:203], v208 offset:20992
  v_mfma_f32_32x32x16_bf16 v[80:95], v[192:195], a[100:103], v[80:95]
  ds_read_b64_tr_b16 v[204:205], v209 offset:20480
  ds_read_b64_tr_b16 v[206:207], v209 offset:20992
  s_add_u32 m0, s41, 0x14000
  s_add_u32 s44, s45, s59
  buffer_load_dwordx4 v214, s[28:31], s44 offen offset:0 lds
  s_waitcnt lgkmcnt(6)
  v_mfma_f32_32x32x16_bf16 v[96:111], v[196:199], a[96:99], v[96:111]
  ds_read_b128 a[112:115], v130 offset:0
  v_mfma_f32_32x32x16_bf16 v[112:127], v[196:199], a[100:103], v[112:127]
  ds_read_b128 a[116:119], v130 offset:4096
  buffer_load_dwordx4 v215, s[28:31], s44 offen offset:1024 lds
  s_add_u32 s59, s59, 0x3c000
  s_waitcnt lgkmcnt(4)
  v_mfma_f32_32x32x16_bf16 v[64:79], v[200:203], a[104:107], v[64:79]
  ds_read_b64_tr_b16 v[192:193], v208 offset:24576
  ds_read_b64_tr_b16 v[194:195], v208 offset:25088
  ds_read_b128 a[120:123], v131 offset:0
  v_mfma_f32_32x32x16_bf16 v[80:95], v[200:203], a[108:111], v[80:95]
  ds_read_b64_tr_b16 v[196:197], v209 offset:24576
  ds_read_b64_tr_b16 v[198:199], v209 offset:25088
  ds_read_b128 a[124:127], v131 offset:4096
  buffer_load_dwordx4 v216, s[28:31], s44 offen offset:2048 lds
  s_cmp_eq_u32 s59, 0x258000
  s_cselect_b32 s59, 0, s59
  s_waitcnt lgkmcnt(8)
  v_mfma_f32_32x32x16_bf16 v[96:111], v[204:207], a[104:107], v[96:111]
  v_mfma_f32_32x32x16_bf16 v[112:127], v[204:207], a[108:111], v[112:127]
  s_waitcnt vmcnt(7) lgkmcnt(0)
  s_barrier
  v_mfma_f32_32x32x16_bf16 v[64:79], v[192:195], a[112:115], v[64:79]
  ds_read_b64_tr_b16 v[200:201], v208 offset:28672
  ds_read_b64_tr_b16 v[202:203], v208 offset:29184
  buffer_load_dwordx4 v217, s[28:31], s44 offen offset:3072 lds
  v_mfma_f32_32x32x16_bf16 v[80:95], v[192:195], a[116:119], v[80:95]
  ds_read_b64_tr_b16 v[204:205], v209 offset:28672
  ds_read_b64_tr_b16 v[206:207], v209 offset:29184
  s_add_u32 m0, s41, 0x18000
  s_nop 0
  buffer_load_dwordx4 v140, s[24:27], s58 offen offset:0 lds
  v_mfma_f32_32x32x16_bf16 v[96:111], v[196:199], a[112:115], v[96:111]
  ds_read_b128 a[128:131], v128 offset:32768
  v_mfma_f32_32x32x16_bf16 v[112:127], v[196:199], a[116:119], v[112:127]
  ds_read_b128 a[132:135], v128 offset:36864
  buffer_load_dwordx4 v141, s[24:27], s58 offen offset:1024 lds
  s_waitcnt lgkmcnt(4)
  v_mfma_f32_32x32x16_bf16 v[64:79], v[200:203], a[120:123], v[64:79]
  ds_read_b64_tr_b16 v[192:193], v208 offset:49152
  ds_read_b64_tr_b16 v[194:195], v208 offset:49664
  v_mfma_f32_32x32x16_bf16 v[80:95], v[200:203], a[124:127], v[80:95]
  ds_read_b64_tr_b16 v[196:197], v209 offset:49152
  ds_read_b64_tr_b16 v[198:199], v209 offset:49664
  buffer_load_dwordx4 v142, s[24:27], s58 offen offset:2048 lds
  s_waitcnt lgkmcnt(6)
  v_mfma_f32_32x32x16_bf16 v[96:111], v[204:207], a[120:123], v[96:111]
  ds_read_b128 a[136:139], v129 offset:32768
  v_mfma_f32_32x32x16_bf16 v[112:127], v[204:207], a[124:127], v[112:127]
  ds_read_b128 a[140:143], v129 offset:36864
  buffer_load_dwordx4 v143, s[24:27], s58 offen offset:3072 lds
  s_add_u32 s58, s58, 0x80
  s_cmp_eq_u32 s58, 0x500
  s_cselect_b32 s58, 0, s58
  s_waitcnt lgkmcnt(4)
  v_mfma_f32_32x32x16_bf16 v[64:79], v[192:195], a[128:131], v[64:79]
  ds_read_b64_tr_b16 v[200:201], v208 offset:53248
  ds_read_b64_tr_b16 v[202:203], v208 offset:53760
  v_mfma_f32_32x32x16_bf16 v[80:95], v[192:195], a[132:135], v[80:95]
  ds_read_b64_tr_b16 v[204:205], v209 offset:53248
  ds_read_b64_tr_b16 v[206:207], v209 offset:53760
  s_add_u32 m0, s41, 0x1c000
  s_add_u32 s44, s45, s59
  buffer_load_dwordx4 v214, s[28:31], s44 offen offset:0 lds
  s_waitcnt lgkmcnt(6)
  v_mfma_f32_32x32x16_bf16 v[96:111], v[196:199], a[128:131], v[96:111]
  ds_read_b128 a[144:147], v130 offset:32768
  v_mfma_f32_32x32x16_bf16 v[112:127], v[196:199], a[132:135], v[112:127]
  ds_read_b128 a[148:151], v130 offset:36864
  buffer_load_dwordx4 v215, s[28:31], s44 offen offset:1024 lds
  s_add_u32 s59, s59, 0x3c000
  s_waitcnt lgkmcnt(4)
  v_mfma_f32_32x32x16_bf16 v[64:79], v[200:203], a[136:139], v[64:79]
  ds_read_b64_tr_b16 v[192:193], v208 offset:57344
  ds_read_b64_tr_b16 v[194:195], v208 offset:57856
  ds_read_b128 a[152:155], v131 offset:32768
  v_mfma_f32_32x32x16_bf16 v[80:95], v[200:203], a[140:143], v[80:95]
  ds_read_b64_tr_b16 v[196:197], v209 offset:57344
  ds_read_b64_tr_b16 v[198:199], v209 offset:57856
  ds_read_b128 a[156:159], v131 offset:36864
  buffer_load_dwordx4 v216, s[28:31], s44 offen offset:2048 lds
  s_cmp_eq_u32 s59, 0x258000
  s_cselect_b32 s59, 0, s59
  s_waitcnt lgkmcnt(8)
  v_mfma_f32_32x32x16_bf16 v[96:111], v[204:207], a[136:139], v[96:111]
  v_mfma_f32_32x32x16_bf16 v[112:127], v[204:207], a[140:143], v[112:127]
  s_waitcnt vmcnt(7) lgkmcnt(0)
  s_barrier
  v_mfma_f32_32x32x16_bf16 v[64:79], v[192:195], a[144:147], v[64:79]
  ds_read_b64_tr_b16 v[200:201], v208 offset:61440
  ds_read_b64_tr_b16 v[202:203], v208 offset:61952
  buffer_load_dword v255, v254, s[8:11], 0 offen offset:0 sc1
  buffer_load_dwordx4 v217, s[28:31], s44 offen offset:3072 lds
  v_mfma_f32_32x32x16_bf16 v[80:95], v[192:195], a[148:151], v[80:95]
  ds_read_b64_tr_b16 v[204:205], v209 offset:61440
  ds_read_b64_tr_b16 v[206:207], v209 offset:61952
  s_add_u32 m0, s41, 0x20000
  s_nop 0
  buffer_load_dwordx4 v140, s[24:27], s58 offen offset:0 lds
  v_mfma_f32_32x32x16_bf16 v[96:111], v[196:199], a[144:147], v[96:111]
  ds_read_b128 a[160:163], v132 offset:0
  v_mfma_f32_32x32x16_bf16 v[112:127], v[196:199], a[148:151], v[112:127]
  ds_read_b128 a[164:167], v132 offset:4096
  buffer_load_dwordx4 v141, s[24:27], s58 offen offset:1024 lds
  s_waitcnt lgkmcnt(4)
  v_mfma_f32_32x32x16_bf16 v[64:79], v[200:203], a[152:155], v[64:79]
  ds_read_b64_tr_b16 v[192:193], v210 offset:16384
  ds_read_b64_tr_b16 v[194:195], v210 offset:16896
  v_mfma_f32_32x32x16_bf16 v[80:95], v[200:203], a[156:159], v[80:95]
  ds_read_b64_tr_b16 v[196:197], v211 offset:16384
  ds_read_b64_tr_b16 v[198:199], v211 offset:16896
  buffer_load_dwordx4 v142, s[24:27], s58 offen offset:2048 lds
  s_waitcnt lgkmcnt(6)
  v_mfma_f32_32x32x16_bf16 v[96:111], v[204:207], a[152:155], v[96:111]
  ds_read_b128 a[168:171], v133 offset:0
  v_mfma_f32_32x32x16_bf16 v[112:127], v[204:207], a[156:159], v[112:127]
  ds_read_b128 a[172:175], v133 offset:4096
  buffer_load_dwordx4 v143, s[24:27], s58 offen offset:3072 lds
  s_add_u32 s58, s58, 0x80
  s_cmp_eq_u32 s58, 0x500
  s_cselect_b32 s58, 0, s58
  s_waitcnt lgkmcnt(4)
  v_mfma_f32_32x32x16_bf16 v[64:79], v[192:195], a[160:163], v[64:79]
  ds_read_b64_tr_b16 v[200:201], v210 offset:20480
  ds_read_b64_tr_b16 v[202:203], v210 offset:20992
  v_mfma_f32_32x32x16_bf16 v[80:95], v[192:195], a[164:167], v[80:95]
  ds_read_b64_tr_b16 v[204:205], v211 offset:20480
  ds_read_b64_tr_b16 v[206:207], v211 offset:20992
  s_add_u32 m0, s41, 0x24000
  s_add_u32 s44, s45, s59
  buffer_load_dwordx4 v214, s[28:31], s44 offen offset:0 lds
  s_waitcnt lgkmcnt(6)
  v_mfma_f32_32x32x16_bf16 v[96:111], v[196:199], a[160:163], v[96:111]
  ds_read_b128 a[176:179], v134 offset:0
  v_mfma_f32_32x32x16_bf16 v[112:127], v[196:199], a[164:167], v[112:127]
  ds_read_b128 a[180:183], v134 offset:4096
  buffer_load_dwordx4 v215, s[28:31], s44 offen offset:1024 lds
  s_add_u32 s59, s59, 0x3c000
  s_waitcnt lgkmcnt(4)
  v_mfma_f32_32x32x16_bf16 v[64:79], v[200:203], a[168:171], v[64:79]
  ds_read_b64_tr_b16 v[192:193], v210 offset:24576
  ds_read_b64_tr_b16 v[194:195], v210 offset:25088
  ds_read_b128 a[184:187], v135 offset:0
  v_mfma_f32_32x32x16_bf16 v[80:95], v[200:203], a[172:175], v[80:95]
  ds_read_b64_tr_b16 v[196:197], v211 offset:24576
  ds_read_b64_tr_b16 v[198:199], v211 offset:25088
  ds_read_b128 a[188:191], v135 offset:4096
  buffer_load_dwordx4 v216, s[28:31], s44 offen offset:2048 lds
  s_cmp_eq_u32 s59, 0x258000
  s_cselect_b32 s59, 0, s59
  s_waitcnt lgkmcnt(8)
  v_mfma_f32_32x32x16_bf16 v[96:111], v[204:207], a[168:171], v[96:111]
  v_mfma_f32_32x32x16_bf16 v[112:127], v[204:207], a[172:175], v[112:127]
  s_waitcnt vmcnt(7) lgkmcnt(0)
  s_barrier
  v_mfma_f32_32x32x16_bf16 v[64:79], v[192:195], a[176:179], v[64:79]
  ds_read_b64_tr_b16 v[200:201], v210 offset:28672
  ds_read_b64_tr_b16 v[202:203], v210 offset:29184
  buffer_load_dwordx4 v217, s[28:31], s44 offen offset:3072 lds
  v_mfma_f32_32x32x16_bf16 v[80:95], v[192:195], a[180:183], v[80:95]
  ds_read_b64_tr_b16 v[204:205], v211 offset:28672
  ds_read_b64_tr_b16 v[206:207], v211 offset:29184
  s_add_u32 m0, s41, 0
  s_add_u32 s44, s46, s59
  buffer_load_dwordx4 v214, s[28:31], s44 offen offset:0 lds
  v_mfma_f32_32x32x16_bf16 v[96:111], v[196:199], a[176:179], v[96:111]
  ds_read_b128 a[192:195], v132 offset:32768
  v_mfma_f32_32x32x16_bf16 v[112:127], v[196:199], a[180:183], v[112:127]
  ds_read_b128 a[196:199], v132 offset:36864
  buffer_load_dwordx4 v215, s[28:31], s44 offen offset:1024 lds
  s_add_u32 s59, s59, 0x3c000
  s_waitcnt lgkmcnt(4)
  v_mfma_f32_32x32x16_bf16 v[64:79], v[200:203], a[184:187], v[64:79]
  ds_read_b64_tr_b16 v[192:193], v210 offset:49152
  ds_read_b64_tr_b16 v[194:195], v210 offset:49664
  v_mfma_f32_32x32x16_bf16 v[80:95], v[200:203], a[188:191], v[80:95]
  ds_read_b64_tr_b16 v[196:197], v211 offset:49152
  ds_read_b64_tr_b16 v[198:199], v211 offset:49664
  buffer_load_dwordx4 v216, s[28:31], s44 offen offset:2048 lds
  s_cmp_eq_u32 s59, 0x258000
  s_cselect_b32 s59, 0, s59
  s_waitcnt lgkmcnt(6)
  v_mfma_f32_32x32x16_bf16 v[96:111], v[204:207], a[184:187], v[96:111]
  ds_read_b128 a[200:203], v133 offset:32768
  v_mfma_f32_32x32x16_bf16 v[112:127], v[204:207], a[188:191], v[112:127]
  ds_read_b128 a[204:207], v133 offset:36864
  buffer_load_dwordx4 v217, s[28:31], s44 offen offset:3072 lds
  s_waitcnt lgkmcnt(4)
  v_mfma_f32_32x32x16_bf16 v[64:79], v[192:195], a[192:195], v[64:79]
  ds_read_b64_tr_b16 v[200:201], v210 offset:53248
  ds_read_b64_tr_b16 v[202:203], v210 offset:53760
  v_mfma_f32_32x32x16_bf16 v[80:95], v[192:195], a[196:199], v[80:95]
  ds_read_b64_tr_b16 v[204:205], v211 offset:53248
  ds_read_b64_tr_b16 v[206:207], v211 offset:53760
  s_add_u32 m0, s41, 0x4000
  s_add_u32 s44, s46, s59
  buffer_load_dwordx4 v214, s[28:31], s44 offen offset:0 lds
  s_waitcnt lgkmcnt(6)
  v_mfma_f32_32x32x16_bf16 v[96:111], v[196:199], a[192:195], v[96:111]
  ds_read_b128 a[208:211], v134 offset:32768
  v_mfma_f32_32x32x16_bf16 v[112:127], v[196:199], a[196:199], v[112:127]
  ds_read_b128 a[212:215], v134 offset:36864
  buffer_load_dwordx4 v215, s[28:31], s44 offen offset:1024 lds
  s_add_u32 s59, s59, 0x3c000
  s_waitcnt lgkmcnt(4)
  v_mfma_f32_32x32x16_bf16 v[64:79], v[200:203], a[200:203], v[64:79]
  ds_read_b64_tr_b16 v[192:193], v210 offset:57344
  ds_read_b64_tr_b16 v[194:195], v210 offset:57856
  ds_read_b128 a[216:219], v135 offset:32768
  v_mfma_f32_32x32x16_bf16 v[80:95], v[200:203], a[204:207], v[80:95]
  ds_read_b64_tr_b16 v[196:197], v211 offset:57344
  ds_read_b64_tr_b16 v[198:199], v211 offset:57856
  ds_read_b128 a[220:223], v135 offset:36864
  buffer_load_dwordx4 v216, s[28:31], s44 offen offset:2048 lds
  s_cmp_eq_u32 s59, 0x258000
  s_cselect_b32 s59, 0, s59
  s_waitcnt lgkmcnt(8)
  v_mfma_f32_32x32x16_bf16 v[96:111], v[204:207], a[200:203], v[96:111]
  v_mfma_f32_32x32x16_bf16 v[112:127], v[204:207], a[204:207], v[112:127]
  s_waitcnt vmcnt(7) lgkmcnt(0)
  s_barrier
  v_mfma_f32_32x32x16_bf16 v[64:79], v[192:195], a[208:211], v[64:79]
  ds_read_b64_tr_b16 v[200:201], v210 offset:61440
  ds_read_b64_tr_b16 v[202:203], v210 offset:61952
  buffer_load_dwordx4 v217, s[28:31], s44 offen offset:3072 lds
  v_mfma_f32_32x32x16_bf16 v[80:95], v[192:195], a[212:215], v[80:95]
  ds_read_b64_tr_b16 v[204:205], v211 offset:61440
  ds_read_b64_tr_b16 v[206:207], v211 offset:61952
  s_add_u32 m0, s41, 0x8000
  s_add_u32 s44, s46, s59
  buffer_load_dwordx4 v214, s[28:31], s44 offen offset:0 lds
  v_mfma_f32_32x32x16_bf16 v[96:111], v[196:199], a[208:211], v[96:111]
  ds_read_b128 a[224:227], v136 offset:0
  v_mfma_f32_32x32x16_bf16 v[112:127], v[196:199], a[212:215], v[112:127]
  ds_read_b128 a[228:231], v136 offset:4096
  buffer_load_dwordx4 v215, s[28:31], s44 offen offset:1024 lds
  s_add_u32 s59, s59, 0x3c000
  s_waitcnt lgkmcnt(4)
  v_mfma_f32_32x32x16_bf16 v[64:79], v[200:203], a[216:219], v[64:79]
  ds_read_b64_tr_b16 v[192:193], v212 offset:16384
  ds_read_b64_tr_b16 v[194:195], v212 offset:16896
  v_mfma_f32_32x32x16_bf16 v[80:95], v[200:203], a[220:223], v[80:95]
  ds_read_b64_tr_b16 v[196:197], v213 offset:16384
  ds_read_b64_tr_b16 v[198:199], v213 offset:16896
  buffer_load_dwordx4 v216, s[28:31], s44 offen offset:2048 lds
  s_cmp_eq_u32 s59, 0x258000
  s_cselect_b32 s59, 0, s59
  s_waitcnt lgkmcnt(6)
  v_mfma_f32_32x32x16_bf16 v[96:111], v[204:207], a[216:219], v[96:111]
  ds_read_b128 a[232:235], v137 offset:0
  v_mfma_f32_32x32x16_bf16 v[112:127], v[204:207], a[220:223], v[112:127]
  ds_read_b128 a[236:239], v137 offset:4096
  buffer_load_dwordx4 v217, s[28:31], s44 offen offset:3072 lds
  s_waitcnt lgkmcnt(4)
  v_mfma_f32_32x32x16_bf16 v[64:79], v[192:195], a[224:227], v[64:79]
  ds_read_b64_tr_b16 v[200:201], v212 offset:20480
  ds_read_b64_tr_b16 v[202:203], v212 offset:20992
  v_mfma_f32_32x32x16_bf16 v[80:95], v[192:195], a[228:231], v[80:95]
  ds_read_b64_tr_b16 v[204:205], v213 offset:20480
  ds_read_b64_tr_b16 v[206:207], v213 offset:20992
  s_add_u32 m0, s41, 0xc000
  s_add_u32 s44, s46, s59
  buffer_load_dwordx4 v214, s[28:31], s44 offen offset:0 lds
  s_waitcnt lgkmcnt(6)
  v_mfma_f32_32x32x16_bf16 v[96:111], v[196:199], a[224:227], v[96:111]
  ds_read_b128 a[240:243], v138 offset:0
  v_mfma_f32_32x32x16_bf16 v[112:127], v[196:199], a[228:231], v[112:127]
  ds_read_b128 a[244:247], v138 offset:4096
  buffer_load_dwordx4 v215, s[28:31], s44 offen offset:1024 lds
  s_add_u32 s59, s59, 0x3c000
  s_waitcnt lgkmcnt(4)
  v_mfma_f32_32x32x16_bf16 v[64:79], v[200:203], a[232:235], v[64:79]
  ds_read_b64_tr_b16 v[192:193], v212 offset:24576
  ds_read_b64_tr_b16 v[194:195], v212 offset:25088
  v_mfma_f32_32x32x16_bf16 v[80:95], v[200:203], a[236:239], v[80:95]
  ds_read_b64_tr_b16 v[196:197], v213 offset:24576
  ds_read_b64_tr_b16 v[198:199], v213 offset:25088
  buffer_load_dwordx4 v216, s[28:31], s44 offen offset:2048 lds
  s_cmp_eq_u32 s59, 0x258000
  s_cselect_b32 s59, 0, s59
  s_waitcnt lgkmcnt(6)
  v_mfma_f32_32x32x16_bf16 v[96:111], v[204:207], a[232:235], v[96:111]
  ds_read_b128 a[248:251], v139 offset:0
  v_mfma_f32_32x32x16_bf16 v[112:127], v[204:207], a[236:239], v[112:127]
  ds_read_b128 a[252:255], v139 offset:4096
  buffer_load_dwordx4 v217, s[28:31], s44 offen offset:3072 lds
  s_waitcnt lgkmcnt(4)
  v_mfma_f32_32x32x16_bf16 v[64:79], v[192:195], a[240:243], v[64:79]
  ds_read_b64_tr_b16 v[200:201], v212 offset:28672
  ds_read_b64_tr_b16 v[202:203], v212 offset:29184
  v_mfma_f32_32x32x16_bf16 v[80:95], v[192:195], a[244:247], v[80:95]
  ds_read_b64_tr_b16 v[204:205], v213 offset:28672
  ds_read_b64_tr_b16 v[206:207], v213 offset:29184
  s_add_u32 m0, s41, 0x10000
  s_add_u32 s44, s46, s59
  buffer_load_dwordx4 v214, s[28:31], s44 offen offset:0 lds
  s_waitcnt lgkmcnt(6)
  v_mfma_f32_32x32x16_bf16 v[96:111], v[196:199], a[240:243], v[96:111]
  v_mfma_f32_32x32x16_bf16 v[112:127], v[196:199], a[244:247], v[112:127]
  v_readlane_b32 s100, v255, 0
  v_readlane_b32 s101, v255, 1
  s_nop 0
  s_min_u32 s100, s100, s101
  v_readlane_b32 s101, v255, 2
  s_nop 0
  s_min_u32 s100, s100, s101
  s_cmp_lt_u32 s100, s76
  s_cbranch_scc1 qkv_poll0
qkv_poll0_d:
  s_waitcnt vmcnt(13) lgkmcnt(0)
  s_barrier
  v_mfma_f32_32x32x16_bf16 v[64:79], v[200:203], a[248:251], v[64:79]
  ds_read_b64_tr_b16 v[192:193], v208 offset:0
  ds_read_b64_tr_b16 v[194:195], v208 offset:512
  v_and_b32 v246, 0x1ff, v218
  v_lshrrev_b32 v246, 1, v246
  v_lshrrev_b32 v247, 9, v218
  v_mul_u32_u24 v247, 0x500, v247
  v_add_u32 v246, v246, v247
  buffer_load_dwordx2 v[226:227], v246, s[36:39], s56 offen offset:0 sc1
  v_mfma_f32_32x32x16_bf16 v[80:95], v[200:203], a[252:255], v[80:95]
  ds_read_b64_tr_b16 v[196:197], v209 offset:0
  ds_read_b64_tr_b16 v[198:199], v209 offset:512
  buffer_load_dwordx2 v[228:229], v246, s[36:39], s56 offen offset:256 sc1
  v_mfma_f32_32x32x16_bf16 v[96:111], v[204:207], a[248:251], v[96:111]
  buffer_load_dwordx2 v[230:231], v246, s[36:39], s56 offen offset:512 sc1
  v_mfma_f32_32x32x16_bf16 v[112:127], v[204:207], a[252:255], v[112:127]
  buffer_load_dwordx2 v[232:233], v246, s[36:39], s56 offen offset:768 sc1
  s_waitcnt lgkmcnt(2)
  v_mfma_f32_32x32x16_bf16 v[128:143], v[192:195], v[0:3], 0
  ds_read_b64_tr_b16 v[200:201], v208 offset:4096
  ds_read_b64_tr_b16 v[202:203], v208 offset:4608
  buffer_load_dwordx2 v[234:235], v246, s[36:39], s56 offen offset:1024 sc1
  v_mfma_f32_32x32x16_bf16 v[144:159], v[192:195], v[4:7], 0
  ds_read_b64_tr_b16 v[204:205], v209 offset:4096
  ds_read_b64_tr_b16 v[206:207], v209 offset:4608
  s_add_u32 s67, s55, 0
  buffer_load_dword v236, v219, s[36:39], s67 offen offset:0 sc1
  s_waitcnt lgkmcnt(4)
  v_mfma_f32_32x32x16_bf16 v[160:175], v[196:199], v[0:3], 0
  buffer_load_dword v237, v219, s[36:39], s67 offen offset:128 sc1
  v_mfma_f32_32x32x16_bf16 v[176:191], v[196:199], v[4:7], 0
  buffer_load_dword v238, v219, s[36:39], s67 offen offset:256 sc1
  s_waitcnt lgkmcnt(2)
  v_mfma_f32_32x32x16_bf16 v[128:143], v[200:203], v[8:11], v[128:143]
  ds_read_b64_tr_b16 v[192:193], v208 offset:8192
  ds_read_b64_tr_b16 v[194:195], v208 offset:8704
  buffer_load_dword v239, v219, s[36:39], s67 offen offset:384 sc1
  v_mfma_f32_32x32x16_bf16 v[144:159], v[200:203], v[12:15], v[144:159]
  ds_read_b64_tr_b16 v[196:197], v209 offset:8192
  ds_read_b64_tr_b16 v[198:199], v209 offset:8704
  buffer_load_dword v240, v219, s[36:39], s67 offen offset:512 sc1
  s_waitcnt lgkmcnt(4)
  v_mfma_f32_32x32x16_bf16 v[160:175], v[204:207], v[8:11], v[160:175]
  buffer_load_dword v241, v219, s[36:39], s67 offen offset:640 sc1
  v_mfma_f32_32x32x16_bf16 v[176:191], v[204:207], v[12:15], v[176:191]
  buffer_load_dword v242, v219, s[36:39], s67 offen offset:768 sc1
  s_waitcnt lgkmcnt(2)
  v_mfma_f32_32x32x16_bf16 v[128:143], v[192:195], v[16:19], v[128:143]
  ds_read_b64_tr_b16 v[200:201], v208 offset:12288
  ds_read_b64_tr_b16 v[202:203], v208 offset:12800
  buffer_load_dword v243, v219, s[36:39], s67 offen offset:896 sc1
  v_mfma_f32_32x32x16_bf16 v[144:159], v[192:195], v[20:23], v[144:159]
  ds_read_b64_tr_b16 v[204:205], v209 offset:12288
  ds_read_b64_tr_b16 v[206:207], v209 offset:12800
  buffer_load_dword v244, v219, s[36:39], s67 offen offset:1024 sc1
  s_waitcnt lgkmcnt(4)
  v_mfma_f32_32x32x16_bf16 v[160:175], v[196:199], v[16:19], v[160:175]
  buffer_load_dword v245, v219, s[36:39], s67 offen offset:1152 sc1
  v_mfma_f32_32x32x16_bf16 v[176:191], v[196:199], v[20:23], v[176:191]
  s_waitcnt vmcnt(24) lgkmcnt(0)
  s_barrier
  v_mfma_f32_32x32x16_bf16 v[128:143], v[200:203], v[24:27], v[128:143]
  ds_read_b64_tr_b16 v[192:193], v208 offset:16384
  ds_read_b64_tr_b16 v[194:195], v208 offset:16896
  buffer_load_dwordx4 v215, s[28:31], s44 offen offset:1024 lds
  s_add_u32 s59, s59, 0x3c000
  v_mfma_f32_32x32x16_bf16 v[144:159], v[200:203], v[28:31], v[144:159]
  ds_read_b64_tr_b16 v[196:197], v209 offset:16384
  ds_read_b64_tr_b16 v[198:199], v209 offset:16896
  buffer_load_dwordx4 v216, s[28:31], s44 offen offset:2048 lds
  s_cmp_eq_u32 s59, 0x258000
  s_cselect_b32 s59, 0, s59
  v_mfma_f32_32x32x16_bf16 v[160:175], v[204:207], v[24:27], v[160:175]
  buffer_load_dwordx4 v217, s[28:31], s44 offen offset:3072 lds
  v_mfma_f32_32x32x16_bf16 v[176:191], v[204:207], v[28:31], v[176:191]
  s_waitcnt lgkmcnt(2)
  v_mfma_f32_32x32x16_bf16 v[128:143], v[192:195], v[32:35], v[128:143]
  ds_read_b64_tr_b16 v[200:201], v208 offset:20480
  ds_read_b64_tr_b16 v[202:203], v208 offset:20992
  s_add_u32 m0, s41, 0x14000
  s_add_u32 s44, s46, s59
  buffer_load_dwordx4 v214, s[28:31], s44 offen offset:0 lds
  v_mfma_f32_32x32x16_bf16 v[144:159], v[192:195], v[36:39], v[144:159]
  ds_read_b64_tr_b16 v[204:205], v209 offset:20480
  ds_read_b64_tr_b16 v[206:207], v209 offset:20992
  s_waitcnt lgkmcnt(4)
  v_mfma_f32_32x32x16_bf16 v[160:175], v[196:199], v[32:35], v[160:175]
  buffer_load_dwordx4 v215, s[28:31], s44 offen offset:1024 lds
  s_add_u32 s59, s59, 0x3c000
  v_mfma_f32_32x32x16_bf16 v[176:191], v[196:199], v[36:39], v[176:191]
  s_waitcnt lgkmcnt(2)
  v_mfma_f32_32x32x16_bf16 v[128:143], v[200:203], v[40:43], v[128:143]
  ds_read_b64_tr_b16 v[192:193], v208 offset:24576
  ds_read_b64_tr_b16 v[194:195], v208 offset:25088
  buffer_load_dwordx4 v216, s[28:31], s44 offen offset:2048 lds
  s_cmp_eq_u32 s59, 0x258000
  s_cselect_b32 s59, 0, s59
  v_mfma_f32_32x32x16_bf16 v[144:159], v[200:203], v[44:47], v[144:159]
  ds_read_b64_tr_b16 v[196:197], v209 offset:24576
  ds_read_b64_tr_b16 v[198:199], v209 offset:25088
  s_waitcnt lgkmcnt(4)
  v_mfma_f32_32x32x16_bf16 v[160:175], v[204:207], v[40:43], v[160:175]
  buffer_load_dwordx4 v217, s[28:31], s44 offen offset:3072 lds
  v_mfma_f32_32x32x16_bf16 v[176:191], v[204:207], v[44:47], v[176:191]
  s_waitcnt lgkmcnt(2)
  v_mfma_f32_32x32x16_bf16 v[128:143], v[192:195], v[48:51], v[128:143]
  ds_read_b64_tr_b16 v[200:201], v208 offset:28672
  ds_read_b64_tr_b16 v[202:203], v208 offset:29184
  s_add_u32 m0, s41, 0x18000
  s_add_u32 s44, s46, s59
  buffer_load_dwordx4 v214, s[28:31], s44 offen offset:0 lds
  v_mfma_f32_32x32x16_bf16 v[144:159], v[192:195], v[52:55], v[144:159]
  ds_read_b64_tr_b16 v[204:205], v209 offset:28672
  ds_read_b64_tr_b16 v[206:207], v209 offset:29184
  s_waitcnt lgkmcnt(4)
  v_mfma_f32_32x32x16_bf16 v[160:175], v[196:199], v[48:51], v[160:175]
  buffer_load_dwordx4 v215, s[28:31], s44 offen offset:1024 lds
  s_add_u32 s59, s59, 0x3c000
  v_mfma_f32_32x32x16_bf16 v[176:191], v[196:199], v[52:55], v[176:191]
  s_waitcnt vmcnt(29) lgkmcnt(0)
  s_barrier
  v_mfma_f32_32x32x16_bf16 v[128:143], v[200:203], v[56:59], v[128:143]
  ds_read_b64_tr_b16 v[192:193], v208 offset:32768
  ds_read_b64_tr_b16 v[194:195], v208 offset:33280
  buffer_load_dwordx4 v216, s[28:31], s44 offen offset:2048 lds
  s_cmp_eq_u32 s59, 0x258000
  s_cselect_b32 s59, 0, s59
  v_mfma_f32_32x32x16_bf16 v[144:159], v[200:203], v[60:63], v[144:159]
  ds_read_b64_tr_b16 v[196:197], v209 offset:32768
  ds_read_b64_tr_b16 v[198:199], v209 offset:33280
  s_waitcnt vmcnt(23)
  v_add_f32 v226, v226, v228
  v_add_f32 v227, v227, v229
  s_waitcnt vmcnt(21)
  v_add_f32 v230, v230, v232
  v_mfma_f32_32x32x16_bf16 v[160:175], v[204:207], v[56:59], v[160:175]
  buffer_load_dwordx4 v217, s[28:31], s44 offen offset:3072 lds
  v_add_f32 v231, v231, v233
  s_waitcnt vmcnt(21)
  v_add_f32 v226, v226, v234
  v_add_f32 v227, v227, v235
  v_add_f32 v226, v226, v230
  v_mfma_f32_32x32x16_bf16 v[176:191], v[204:207], v[60:63], v[176:191]
  v_add_f32 v227, v227, v231
  v_mul_f32 v226, 0xbacccccd, v226
  v_mul_f32 v227, 0x3acccccd, v227
  v_fma_f32 v227, -v226, v226, v227
  v_and_b32 v246, 0xffff0000, v226
  s_waitcnt lgkmcnt(2)
  v_mfma_f32_32x32x16_bf16 v[128:143], v[192:195], a[0:3], v[128:143]
  ds_read_b64_tr_b16 v[200:201], v208 offset:36864
  ds_read_b64_tr_b16 v[202:203], v208 offset:37376
  s_add_u32 m0, s41, 0x1c000
  s_add_u32 s44, s46, s59
  buffer_load_dwordx4 v214, s[28:31], s44 offen offset:0 lds
  v_mfma_f32_32x32x16_bf16 v[144:159], v[192:195], a[4:7], v[144:159]
  ds_read_b64_tr_b16 v[204:205], v209 offset:36864
  ds_read_b64_tr_b16 v[206:207], v209 offset:37376
  v_max_f32 v227, 0, v227
  v_sub_f32 v247, v226, v246
  v_add_f32 v227, 0x3727c5ac, v227
  s_waitcnt lgkmcnt(4)
  v_mfma_f32_32x32x16_bf16 v[160:175], v[196:199], a[0:3], v[160:175]
  buffer_load_dwordx4 v215, s[28:31], s44 offen offset:1024 lds
  s_add_u32 s59, s59, 0x3c000
  v_cvt_pk_bf16_f32 v246, v246, v246
  v_rsq_f32 v227, v227
  v_mfma_f32_32x32x16_bf16 v[176:191], v[196:199], a[4:7], v[176:191]
  v_cvt_pk_bf16_f32 v247, v247, 0
  v_mov_b32 v228, v246
  v_mov_b32 v230, 0
  v_mov_b32 v232, 0
  v_mov_b32 v234, v246
  s_waitcnt lgkmcnt(2)
  v_mfma_f32_32x32x16_bf16 v[128:143], v[200:203], a[8:11], v[128:143]
  ds_read_b64_tr_b16 v[192:193], v208 offset:40960
  ds_read_b64_tr_b16 v[194:195], v208 offset:41472
  buffer_load_dwordx4 v216, s[28:31], s44 offen offset:2048 lds
  s_cmp_eq_u32 s59, 0x258000
  s_cselect_b32 s59, 0, s59
  v_mfma_f32_32x32x16_bf16 v[144:159], v[200:203], a[12:15], v[144:159]
  ds_read_b64_tr_b16 v[196:197], v209 offset:40960
  ds_read_b64_tr_b16 v[198:199], v209 offset:41472
  v_mov_b32 v229, v247
  v_mov_b32 v231, 0
  v_mov_b32 v233, 0
  s_waitcnt lgkmcnt(4)
  v_mfma_f32_32x32x16_bf16 v[160:175], v[204:207], a[8:11], v[160:175]
  buffer_load_dwordx4 v217, s[28:31], s44 offen offset:3072 lds
  v_mov_b32 v235, v247
  v_mov_b32 v220, v227
  v_permlane32_swap_b32 v228, v230
  v_permlane32_swap_b32 v232, v234
  v_mfma_f32_32x32x16_bf16 v[176:191], v[204:207], a[12:15], v[176:191]
  v_permlane32_swap_b32 v229, v231
  v_permlane32_swap_b32 v233, v235
  v_mov_b32 v223, v220
  s_nop 0
  s_nop 0
  v_permlane32_swap_b32 v220, v223
  s_waitcnt lgkmcnt(2)
  v_mfma_f32_32x32x16_bf16 v[128:143], v[192:195], a[16:19], v[128:143]
  ds_read_b64_tr_b16 v[200:201], v208 offset:45056
  ds_read_b64_tr_b16 v[202:203], v208 offset:45568
  s_add_u32 m0, s41, 0x20000
  s_add_u32 s44, s46, s59
  buffer_load_dwordx4 v214, s[28:31], s44 offen offset:0 lds
  v_mfma_f32_32x32x16_bf16 v[144:159], v[192:195], a[20:23], v[144:159]
  ds_read_b64_tr_b16 v[204:205], v209 offset:45056
  ds_read_b64_tr_b16 v[206:207], v209 offset:45568
  s_waitcnt vmcnt(24)
  v_add_f32 v236, v236, v237
  s_waitcnt vmcnt(22)
  v_add_f32 v238, v238, v239
  s_waitcnt vmcnt(20)
  v_add_f32 v240, v240, v241
  s_waitcnt lgkmcnt(4)
  v_mfma_f32_32x32x16_bf16 v[160:175], v[196:199], a[16:19], v[160:175]
  buffer_load_dwordx4 v215, s[28:31], s44 offen offset:1024 lds
  s_add_u32 s59, s59, 0x3c000
  s_waitcnt vmcnt(19)
  v_add_f32 v242, v242, v243
  s_waitcnt vmcnt(17)
  v_add_f32 v244, v244, v245
  v_add_f32 v236, v236, v238
  v_mfma_f32_32x32x16_bf16 v[176:191], v[196:199], a[20:23], v[176:191]
  s_waitcnt lgkmcnt(0)
  s_barrier
  v_mfma_f32_32x32x16_bf16 v[128:143], v[200:203], a[24:27], v[128:143]
  ds_read_b64_tr_b16 v[192:193], v208 offset:49152
  ds_read_b64_tr_b16 v[194:195], v208 offset:49664
  buffer_load_dwordx4 v216, s[28:31], s44 offen offset:2048 lds
  s_cmp_eq_u32 s59, 0x258000
  s_cselect_b32 s59, 0, s59
  v_mfma_f32_32x32x16_bf16 v[144:159], v[200:203], a[28:31], v[144:159]
  ds_read_b64_tr_b16 v[196:197], v209 offset:49152
  ds_read_b64_tr_b16 v[198:199], v209 offset:49664
  v_add_f32 v240, v240, v242
  v_add_f32 v236, v236, v244
  v_add_f32 v236, v236, v240
  v_mfma_f32_32x32x16_bf16 v[160:175], v[204:207], a[24:27], v[160:175]
  buffer_load_dwordx4 v217, s[28:31], s44 offen offset:3072 lds
  v_and_b32 v237, 0xffff0000, v236
  v_sub_f32 v236, v236, v237
  v_cvt_pk_bf16_f32 v226, v237, v236
  v_cvt_pk_bf16_f32 v227, v237, 0
  v_mfma_f32_32x32x16_bf16 v[176:191], v[204:207], a[28:31], v[176:191]
  s_nop 0
  v_mfma_f32_32x32x8_bf16 v[64:79], v[226:227], v[228:229], v[64:79]
  s_waitcnt lgkmcnt(2)
  v_mfma_f32_32x32x16_bf16 v[128:143], v[192:195], a[32:35], v[128:143]
  ds_read_b64_tr_b16 v[200:201], v208 offset:53248
  ds_read_b64_tr_b16 v[202:203], v208 offset:53760
  s_add_u32 m0, s41, 0x24000
  s_add_u32 s44, s46, s59
  buffer_load_dwordx4 v214, s[28:31], s44 offen offset:0 lds
  v_mfma_f32_32x32x16_bf16 v[144:159], v[192:195], a[36:39], v[144:159]
  ds_read_b64_tr_b16 v[204:205], v209 offset:53248
  ds_read_b64_tr_b16 v[206:207], v209 offset:53760
  v_mfma_f32_32x32x8_bf16 v[80:95], v[226:227], v[230:231], v[80:95]
  s_waitcnt lgkmcnt(4)
  v_mfma_f32_32x32x16_bf16 v[160:175], v[196:199], a[32:35], v[160:175]
  buffer_load_dwordx4 v215, s[28:31], s44 offen offset:1024 lds
  s_add_u32 s59, s59, 0x3c000
  v_mfma_f32_32x32x8_bf16 v[96:111], v[226:227], v[232:233], v[96:111]
  v_mfma_f32_32x32x16_bf16 v[176:191], v[196:199], a[36:39], v[176:191]
  v_mfma_f32_32x32x8_bf16 v[112:127], v[226:227], v[234:235], v[112:127]
  v_mul_f32 v221, s78, v220
  v_mul_f32 v224, s78, v223
  s_waitcnt lgkmcnt(2)
  v_mfma_f32_32x32x16_bf16 v[128:143], v[200:203], a[40:43], v[128:143]
  ds_read_b64_tr_b16 v[192:193], v208 offset:57344
  ds_read_b64_tr_b16 v[194:195], v208 offset:57856
  buffer_load_dwordx4 v216, s[28:31], s44 offen offset:2048 lds
  s_cmp_eq_u32 s59, 0x258000
  s_cselect_b32 s59, 0, s59
  v_mfma_f32_32x32x16_bf16 v[144:159], v[200:203], a[44:47], v[144:159]
  ds_read_b64_tr_b16 v[196:197], v209 offset:57344
  ds_read_b64_tr_b16 v[198:199], v209 offset:57856
  v_mul_f32 v64, v64, v221
  v_mul_f32 v65, v65, v221
  v_mul_f32 v66, v66, v221
  s_waitcnt lgkmcnt(4)
  v_mfma_f32_32x32x16_bf16 v[160:175], v[204:207], a[40:43], v[160:175]
  buffer_load_dwordx4 v217, s[28:31], s44 offen offset:3072 lds
  v_mul_f32 v67, v67, v221
  v_mul_f32 v68, v68, v221
  v_mul_f32 v69, v69, v221
  v_mul_f32 v70, v70, v221
  v_mfma_f32_32x32x16_bf16 v[176:191], v[204:207], a[44:47], v[176:191]
  v_mul_f32 v71, v71, v221
  v_cvt_pk_bf16_f32 v64, v64, v65
  v_cvt_pk_bf16_f32 v65, v66, v67
  v_cvt_pk_bf16_f32 v66, v68, v69
  v_cvt_pk_bf16_f32 v67, v70, v71
  s_waitcnt lgkmcnt(2)
  v_mfma_f32_32x32x16_bf16 v[128:143], v[192:195], a[48:51], v[128:143]
  ds_read_b64_tr_b16 v[200:201], v208 offset:61440
  ds_read_b64_tr_b16 v[202:203], v208 offset:61952
  s_add_u32 m0, s41, 0
  s_add_u32 s44, s47, s59
  buffer_load_dwordx4 v214, s[28:31], s44 offen offset:0 lds
  v_mfma_f32_32x32x16_bf16 v[144:159], v[192:195], a[52:55], v[144:159]
  ds_read_b64_tr_b16 v[204:205], v209 offset:61440
  ds_read_b64_tr_b16 v[206:207], v209 offset:61952
  s_add_u32 s60, s48, 0
  buffer_store_dwordx4 v[64:67], v218, s[36:39], s60 offen sc1
  s_waitcnt lgkmcnt(4)
  v_mfma_f32_32x32x16_bf16 v[160:175], v[196:199], a[48:51], v[160:175]
  buffer_load_dwordx4 v215, s[28:31], s44 offen offset:1024 lds
  s_add_u32 s59, s59, 0x3c000
  v_mfma_f32_32x32x16_bf16 v[176:191], v[196:199], a[52:55], v[176:191]
  s_waitcnt vmcnt(23) lgkmcnt(0)
  s_barrier
  v_mfma_f32_32x32x16_bf16 v[128:143], v[200:203], a[56:59], v[128:143]
  ds_read_b64_tr_b16 v[192:193], v210 offset:0
  ds_read_b64_tr_b16 v[194:195], v210 offset:512
  buffer_load_dwordx4 v216, s[28:31], s44 offen offset:2048 lds
  s_cmp_eq_u32 s59, 0x258000
  s_cselect_b32 s59, 0, s59
  v_mfma_f32_32x32x16_bf16 v[144:159], v[200:203], a[60:63], v[144:159]
  ds_read_b64_tr_b16 v[196:197], v211 offset:0
  ds_read_b64_tr_b16 v[198:199], v211 offset:512
  v_mul_f32 v72, v72, v221
  v_mul_f32 v73, v73, v221
  v_mul_f32 v74, v74, v221
  v_mfma_f32_32x32x16_bf16 v[160:175], v[204:207], a[56:59], v[160:175]
  buffer_load_dwordx4 v217, s[28:31], s44 offen offset:3072 lds
  v_mul_f32 v75, v75, v221
  v_mul_f32 v76, v76, v221
  v_mul_f32 v77, v77, v221
  v_mul_f32 v78, v78, v221
  v_mfma_f32_32x32x16_bf16 v[176:191], v[204:207], a[60:63], v[176:191]
  v_mul_f32 v79, v79, v221
  v_cvt_pk_bf16_f32 v72, v72, v73
  v_cvt_pk_bf16_f32 v73, v74, v75
  v_cvt_pk_bf16_f32 v74, v76, v77
  v_cvt_pk_bf16_f32 v75, v78, v79
  s_waitcnt lgkmcnt(2)
  v_mfma_f32_32x32x16_bf16 v[128:143], v[192:195], a[64:67], v[128:143]
  ds_read_b64_tr_b16 v[200:201], v210 offset:4096
  ds_read_b64_tr_b16 v[202:203], v210 offset:4608
  s_add_u32 m0, s41, 0x4000
  s_add_u32 s44, s47, s59
  buffer_load_dwordx4 v214, s[28:31], s44 offen offset:0 lds
  v_mfma_f32_32x32x16_bf16 v[144:159], v[192:195], a[68:71], v[144:159]
  ds_read_b64_tr_b16 v[204:205], v211 offset:4096
  ds_read_b64_tr_b16 v[206:207], v211 offset:4608
  s_add_u32 s61, s48, 0x1000
  buffer_store_dwordx4 v[72:75], v218, s[36:39], s61 offen sc1
  s_waitcnt lgkmcnt(4)
  v_mfma_f32_32x32x16_bf16 v[160:175], v[196:199], a[64:67], v[160:175]
  buffer_load_dwordx4 v215, s[28:31], s44 offen offset:1024 lds
  s_add_u32 s59, s59, 0x3c000
  v_mfma_f32_32x32x16_bf16 v[176:191], v[196:199], a[68:71], v[176:191]
  v_mul_f32 v80, v80, v224
  v_mul_f32 v81, v81, v224
  v_mul_f32 v82, v82, v224
  v_mul_f32 v83, v83, v224
  v_mul_f32 v84, v84, v224
  s_waitcnt lgkmcnt(2)
  v_mfma_f32_32x32x16_bf16 v[128:143], v[200:203], a[72:75], v[128:143]
  ds_read_b64_tr_b16 v[192:193], v210 offset:8192
  ds_read_b64_tr_b16 v[194:195], v210 offset:8704
  buffer_load_dwordx4 v216, s[28:31], s44 offen offset:2048 lds
  s_cmp_eq_u32 s59, 0x258000
  s_cselect_b32 s59, 0, s59
  v_mfma_f32_32x32x16_bf16 v[144:159], v[200:203], a[76:79], v[144:159]
  ds_read_b64_tr_b16 v[196:197], v211 offset:8192
  ds_read_b64_tr_b16 v[198:199], v211 offset:8704
  v_mul_f32 v85, v85, v224
  v_mul_f32 v86, v86, v224
  v_mul_f32 v87, v87, v224
  s_waitcnt lgkmcnt(4)
  v_mfma_f32_32x32x16_bf16 v[160:175], v[204:207], a[72:75], v[160:175]
  buffer_load_dwordx4 v217, s[28:31], s44 offen offset:3072 lds
  v_cvt_pk_bf16_f32 v80, v80, v81
  v_cvt_pk_bf16_f32 v81, v82, v83
  v_cvt_pk_bf16_f32 v82, v84, v85
  v_cvt_pk_bf16_f32 v83, v86, v87
  v_mfma_f32_32x32x16_bf16 v[176:191], v[204:207], a[76:79], v[176:191]
  s_add_u32 s62, s48, 0x14000
  buffer_store_dwordx4 v[80:83], v218, s[36:39], s62 offen sc1
  s_waitcnt lgkmcnt(2)
  v_mfma_f32_32x32x16_bf16 v[128:143], v[192:195], a[80:83], v[128:143]
  ds_read_b64_tr_b16 v[200:201], v210 offset:12288
  ds_read_b64_tr_b16 v[202:203], v210 offset:12800
  v_mfma_f32_32x32x16_bf16 v[144:159], v[192:195], a[84:87], v[144:159]
  ds_read_b64_tr_b16 v[204:205], v211 offset:12288
  ds_read_b64_tr_b16 v[206:207], v211 offset:12800
  v_mul_f32 v88, v88, v224
  v_mul_f32 v89, v89, v224
  v_mul_f32 v90, v90, v224
  s_waitcnt lgkmcnt(4)
  v_mfma_f32_32x32x16_bf16 v[160:175], v[196:199], a[80:83], v[160:175]
  v_mul_f32 v91, v91, v224
  v_mul_f32 v92, v92, v224
  v_mul_f32 v93, v93, v224
  v_mul_f32 v94, v94, v224
  v_mul_f32 v95, v95, v224
  v_mfma_f32_32x32x16_bf16 v[176:191], v[196:199], a[84:87], v[176:191]
  s_waitcnt vmcnt(27) lgkmcnt(0)
  s_barrier
  v_mfma_f32_32x32x16_bf16 v[128:143], v[200:203], a[88:91], v[128:143]
  ds_read_b64_tr_b16 v[192:193], v210 offset:16384
  ds_read_b64_tr_b16 v[194:195], v210 offset:16896
  v_cvt_pk_bf16_f32 v88, v88, v89
  v_cvt_pk_bf16_f32 v89, v90, v91
  v_cvt_pk_bf16_f32 v90, v92, v93
  v_mfma_f32_32x32x16_bf16 v[144:159], v[200:203], a[92:95], v[144:159]
  ds_read_b64_tr_b16 v[196:197], v211 offset:16384
  ds_read_b64_tr_b16 v[198:199], v211 offset:16896
  v_cvt_pk_bf16_f32 v91, v94, v95
  s_add_u32 s63, s48, 0x15000
  buffer_store_dwordx4 v[88:91], v218, s[36:39], s63 offen sc1
  v_mfma_f32_32x32x16_bf16 v[160:175], v[204:207], a[88:91], v[160:175]
  v_mfma_f32_32x32x16_bf16 v[176:191], v[204:207], a[92:95], v[176:191]
  s_waitcnt lgkmcnt(2)
  v_mfma_f32_32x32x16_bf16 v[128:143], v[192:195], a[96:99], v[128:143]
  ds_read_b64_tr_b16 v[200:201], v210 offset:20480
  ds_read_b64_tr_b16 v[202:203], v210 offset:20992
  v_mul_f32 v96, v96, v221
  v_mul_f32 v97, v97, v221
  v_mul_f32 v98, v98, v221
  v_mfma_f32_32x32x16_bf16 v[144:159], v[192:195], a[100:103], v[144:159]
  ds_read_b64_tr_b16 v[204:205], v211 offset:20480
  ds_read_b64_tr_b16 v[206:207], v211 offset:20992
  v_mul_f32 v99, v99, v221
  v_mul_f32 v100, v100, v221
  v_mul_f32 v101, v101, v221
  s_waitcnt lgkmcnt(4)
  v_mfma_f32_32x32x16_bf16 v[160:175], v[196:199], a[96:99], v[160:175]
  v_mul_f32 v102, v102, v221
  v_mul_f32 v103, v103, v221
  v_cvt_pk_bf16_f32 v96, v96, v97
  v_cvt_pk_bf16_f32 v97, v98, v99
  v_cvt_pk_bf16_f32 v98, v100, v101
  v_mfma_f32_32x32x16_bf16 v[176:191], v[196:199], a[100:103], v[176:191]
  v_cvt_pk_bf16_f32 v99, v102, v103
  s_add_u32 s60, s51, 0
  buffer_store_dwordx4 v[96:99], v218, s[36:39], s60 offen sc1
  s_waitcnt lgkmcnt(2)
  v_mfma_f32_32x32x16_bf16 v[128:143], v[200:203], a[104:107], v[128:143]
  ds_read_b64_tr_b16 v[192:193], v210 offset:24576
  ds_read_b64_tr_b16 v[194:195], v210 offset:25088
  v_mfma_f32_32x32x16_bf16 v[144:159], v[200:203], a[108:111], v[144:159]
  ds_read_b64_tr_b16 v[196:197], v211 offset:24576
  ds_read_b64_tr_b16 v[198:199], v211 offset:25088
  v_mul_f32 v104, v104, v221
  v_mul_f32 v105, v105, v221
  v_mul_f32 v106, v106, v221
  s_waitcnt lgkmcnt(4)
  v_mfma_f32_32x32x16_bf16 v[160:175], v[204:207], a[104:107], v[160:175]
  v_mul_f32 v107, v107, v221
  v_mul_f32 v108, v108, v221
  v_mul_f32 v109, v109, v221
  v_mul_f32 v110, v110, v221
  v_mul_f32 v111, v111, v221
  v_mfma_f32_32x32x16_bf16 v[176:191], v[204:207], a[108:111], v[176:191]
  v_cvt_pk_bf16_f32 v104, v104, v105
  v_cvt_pk_bf16_f32 v105, v106, v107
  v_cvt_pk_bf16_f32 v106, v108, v109
  v_cvt_pk_bf16_f32 v107, v110, v111
  s_add_u32 s61, s51, 0x1000
  s_waitcnt lgkmcnt(2)
  v_mfma_f32_32x32x16_bf16 v[128:143], v[192:195], a[112:115], v[128:143]
  ds_read_b64_tr_b16 v[200:201], v210 offset:28672
  ds_read_b64_tr_b16 v[202:203], v210 offset:29184
  buffer_store_dwordx4 v[104:107], v218, s[36:39], s61 offen sc1
  v_mfma_f32_32x32x16_bf16 v[144:159], v[192:195], a[116:119], v[144:159]
  ds_read_b64_tr_b16 v[204:205], v211 offset:28672
  ds_read_b64_tr_b16 v[206:207], v211 offset:29184
  s_waitcnt lgkmcnt(4)
  v_mfma_f32_32x32x16_bf16 v[160:175], v[196:199], a[112:115], v[160:175]
  v_mul_f32 v112, v112, v224
  v_mul_f32 v113, v113, v224
  v_mul_f32 v114, v114, v224
  v_mul_f32 v115, v115, v224
  v_mul_f32 v116, v116, v224
  v_mfma_f32_32x32x16_bf16 v[176:191], v[196:199], a[116:119], v[176:191]
  s_waitcnt vmcnt(26) lgkmcnt(0)
  s_barrier
  v_mfma_f32_32x32x16_bf16 v[128:143], v[200:203], a[120:123], v[128:143]
  ds_read_b64_tr_b16 v[192:193], v210 offset:32768
  ds_read_b64_tr_b16 v[194:195], v210 offset:33280
  s_add_u32 m0, s41, 0x8000
  s_add_u32 s44, s47, s59
  buffer_load_dwordx4 v214, s[28:31], s44 offen offset:0 lds
  v_mfma_f32_32x32x16_bf16 v[144:159], v[200:203], a[124:127], v[144:159]
  ds_read_b64_tr_b16 v[196:197], v211 offset:32768
  ds_read_b64_tr_b16 v[198:199], v211 offset:33280
  buffer_load_dwordx4 v215, s[28:31], s44 offen offset:1024 lds
  s_add_u32 s59, s59, 0x3c000
  v_mul_f32 v117, v117, v224
  v_mfma_f32_32x32x16_bf16 v[160:175], v[204:207], a[120:123], v[160:175]
  buffer_load_dwordx4 v216, s[28:31], s44 offen offset:2048 lds
  s_cmp_eq_u32 s59, 0x258000
  s_cselect_b32 s59, 0, s59
  v_mul_f32 v118, v118, v224
  v_mul_f32 v119, v119, v224
  v_mfma_f32_32x32x16_bf16 v[176:191], v[204:207], a[124:127], v[176:191]
  v_cvt_pk_bf16_f32 v112, v112, v113
  v_cvt_pk_bf16_f32 v113, v114, v115
  v_cvt_pk_bf16_f32 v114, v116, v117
  v_cvt_pk_bf16_f32 v115, v118, v119
  s_add_u32 s62, s51, 0x14000
  s_waitcnt lgkmcnt(2)
  v_mfma_f32_32x32x16_bf16 v[128:143], v[192:195], a[128:131], v[128:143]
  ds_read_b64_tr_b16 v[200:201], v210 offset:36864
  ds_read_b64_tr_b16 v[202:203], v210 offset:37376
  buffer_load_dwordx4 v217, s[28:31], s44 offen offset:3072 lds
  buffer_store_dwordx4 v[112:115], v218, s[36:39], s62 offen sc1
  v_mfma_f32_32x32x16_bf16 v[144:159], v[192:195], a[132:135], v[144:159]
  ds_read_b64_tr_b16 v[204:205], v211 offset:36864
  ds_read_b64_tr_b16 v[206:207], v211 offset:37376
  s_waitcnt lgkmcnt(4)
  v_mfma_f32_32x32x16_bf16 v[160:175], v[196:199], a[128:131], v[160:175]
  s_add_u32 m0, s41, 0xc000
  s_add_u32 s44, s47, s59
  buffer_load_dwordx4 v214, s[28:31], s44 offen offset:0 lds
  v_mul_f32 v120, v120, v224
  v_mul_f32 v121, v121, v224
  v_mfma_f32_32x32x16_bf16 v[176:191], v[196:199], a[132:135], v[176:191]
  v_mul_f32 v122, v122, v224
  v_mul_f32 v123, v123, v224
  v_mul_f32 v124, v124, v224
  v_mul_f32 v125, v125, v224
  v_mul_f32 v126, v126, v224
  s_waitcnt lgkmcnt(2)
  v_mfma_f32_32x32x16_bf16 v[128:143], v[200:203], a[136:139], v[128:143]
  ds_read_b64_tr_b16 v[192:193], v210 offset:40960
  ds_read_b64_tr_b16 v[194:195], v210 offset:41472
  buffer_load_dwordx4 v215, s[28:31], s44 offen offset:1024 lds
  s_add_u32 s59, s59, 0x3c000
  v_mul_f32 v127, v127, v224
  v_mfma_f32_32x32x16_bf16 v[144:159], v[200:203], a[140:143], v[144:159]
  ds_read_b64_tr_b16 v[196:197], v211 offset:40960
  ds_read_b64_tr_b16 v[198:199], v211 offset:41472
  v_cvt_pk_bf16_f32 v120, v120, v121
  v_cvt_pk_bf16_f32 v121, v122, v123
  v_cvt_pk_bf16_f32 v122, v124, v125
  s_waitcnt lgkmcnt(4)
  v_mfma_f32_32x32x16_bf16 v[160:175], v[204:207], a[136:139], v[160:175]
  buffer_load_dwordx4 v216, s[28:31], s44 offen offset:2048 lds
  s_cmp_eq_u32 s59, 0x258000
  s_cselect_b32 s59, 0, s59
  v_cvt_pk_bf16_f32 v123, v126, v127
  s_add_u32 s63, s51, 0x15000
  v_mfma_f32_32x32x16_bf16 v[176:191], v[204:207], a[140:143], v[176:191]
  buffer_store_dwordx4 v[120:123], v218, s[36:39], s63 offen sc1
  s_waitcnt lgkmcnt(2)
  v_mfma_f32_32x32x16_bf16 v[128:143], v[192:195], a[144:147], v[128:143]
  ds_read_b64_tr_b16 v[200:201], v210 offset:45056
  ds_read_b64_tr_b16 v[202:203], v210 offset:45568
  buffer_load_dwordx4 v217, s[28:31], s44 offen offset:3072 lds
  v_mfma_f32_32x32x16_bf16 v[144:159], v[192:195], a[148:151], v[144:159]
  ds_read_b64_tr_b16 v[204:205], v211 offset:45056
  ds_read_b64_tr_b16 v[206:207], v211 offset:45568
  s_waitcnt lgkmcnt(4)
  v_mfma_f32_32x32x16_bf16 v[160:175], v[196:199], a[144:147], v[160:175]
  v_mfma_f32_32x32x16_bf16 v[176:191], v[196:199], a[148:151], v[176:191]
  s_waitcnt vmcnt(32) lgkmcnt(0)
  s_barrier
  v_mfma_f32_32x32x16_bf16 v[128:143], v[200:203], a[152:155], v[128:143]
  ds_read_b64_tr_b16 v[192:193], v210 offset:49152
  ds_read_b64_tr_b16 v[194:195], v210 offset:49664
  s_add_u32 m0, s41, 0x10000
  s_add_u32 s44, s47, s59
  buffer_load_dwordx4 v214, s[28:31], s44 offen offset:0 lds
  v_mfma_f32_32x32x16_bf16 v[144:159], v[200:203], a[156:159], v[144:159]
  ds_read_b64_tr_b16 v[196:197], v211 offset:49152
  ds_read_b64_tr_b16 v[198:199], v211 offset:49664
  buffer_load_dwordx4 v215, s[28:31], s44 offen offset:1024 lds
  s_add_u32 s59, s59, 0x3c000
  v_mfma_f32_32x32x16_bf16 v[160:175], v[204:207], a[152:155], v[160:175]
  buffer_load_dwordx4 v216, s[28:31], s44 offen offset:2048 lds
  s_cmp_eq_u32 s59, 0x258000
  s_cselect_b32 s59, 0, s59
  v_mfma_f32_32x32x16_bf16 v[176:191], v[204:207], a[156:159], v[176:191]
  s_waitcnt lgkmcnt(2)
  v_mfma_f32_32x32x16_bf16 v[128:143], v[192:195], a[160:163], v[128:143]
  ds_read_b64_tr_b16 v[200:201], v210 offset:53248
  ds_read_b64_tr_b16 v[202:203], v210 offset:53760
  buffer_load_dwordx4 v217, s[28:31], s44 offen offset:3072 lds
  v_mfma_f32_32x32x16_bf16 v[144:159], v[192:195], a[164:167], v[144:159]
  ds_read_b64_tr_b16 v[204:205], v211 offset:53248
  ds_read_b64_tr_b16 v[206:207], v211 offset:53760
  s_waitcnt lgkmcnt(4)
  v_mfma_f32_32x32x16_bf16 v[160:175], v[196:199], a[160:163], v[160:175]
  s_add_u32 m0, s41, 0x14000
  s_add_u32 s44, s47, s59
  buffer_load_dwordx4 v214, s[28:31], s44 offen offset:0 lds
  v_mfma_f32_32x32x16_bf16 v[176:191], v[196:199], a[164:167], v[176:191]
  s_waitcnt lgkmcnt(2)
  v_mfma_f32_32x32x16_bf16 v[128:143], v[200:203], a[168:171], v[128:143]
  ds_read_b64_tr_b16 v[192:193], v210 offset:57344
  ds_read_b64_tr_b16 v[194:195], v210 offset:57856
  buffer_load_dwordx4 v215, s[28:31], s44 offen offset:1024 lds
  s_add_u32 s59, s59, 0x3c000
  v_mfma_f32_32x32x16_bf16 v[144:159], v[200:203], a[172:175], v[144:159]
  ds_read_b64_tr_b16 v[196:197], v211 offset:57344
  ds_read_b64_tr_b16 v[198:199], v211 offset:57856
  s_waitcnt lgkmcnt(4)
  v_mfma_f32_32x32x16_bf16 v[160:175], v[204:207], a[168:171], v[160:175]
  buffer_load_dwordx4 v216, s[28:31], s44 offen offset:2048 lds
  s_cmp_eq_u32 s59, 0x258000
  s_cselect_b32 s59, 0, s59
  v_mfma_f32_32x32x16_bf16 v[176:191], v[204:207], a[172:175], v[176:191]
  s_waitcnt lgkmcnt(2)
  v_mfma_f32_32x32x16_bf16 v[128:143], v[192:195], a[176:179], v[128:143]
  ds_read_b64_tr_b16 v[200:201], v210 offset:61440
  ds_read_b64_tr_b16 v[202:203], v210 offset:61952
  buffer_load_dwordx4 v217, s[28:31], s44 offen offset:3072 lds
  v_mfma_f32_32x32x16_bf16 v[144:159], v[192:195], a[180:183], v[144:159]
  ds_read_b64_tr_b16 v[204:205], v211 offset:61440
  ds_read_b64_tr_b16 v[206:207], v211 offset:61952
  s_waitcnt lgkmcnt(4)
  v_mfma_f32_32x32x16_bf16 v[160:175], v[196:199], a[176:179], v[160:175]
  v_mfma_f32_32x32x16_bf16 v[176:191], v[196:199], a[180:183], v[176:191]
  s_waitcnt vmcnt(36) lgkmcnt(0)
  s_barrier
  v_mfma_f32_32x32x16_bf16 v[128:143], v[200:203], a[184:187], v[128:143]
  ds_read_b64_tr_b16 v[192:193], v212 offset:0
  ds_read_b64_tr_b16 v[194:195], v212 offset:512
  s_add_u32 s67, s55, 0x1400
  buffer_load_dword v238, v219, s[36:39], s67 offen offset:0 sc1
  v_mfma_f32_32x32x16_bf16 v[144:159], v[200:203], a[188:191], v[144:159]
  ds_read_b64_tr_b16 v[196:197], v213 offset:0
  ds_read_b64_tr_b16 v[198:199], v213 offset:512
  buffer_load_dword v239, v219, s[36:39], s67 offen offset:128 sc1
  v_mfma_f32_32x32x16_bf16 v[160:175], v[204:207], a[184:187], v[160:175]
  s_add_u32 m0, s41, 0x18000
  s_add_u32 s44, s47, s59
  buffer_load_dwordx4 v214, s[28:31], s44 offen offset:0 lds
  v_mfma_f32_32x32x16_bf16 v[176:191], v[204:207], a[188:191], v[176:191]
  buffer_load_dwordx4 v215, s[28:31], s44 offen offset:1024 lds
  s_add_u32 s59, s59, 0x3c000
  s_waitcnt lgkmcnt(2)
  v_mfma_f32_32x32x16_bf16 v[128:143], v[192:195], a[192:195], v[128:143]
  ds_read_b64_tr_b16 v[200:201], v212 offset:4096
  ds_read_b64_tr_b16 v[202:203], v212 offset:4608
  buffer_load_dwordx4 v216, s[28:31], s44 offen offset:2048 lds
  s_cmp_eq_u32 s59, 0x258000
  s_cselect_b32 s59, 0, s59
  v_mfma_f32_32x32x16_bf16 v[144:159], v[192:195], a[196:199], v[144:159]
  ds_read_b64_tr_b16 v[204:205], v213 offset:4096
  ds_read_b64_tr_b16 v[206:207], v213 offset:4608
  s_waitcnt lgkmcnt(4)
  v_mfma_f32_32x32x16_bf16 v[160:175], v[196:199], a[192:195], v[160:175]
  buffer_load_dwordx4 v217, s[28:31], s44 offen offset:3072 lds
  v_mfma_f32_32x32x16_bf16 v[176:191], v[196:199], a[196:199], v[176:191]
  s_waitcnt lgkmcnt(2)
  v_mfma_f32_32x32x16_bf16 v[128:143], v[200:203], a[200:203], v[128:143]
  ds_read_b64_tr_b16 v[192:193], v212 offset:8192
  ds_read_b64_tr_b16 v[194:195], v212 offset:8704
  s_add_u32 m0, s41, 0x1c000
  s_add_u32 s44, s47, s59
  buffer_load_dwordx4 v214, s[28:31], s44 offen offset:0 lds
  v_mfma_f32_32x32x16_bf16 v[144:159], v[200:203], a[204:207], v[144:159]
  ds_read_b64_tr_b16 v[196:197], v213 offset:8192
  ds_read_b64_tr_b16 v[198:199], v213 offset:8704
  s_waitcnt lgkmcnt(4)
  v_mfma_f32_32x32x16_bf16 v[160:175], v[204:207], a[200:203], v[160:175]
  buffer_load_dwordx4 v215, s[28:31], s44 offen offset:1024 lds
  s_add_u32 s59, s59, 0x3c000
  v_mfma_f32_32x32x16_bf16 v[176:191], v[204:207], a[204:207], v[176:191]
  s_waitcnt lgkmcnt(2)
  v_mfma_f32_32x32x16_bf16 v[128:143], v[192:195], a[208:211], v[128:143]
  ds_read_b64_tr_b16 v[200:201], v212 offset:12288
  ds_read_b64_tr_b16 v[202:203], v212 offset:12800
  buffer_load_dwordx4 v216, s[28:31], s44 offen offset:2048 lds
  s_cmp_eq_u32 s59, 0x258000
  s_cselect_b32 s59, 0, s59
  v_mfma_f32_32x32x16_bf16 v[144:159], v[192:195], a[212:215], v[144:159]
  ds_read_b64_tr_b16 v[204:205], v213 offset:12288
  ds_read_b64_tr_b16 v[206:207], v213 offset:12800
  s_waitcnt lgkmcnt(4)
  v_mfma_f32_32x32x16_bf16 v[160:175], v[196:199], a[208:211], v[160:175]
  buffer_load_dwordx4 v217, s[28:31], s44 offen offset:3072 lds
  v_mfma_f32_32x32x16_bf16 v[176:191], v[196:199], a[212:215], v[176:191]
  s_waitcnt vmcnt(42) lgkmcnt(0)
  s_barrier
  v_mfma_f32_32x32x16_bf16 v[128:143], v[200:203], a[216:219], v[128:143]
  ds_read_b64_tr_b16 v[192:193], v212 offset:16384
  ds_read_b64_tr_b16 v[194:195], v212 offset:16896
  s_add_u32 m0, s41, 0x20000
  s_add_u32 s44, s47, s59
  buffer_load_dwordx4 v214, s[28:31], s44 offen offset:0 lds
  v_mfma_f32_32x32x16_bf16 v[144:159], v[200:203], a[220:223], v[144:159]
  ds_read_b64_tr_b16 v[196:197], v213 offset:16384
  ds_read_b64_tr_b16 v[198:199], v213 offset:16896
  v_mfma_f32_32x32x16_bf16 v[160:175], v[204:207], a[216:219], v[160:175]
  buffer_load_dwordx4 v215, s[28:31], s44 offen offset:1024 lds
  s_add_u32 s59, s59, 0x3c000
  v_mfma_f32_32x32x16_bf16 v[176:191], v[204:207], a[220:223], v[176:191]
  s_waitcnt lgkmcnt(2)
  v_mfma_f32_32x32x16_bf16 v[128:143], v[192:195], a[224:227], v[128:143]
  ds_read_b64_tr_b16 v[200:201], v212 offset:20480
  ds_read_b64_tr_b16 v[202:203], v212 offset:20992
  buffer_load_dwordx4 v216, s[28:31], s44 offen offset:2048 lds
  s_cmp_eq_u32 s59, 0x258000
  s_cselect_b32 s59, 0, s59
  v_mfma_f32_32x32x16_bf16 v[144:159], v[192:195], a[228:231], v[144:159]
  ds_read_b64_tr_b16 v[204:205], v213 offset:20480
  ds_read_b64_tr_b16 v[206:207], v213 offset:20992
  s_waitcnt lgkmcnt(4)
  v_mfma_f32_32x32x16_bf16 v[160:175], v[196:199], a[224:227], v[160:175]
  buffer_load_dwordx4 v217, s[28:31], s44 offen offset:3072 lds
  v_mfma_f32_32x32x16_bf16 v[176:191], v[196:199], a[228:231], v[176:191]
  s_waitcnt lgkmcnt(2)
  v_mfma_f32_32x32x16_bf16 v[128:143], v[200:203], a[232:235], v[128:143]
  ds_read_b64_tr_b16 v[192:193], v212 offset:24576
  ds_read_b64_tr_b16 v[194:195], v212 offset:25088
  v_mfma_f32_32x32x16_bf16 v[144:159], v[200:203], a[236:239], v[144:159]
  ds_read_b64_tr_b16 v[196:197], v213 offset:24576
  ds_read_b64_tr_b16 v[198:199], v213 offset:25088
  s_waitcnt lgkmcnt(4)
  v_mfma_f32_32x32x16_bf16 v[160:175], v[204:207], a[232:235], v[160:175]
  v_mfma_f32_32x32x16_bf16 v[176:191], v[204:207], a[236:239], v[176:191]
  s_waitcnt lgkmcnt(2)
  v_mfma_f32_32x32x16_bf16 v[128:143], v[192:195], a[240:243], v[128:143]
  ds_read_b64_tr_b16 v[200:201], v212 offset:28672
  ds_read_b64_tr_b16 v[202:203], v212 offset:29184
  v_mfma_f32_32x32x16_bf16 v[144:159], v[192:195], a[244:247], v[144:159]
  ds_read_b64_tr_b16 v[204:205], v213 offset:28672
  ds_read_b64_tr_b16 v[206:207], v213 offset:29184
  s_waitcnt lgkmcnt(4)
  v_mfma_f32_32x32x16_bf16 v[160:175], v[196:199], a[240:243], v[160:175]
  v_mfma_f32_32x32x16_bf16 v[176:191], v[196:199], a[244:247], v[176:191]
  s_waitcnt vmcnt(41) lgkmcnt(0)
  s_barrier
  v_mfma_f32_32x32x16_bf16 v[128:143], v[200:203], a[248:251], v[128:143]
  ds_read_b64_tr_b16 v[192:193], v208 offset:0
  ds_read_b64_tr_b16 v[194:195], v208 offset:512
  s_add_u32 m0, s41, 0x24000
  s_add_u32 s44, s47, s59
  buffer_load_dwordx4 v214, s[28:31], s44 offen offset:0 lds
  v_mfma_f32_32x32x16_bf16 v[144:159], v[200:203], a[252:255], v[144:159]
  ds_read_b64_tr_b16 v[196:197], v208 offset:4096
  ds_read_b64_tr_b16 v[198:199], v208 offset:4608
  buffer_load_dwordx4 v215, s[28:31], s44 offen offset:1024 lds
  s_add_u32 s59, s59, 0x3c000
  v_mfma_f32_32x32x16_bf16 v[160:175], v[204:207], a[248:251], v[160:175]
  buffer_load_dwordx4 v216, s[28:31], s44 offen offset:2048 lds
  s_cmp_eq_u32 s59, 0x258000
  s_cselect_b32 s59, 0, s59
  v_mfma_f32_32x32x16_bf16 v[176:191], v[204:207], a[252:255], v[176:191]
  s_waitcnt lgkmcnt(2)
  v_mfma_f32_32x32x16_bf16 v[64:79], v[0:3], v[192:195], 0
  ds_read_b64_tr_b16 v[200:201], v208 offset:8192
  ds_read_b64_tr_b16 v[202:203], v208 offset:8704
  buffer_load_dwordx4 v217, s[28:31], s44 offen offset:3072 lds
  v_mfma_f32_32x32x16_bf16 v[80:95], v[4:7], v[192:195], 0
  ds_read_b64_tr_b16 v[204:205], v208 offset:12288
  ds_read_b64_tr_b16 v[206:207], v208 offset:12800
  s_waitcnt lgkmcnt(4)
  v_mfma_f32_32x32x16_bf16 v[64:79], v[8:11], v[196:199], v[64:79]
  v_mfma_f32_32x32x16_bf16 v[80:95], v[12:15], v[196:199], v[80:95]
  s_waitcnt vmcnt(16)
  v_max_u32 v226, v238, v239
  v_cmp_eq_u32 vcc, -1, v226
  s_nop 0
  s_cmp_lg_u64 vcc, 0
  s_cbranch_scc1 qkv_cs1
qkv_cs1_d:
  s_waitcnt lgkmcnt(0)
  s_barrier
  v_mfma_f32_32x32x16_bf16 v[64:79], v[16:19], v[200:203], v[64:79]
  ds_read_b64_tr_b16 v[192:193], v208 offset:16384
  ds_read_b64_tr_b16 v[194:195], v208 offset:16896
  v_add_f32 v238, v238, v239
  v_and_b32 v239, 0xffff0000, v238
  v_sub_f32 v238, v238, v239
  v_mfma_f32_32x32x16_bf16 v[80:95], v[20:23], v[200:203], v[80:95]
  ds_read_b64_tr_b16 v[196:197], v208 offset:20480
  ds_read_b64_tr_b16 v[198:199], v208 offset:20992
  v_cvt_pk_bf16_f32 v226, v239, v238
  v_cvt_pk_bf16_f32 v227, v239, 0
  v_mfma_f32_32x32x16_bf16 v[64:79], v[24:27], v[204:207], v[64:79]
  s_nop 0
  v_mfma_f32_32x32x8_bf16 v[128:143], v[226:227], v[228:229], v[128:143]
  v_mfma_f32_32x32x16_bf16 v[80:95], v[28:31], v[204:207], v[80:95]
  v_mfma_f32_32x32x8_bf16 v[144:159], v[226:227], v[230:231], v[144:159]
  s_waitcnt lgkmcnt(2)
  v_mfma_f32_32x32x16_bf16 v[64:79], v[32:35], v[192:195], v[64:79]
  ds_read_b64_tr_b16 v[200:201], v208 offset:24576
  ds_read_b64_tr_b16 v[202:203], v208 offset:25088
  v_mfma_f32_32x32x8_bf16 v[160:175], v[226:227], v[232:233], v[160:175]
  v_mfma_f32_32x32x16_bf16 v[80:95], v[36:39], v[192:195], v[80:95]
  ds_read_b64_tr_b16 v[204:205], v208 offset:28672
  ds_read_b64_tr_b16 v[206:207], v208 offset:29184
  v_mfma_f32_32x32x8_bf16 v[176:191], v[226:227], v[234:235], v[176:191]
  s_waitcnt lgkmcnt(4)
  v_mfma_f32_32x32x16_bf16 v[64:79], v[40:43], v[196:199], v[64:79]
  v_mul_f32 v221, s79, v220
  v_mul_f32 v224, s79, v223
  v_mul_f32 v128, v128, v221
  v_mul_f32 v129, v129, v221
  v_mul_f32 v130, v130, v221
  v_mfma_f32_32x32x16_bf16 v[80:95], v[44:47], v[196:199], v[80:95]
  s_waitcnt lgkmcnt(0)
  s_barrier
  v_mfma_f32_32x32x16_bf16 v[64:79], v[48:51], v[200:203], v[64:79]
  ds_read_b64_tr_b16 v[192:193], v208 offset:32768
  ds_read_b64_tr_b16 v[194:195], v208 offset:33280
  v_mul_f32 v131, v131, v221
  v_mul_f32 v132, v132, v221
  v_mul_f32 v133, v133, v221
  v_mfma_f32_32x32x16_bf16 v[80:95], v[52:55], v[200:203], v[80:95]
  ds_read_b64_tr_b16 v[196:197], v208 offset:36864
  ds_read_b64_tr_b16 v[198:199], v208 offset:37376
  v_mul_f32 v134, v134, v221
  v_mul_f32 v135, v135, v221
  v_cvt_pk_bf16_f32 v128, v128, v129
  v_mfma_f32_32x32x16_bf16 v[64:79], v[56:59], v[204:207], v[64:79]
  v_cvt_pk_bf16_f32 v129, v130, v131
  v_cvt_pk_bf16_f32 v130, v132, v133
  v_cvt_pk_bf16_f32 v131, v134, v135
  s_add_u32 s60, s49, 0
  buffer_store_dwordx4 v[128:131], v218, s[36:39], s60 offen sc1
  v_mfma_f32_32x32x16_bf16 v[80:95], v[60:63], v[204:207], v[80:95]
  v_mul_f32 v136, v136, v221
  v_mul_f32 v137, v137, v221
  v_mul_f32 v138, v138, v221
  v_mul_f32 v139, v139, v221
  v_mul_f32 v140, v140, v221
  s_waitcnt lgkmcnt(2)
  v_mfma_f32_32x32x16_bf16 v[64:79], a[0:3], v[192:195], v[64:79]
  ds_read_b64_tr_b16 v[200:201], v208 offset:40960
  ds_read_b64_tr_b16 v[202:203], v208 offset:41472
  v_mul_f32 v141, v141, v221
  v_mul_f32 v142, v142, v221
  v_mul_f32 v143, v143, v221
  v_mfma_f32_32x32x16_bf16 v[80:95], a[4:7], v[192:195], v[80:95]
  ds_read_b64_tr_b16 v[204:205], v208 offset:45056
  ds_read_b64_tr_b16 v[206:207], v208 offset:45568
  v_cvt_pk_bf16_f32 v136, v136, v137
  v_cvt_pk_bf16_f32 v137, v138, v139
  v_cvt_pk_bf16_f32 v138, v140, v141
  s_waitcnt lgkmcnt(4)
  v_mfma_f32_32x32x16_bf16 v[64:79], a[8:11], v[196:199], v[64:79]
  v_cvt_pk_bf16_f32 v139, v142, v143
  s_add_u32 s61, s49, 0x1000
  buffer_store_dwordx4 v[136:139], v218, s[36:39], s61 offen sc1
  v_mul_f32 v144, v144, v224
  v_mul_f32 v145, v145, v224
  v_mfma_f32_32x32x16_bf16 v[80:95], a[12:15], v[196:199], v[80:95]
  s_waitcnt lgkmcnt(0)
  s_barrier
  v_mfma_f32_32x32x16_bf16 v[64:79], a[16:19], v[200:203], v[64:79]
  ds_read_b64_tr_b16 v[192:193], v208 offset:49152
  ds_read_b64_tr_b16 v[194:195], v208 offset:49664
  v_mul_f32 v146, v146, v224
  v_mul_f32 v147, v147, v224
  v_mul_f32 v148, v148, v224
  v_mfma_f32_32x32x16_bf16 v[80:95], a[20:23], v[200:203], v[80:95]
  ds_read_b64_tr_b16 v[196:197], v208 offset:53248
  ds_read_b64_tr_b16 v[198:199], v208 offset:53760
  v_mul_f32 v149, v149, v224
  v_mul_f32 v150, v150, v224
  v_mul_f32 v151, v151, v224
  v_mfma_f32_32x32x16_bf16 v[64:79], a[24:27], v[204:207], v[64:79]
  v_cvt_pk_bf16_f32 v144, v144, v145
  v_cvt_pk_bf16_f32 v145, v146, v147
  v_cvt_pk_bf16_f32 v146, v148, v149
  v_cvt_pk_bf16_f32 v147, v150, v151
  s_add_u32 s62, s49, 0x14000
  v_mfma_f32_32x32x16_bf16 v[80:95], a[28:31], v[204:207], v[80:95]
  buffer_store_dwordx4 v[144:147], v218, s[36:39], s62 offen sc1
  v_mul_f32 v152, v152, v224
  v_mul_f32 v153, v153, v224
  v_mul_f32 v154, v154, v224
  v_mul_f32 v155, v155, v224
  s_waitcnt lgkmcnt(2)
  v_mfma_f32_32x32x16_bf16 v[64:79], a[32:35], v[192:195], v[64:79]
  ds_read_b64_tr_b16 v[200:201], v208 offset:57344
  ds_read_b64_tr_b16 v[202:203], v208 offset:57856
  v_mul_f32 v156, v156, v224
  v_mul_f32 v157, v157, v224
  v_mul_f32 v158, v158, v224
  v_mfma_f32_32x32x16_bf16 v[80:95], a[36:39], v[192:195], v[80:95]
  ds_read_b64_tr_b16 v[204:205], v208 offset:61440
  ds_read_b64_tr_b16 v[206:207], v208 offset:61952
  v_mul_f32 v159, v159, v224
  v_cvt_pk_bf16_f32 v152, v152, v153
  v_cvt_pk_bf16_f32 v153, v154, v155
  s_waitcnt lgkmcnt(4)
  v_mfma_f32_32x32x16_bf16 v[64:79], a[40:43], v[196:199], v[64:79]
  v_cvt_pk_bf16_f32 v154, v156, v157
  v_cvt_pk_bf16_f32 v155, v158, v159
  s_add_u32 s63, s49, 0x15000
  buffer_store_dwordx4 v[152:155], v218, s[36:39], s63 offen sc1
  v_mul_f32 v160, v160, v221
  v_mfma_f32_32x32x16_bf16 v[80:95], a[44:47], v[196:199], v[80:95]
  s_waitcnt lgkmcnt(0)
  s_barrier
  v_mfma_f32_32x32x16_bf16 v[64:79], a[48:51], v[200:203], v[64:79]
  ds_read_b64_tr_b16 v[192:193], v210 offset:0
  ds_read_b64_tr_b16 v[194:195], v210 offset:512
  v_mul_f32 v161, v161, v221
  v_mul_f32 v162, v162, v221
  v_mul_f32 v163, v163, v221
  v_mfma_f32_32x32x16_bf16 v[80:95], a[52:55], v[200:203], v[80:95]
  ds_read_b64_tr_b16 v[196:197], v210 offset:4096
  ds_read_b64_tr_b16 v[198:199], v210 offset:4608
  v_mul_f32 v164, v164, v221
  v_mul_f32 v165, v165, v221
  v_mul_f32 v166, v166, v221
  v_mfma_f32_32x32x16_bf16 v[64:79], a[56:59], v[204:207], v[64:79]
  v_mul_f32 v167, v167, v221
  v_cvt_pk_bf16_f32 v160, v160, v161
  v_cvt_pk_bf16_f32 v161, v162, v163
  v_cvt_pk_bf16_f32 v162, v164, v165
  v_cvt_pk_bf16_f32 v163, v166, v167
  v_mfma_f32_32x32x16_bf16 v[80:95], a[60:63], v[204:207], v[80:95]
  s_add_u32 s60, s52, 0
  buffer_store_dwordx4 v[160:163], v218, s[36:39], s60 offen sc1
  v_mul_f32 v168, v168, v221
  v_mul_f32 v169, v169, v221
  v_mul_f32 v170, v170, v221
  s_waitcnt lgkmcnt(2)
  v_mfma_f32_32x32x16_bf16 v[64:79], a[64:67], v[192:195], v[64:79]
  ds_read_b64_tr_b16 v[200:201], v210 offset:8192
  ds_read_b64_tr_b16 v[202:203], v210 offset:8704
  v_mul_f32 v171, v171, v221
  v_mul_f32 v172, v172, v221
  v_mul_f32 v173, v173, v221
  v_mfma_f32_32x32x16_bf16 v[80:95], a[68:71], v[192:195], v[80:95]
  ds_read_b64_tr_b16 v[204:205], v210 offset:12288
  ds_read_b64_tr_b16 v[206:207], v210 offset:12800
  v_mul_f32 v174, v174, v221
  v_mul_f32 v175, v175, v221
  v_cvt_pk_bf16_f32 v168, v168, v169
  s_waitcnt lgkmcnt(4)
  v_mfma_f32_32x32x16_bf16 v[64:79], a[72:75], v[196:199], v[64:79]
  v_cvt_pk_bf16_f32 v169, v170, v171
  v_cvt_pk_bf16_f32 v170, v172, v173
  v_cvt_pk_bf16_f32 v171, v174, v175
  s_add_u32 s61, s52, 0x1000
  buffer_store_dwordx4 v[168:171], v218, s[36:39], s61 offen sc1
  v_mfma_f32_32x32x16_bf16 v[80:95], a[76:79], v[196:199], v[80:95]
  s_waitcnt lgkmcnt(0)
  s_barrier
  v_mfma_f32_32x32x16_bf16 v[64:79], a[80:83], v[200:203], v[64:79]
  ds_read_b64_tr_b16 v[192:193], v210 offset:16384
  ds_read_b64_tr_b16 v[194:195], v210 offset:16896
  s_add_u32 s67, s55, 0x2800
  buffer_load_dword v240, v219, s[36:39], s67 offen offset:0 sc1
  v_mul_f32 v176, v176, v224
  v_mfma_f32_32x32x16_bf16 v[80:95], a[84:87], v[200:203], v[80:95]
  ds_read_b64_tr_b16 v[196:197], v210 offset:20480
  ds_read_b64_tr_b16 v[198:199], v210 offset:20992
  buffer_load_dword v241, v219, s[36:39], s67 offen offset:128 sc1
  v_mul_f32 v177, v177, v224
  v_mul_f32 v178, v178, v224
  v_mfma_f32_32x32x16_bf16 v[64:79], a[88:91], v[204:207], v[64:79]
  v_mul_f32 v179, v179, v224
  v_mul_f32 v180, v180, v224
  v_mul_f32 v181, v181, v224
  v_mul_f32 v182, v182, v224
  v_mul_f32 v183, v183, v224
  v_mfma_f32_32x32x16_bf16 v[80:95], a[92:95], v[204:207], v[80:95]
  v_cvt_pk_bf16_f32 v176, v176, v177
  v_cvt_pk_bf16_f32 v177, v178, v179
  v_cvt_pk_bf16_f32 v178, v180, v181
  v_cvt_pk_bf16_f32 v179, v182, v183
  s_add_u32 s62, s52, 0x14000
  s_waitcnt lgkmcnt(2)
  v_mfma_f32_32x32x16_bf16 v[64:79], a[96:99], v[192:195], v[64:79]
  ds_read_b64_tr_b16 v[200:201], v210 offset:24576
  ds_read_b64_tr_b16 v[202:203], v210 offset:25088
  buffer_store_dwordx4 v[176:179], v218, s[36:39], s62 offen sc1
  v_mul_f32 v184, v184, v224
  v_mul_f32 v185, v185, v224
  v_mfma_f32_32x32x16_bf16 v[80:95], a[100:103], v[192:195], v[80:95]
  ds_read_b64_tr_b16 v[204:205], v210 offset:28672
  ds_read_b64_tr_b16 v[206:207], v210 offset:29184
  v_mul_f32 v186, v186, v224
  v_mul_f32 v187, v187, v224
  v_mul_f32 v188, v188, v224
  s_waitcnt lgkmcnt(4)
  v_mfma_f32_32x32x16_bf16 v[64:79], a[104:107], v[196:199], v[64:79]
  v_mul_f32 v189, v189, v224
  v_mul_f32 v190, v190, v224
  v_mul_f32 v191, v191, v224
  v_cvt_pk_bf16_f32 v184, v184, v185
  v_cvt_pk_bf16_f32 v185, v186, v187
  v_mfma_f32_32x32x16_bf16 v[80:95], a[108:111], v[196:199], v[80:95]
  s_waitcnt vmcnt(21) lgkmcnt(0)
  s_barrier
  v_mfma_f32_32x32x16_bf16 v[64:79], a[112:115], v[200:203], v[64:79]
  ds_read_b64_tr_b16 v[192:193], v210 offset:32768
  ds_read_b64_tr_b16 v[194:195], v210 offset:33280
  v_cvt_pk_bf16_f32 v186, v188, v189
  v_cvt_pk_bf16_f32 v187, v190, v191
  s_add_u32 s63, s52, 0x15000
  v_mfma_f32_32x32x16_bf16 v[80:95], a[116:119], v[200:203], v[80:95]
  ds_read_b64_tr_b16 v[196:197], v210 offset:36864
  ds_read_b64_tr_b16 v[198:199], v210 offset:37376
  buffer_store_dwordx4 v[184:187], v218, s[36:39], s63 offen sc1
  ds_bpermute_b32 v128, v251, v220 offset:0
  ds_bpermute_b32 v129, v251, v220 offset:4
  v_mfma_f32_32x32x16_bf16 v[64:79], a[120:123], v[204:207], v[64:79]
  ds_bpermute_b32 v130, v251, v220 offset:8
  ds_bpermute_b32 v131, v251, v220 offset:12
  ds_bpermute_b32 v132, v251, v220 offset:32
  ds_bpermute_b32 v133, v251, v220 offset:36
  ds_bpermute_b32 v134, v251, v220 offset:40
  v_mfma_f32_32x32x16_bf16 v[80:95], a[124:127], v[204:207], v[80:95]
  ds_bpermute_b32 v135, v251, v220 offset:44
  ds_bpermute_b32 v136, v251, v220 offset:64
  ds_bpermute_b32 v137, v251, v220 offset:68
  ds_bpermute_b32 v138, v251, v220 offset:72
  ds_bpermute_b32 v139, v251, v220 offset:76
  s_waitcnt lgkmcnt(14)
  v_mfma_f32_32x32x16_bf16 v[64:79], a[128:131], v[192:195], v[64:79]
  ds_read_b64_tr_b16 v[200:201], v210 offset:40960
  ds_read_b64_tr_b16 v[202:203], v210 offset:41472
  ds_bpermute_b32 v140, v251, v220 offset:96
  ds_bpermute_b32 v141, v251, v220 offset:100
  ds_bpermute_b32 v142, v251, v220 offset:104
  v_mfma_f32_32x32x16_bf16 v[80:95], a[132:135], v[192:195], v[80:95]
  ds_read_b64_tr_b16 v[204:205], v210 offset:45056
  ds_read_b64_tr_b16 v[206:207], v210 offset:45568
  ds_bpermute_b32 v143, v251, v220 offset:108
  ds_bpermute_b32 v144, v251, v223 offset:0
  ds_bpermute_b32 v145, v251, v223 offset:4
  s_waitcnt lgkmcnt(15)
  v_mfma_f32_32x32x16_bf16 v[64:79], a[136:139], v[196:199], v[64:79]
  ds_bpermute_b32 v146, v251, v223 offset:8
  ds_bpermute_b32 v147, v251, v223 offset:12
  ds_bpermute_b32 v148, v251, v223 offset:32
  ds_bpermute_b32 v149, v251, v223 offset:36
  ds_bpermute_b32 v150, v251, v223 offset:40
  v_mfma_f32_32x32x16_bf16 v[80:95], a[140:143], v[196:199], v[80:95]
  s_waitcnt vmcnt(2)
  v_max_u32 v226, v240, v241
  v_cmp_eq_u32 vcc, -1, v226
  s_nop 0
  s_cmp_lg_u64 vcc, 0
  s_cbranch_scc1 qkv_cs2
qkv_cs2_d:
  s_waitcnt lgkmcnt(0)
  s_barrier
  v_mfma_f32_32x32x16_bf16 v[64:79], a[144:147], v[200:203], v[64:79]
  ds_read_b64_tr_b16 v[192:193], v210 offset:49152
  ds_read_b64_tr_b16 v[194:195], v210 offset:49664
  v_add_f32 v240, v240, v241
  v_and_b32 v241, 0xffff0000, v240
  v_sub_f32 v240, v240, v241
  v_mfma_f32_32x32x16_bf16 v[80:95], a[148:151], v[200:203], v[80:95]
  ds_read_b64_tr_b16 v[196:197], v210 offset:53248
  ds_read_b64_tr_b16 v[198:199], v210 offset:53760
  v_cvt_pk_bf16_f32 v226, v241, v240
  v_cvt_pk_bf16_f32 v227, v241, 0
  ds_bpermute_b32 v151, v251, v223 offset:44
  v_mfma_f32_32x32x16_bf16 v[64:79], a[152:155], v[204:207], v[64:79]
  v_mfma_f32_32x32x8_bf16 v[64:79], v[228:229], v[226:227], v[64:79]
  ds_bpermute_b32 v152, v251, v223 offset:64
  ds_bpermute_b32 v153, v251, v223 offset:68
  v_mfma_f32_32x32x16_bf16 v[80:95], a[156:159], v[204:207], v[80:95]
  v_mfma_f32_32x32x8_bf16 v[80:95], v[230:231], v[226:227], v[80:95]
  ds_bpermute_b32 v154, v251, v223 offset:72
  ds_bpermute_b32 v155, v251, v223 offset:76
  s_waitcnt lgkmcnt(7)
  v_mfma_f32_32x32x16_bf16 v[64:79], a[160:163], v[192:195], v[64:79]
  ds_read_b64_tr_b16 v[200:201], v210 offset:57344
  ds_read_b64_tr_b16 v[202:203], v210 offset:57856
  ds_bpermute_b32 v156, v251, v223 offset:96
  ds_bpermute_b32 v157, v251, v223 offset:100
  ds_bpermute_b32 v158, v251, v223 offset:104
  v_mfma_f32_32x32x16_bf16 v[80:95], a[164:167], v[192:195], v[80:95]
  ds_read_b64_tr_b16 v[204:205], v210 offset:61440
  ds_read_b64_tr_b16 v[206:207], v210 offset:61952
  ds_bpermute_b32 v159, v251, v223 offset:108
  v_mov_b32 v160, -1
  v_mov_b32 v161, -1
  s_waitcnt lgkmcnt(13)
  v_mfma_f32_32x32x16_bf16 v[64:79], a[168:171], v[196:199], v[64:79]
  v_mov_b32 v162, -1
  v_mov_b32 v163, -1
  s_mul_i32 s57, s68, 5
  s_add_u32 s57, s57, s69
  s_lshl_b32 s57, s57, 15
  v_mfma_f32_32x32x16_bf16 v[80:95], a[172:175], v[196:199], v[80:95]
  s_waitcnt lgkmcnt(0)
  s_barrier
  v_mfma_f32_32x32x16_bf16 v[64:79], a[176:179], v[200:203], v[64:79]
  ds_read_b64_tr_b16 v[192:193], v212 offset:0
  ds_read_b64_tr_b16 v[194:195], v212 offset:512
  s_lshl_b32 s65, s40, 13
  s_add_u32 s57, s57, s65
  s_add_u32 s57, s57, 0x1000000
  v_mfma_f32_32x32x16_bf16 v[80:95], a[180:183], v[200:203], v[80:95]
  ds_read_b64_tr_b16 v[196:197], v212 offset:4096
  ds_read_b64_tr_b16 v[198:199], v212 offset:4608
  buffer_store_dwordx4 v[160:163], v218, s[36:39], s57 offen offset:0 sc1
  v_mfma_f32_32x32x16_bf16 v[64:79], a[184:187], v[204:207], v[64:79]
  v_mfma_f32_32x32x16_bf16 v[80:95], a[188:191], v[204:207], v[80:95]
  s_waitcnt lgkmcnt(2)
  v_mfma_f32_32x32x16_bf16 v[64:79], a[192:195], v[192:195], v[64:79]
  ds_read_b64_tr_b16 v[200:201], v212 offset:8192
  ds_read_b64_tr_b16 v[202:203], v212 offset:8704
  v_mfma_f32_32x32x16_bf16 v[80:95], a[196:199], v[192:195], v[80:95]
  ds_read_b64_tr_b16 v[204:205], v212 offset:12288
  ds_read_b64_tr_b16 v[206:207], v212 offset:12800
  buffer_store_dwordx4 v[160:163], v218, s[36:39], s57 offen offset:1024 sc1
  s_waitcnt lgkmcnt(4)
  v_mfma_f32_32x32x16_bf16 v[64:79], a[200:203], v[196:199], v[64:79]
  v_mfma_f32_32x32x16_bf16 v[80:95], a[204:207], v[196:199], v[80:95]
  s_waitcnt lgkmcnt(0)
  s_barrier
  v_mfma_f32_32x32x16_bf16 v[64:79], a[208:211], v[200:203], v[64:79]
  ds_read_b64_tr_b16 v[192:193], v212 offset:16384
  ds_read_b64_tr_b16 v[194:195], v212 offset:16896
  v_mfma_f32_32x32x16_bf16 v[80:95], a[212:215], v[200:203], v[80:95]
  ds_read_b64_tr_b16 v[196:197], v212 offset:20480
  ds_read_b64_tr_b16 v[198:199], v212 offset:20992
  v_mfma_f32_32x32x16_bf16 v[64:79], a[216:219], v[204:207], v[64:79]
  buffer_store_dwordx4 v[160:163], v218, s[36:39], s57 offen offset:2048 sc1
  v_mfma_f32_32x32x16_bf16 v[80:95], a[220:223], v[204:207], v[80:95]
  s_waitcnt lgkmcnt(2)
  v_mfma_f32_32x32x16_bf16 v[64:79], a[224:227], v[192:195], v[64:79]
  ds_read_b64_tr_b16 v[200:201], v212 offset:24576
  ds_read_b64_tr_b16 v[202:203], v212 offset:25088
  v_mfma_f32_32x32x16_bf16 v[80:95], a[228:231], v[192:195], v[80:95]
  ds_read_b64_tr_b16 v[204:205], v212 offset:28672
  ds_read_b64_tr_b16 v[206:207], v212 offset:29184
  s_waitcnt lgkmcnt(4)
  v_mfma_f32_32x32x16_bf16 v[64:79], a[232:235], v[196:199], v[64:79]
  buffer_store_dwordx4 v[160:163], v218, s[36:39], s57 offen offset:3072 sc1
  v_mfma_f32_32x32x16_bf16 v[80:95], a[236:239], v[196:199], v[80:95]
  s_waitcnt lgkmcnt(2)
  v_mfma_f32_32x32x16_bf16 v[64:79], a[240:243], v[200:203], v[64:79]
  ds_read_b64_tr_b16 v[192:193], v209 offset:0
  ds_read_b64_tr_b16 v[194:195], v209 offset:512
  v_mfma_f32_32x32x16_bf16 v[80:95], a[244:247], v[200:203], v[80:95]
  ds_read_b64_tr_b16 v[196:197], v209 offset:4096
  ds_read_b64_tr_b16 v[198:199], v209 offset:4608
  s_waitcnt lgkmcnt(4)
  v_mfma_f32_32x32x16_bf16 v[64:79], a[248:251], v[204:207], v[64:79]
  s_add_u32 s57, s57, 0x1000
  buffer_store_dwordx4 v[160:163], v218, s[36:39], s57 offen offset:0 sc1
  v_mfma_f32_32x32x16_bf16 v[80:95], a[252:255], v[204:207], v[80:95]
  s_waitcnt lgkmcnt(2)
  v_mfma_f32_32x32x16_bf16 v[96:111], v[0:3], v[192:195], 0
  ds_read_b64_tr_b16 v[200:201], v209 offset:8192
  ds_read_b64_tr_b16 v[202:203], v209 offset:8704
  v_mfma_f32_32x32x16_bf16 v[112:127], v[4:7], v[192:195], 0
  ds_read_b64_tr_b16 v[204:205], v209 offset:12288
  ds_read_b64_tr_b16 v[206:207], v209 offset:12800
  s_waitcnt lgkmcnt(4)
  v_mfma_f32_32x32x16_bf16 v[96:111], v[8:11], v[196:199], v[96:111]
  buffer_store_dwordx4 v[160:163], v218, s[36:39], s57 offen offset:1024 sc1
  v_mfma_f32_32x32x16_bf16 v[112:127], v[12:15], v[196:199], v[112:127]
  s_waitcnt lgkmcnt(2)
  v_mfma_f32_32x32x16_bf16 v[96:111], v[16:19], v[200:203], v[96:111]
  ds_read_b64_tr_b16 v[192:193], v209 offset:16384
  ds_read_b64_tr_b16 v[194:195], v209 offset:16896
  v_mfma_f32_32x32x8_bf16 v[96:111], v[232:233], v[226:227], v[96:111]
  v_mfma_f32_32x32x16_bf16 v[112:127], v[20:23], v[200:203], v[112:127]
  ds_read_b64_tr_b16 v[196:197], v209 offset:20480
  ds_read_b64_tr_b16 v[198:199], v209 offset:20992
  v_mfma_f32_32x32x8_bf16 v[112:127], v[234:235], v[226:227], v[112:127]
  s_waitcnt lgkmcnt(4)
  v_mfma_f32_32x32x16_bf16 v[96:111], v[24:27], v[204:207], v[96:111]
  v_mfma_f32_32x32x16_bf16 v[112:127], v[28:31], v[204:207], v[112:127]
  s_waitcnt lgkmcnt(2)
  v_mfma_f32_32x32x16_bf16 v[96:111], v[32:35], v[192:195], v[96:111]
  ds_read_b64_tr_b16 v[200:201], v209 offset:24576
  ds_read_b64_tr_b16 v[202:203], v209 offset:25088
  buffer_store_dwordx4 v[160:163], v218, s[36:39], s57 offen offset:2048 sc1
  v_mfma_f32_32x32x16_bf16 v[112:127], v[36:39], v[192:195], v[112:127]
  ds_read_b64_tr_b16 v[204:205], v209 offset:28672
  ds_read_b64_tr_b16 v[206:207], v209 offset:29184
  s_waitcnt lgkmcnt(4)
  v_mfma_f32_32x32x16_bf16 v[96:111], v[40:43], v[196:199], v[96:111]
  v_mfma_f32_32x32x16_bf16 v[112:127], v[44:47], v[196:199], v[112:127]
  s_waitcnt lgkmcnt(2)
  v_mfma_f32_32x32x16_bf16 v[96:111], v[48:51], v[200:203], v[96:111]
  ds_read_b64_tr_b16 v[192:193], v209 offset:32768
  ds_read_b64_tr_b16 v[194:195], v209 offset:33280
  buffer_store_dwordx4 v[160:163], v218, s[36:39], s57 offen offset:3072 sc1
  v_mfma_f32_32x32x16_bf16 v[112:127], v[52:55], v[200:203], v[112:127]
  ds_read_b64_tr_b16 v[196:197], v209 offset:36864
  ds_read_b64_tr_b16 v[198:199], v209 offset:37376
  s_waitcnt lgkmcnt(4)
  v_mfma_f32_32x32x16_bf16 v[96:111], v[56:59], v[204:207], v[96:111]
  v_mfma_f32_32x32x16_bf16 v[112:127], v[60:63], v[204:207], v[112:127]
  s_waitcnt lgkmcnt(2)
  v_mfma_f32_32x32x16_bf16 v[96:111], a[0:3], v[192:195], v[96:111]
  ds_read_b64_tr_b16 v[200:201], v209 offset:40960
  ds_read_b64_tr_b16 v[202:203], v209 offset:41472
  v_mul_f32 v64, v64, v128
  v_mul_f32 v65, v65, v129
  v_mul_f32 v66, v66, v130
  v_mfma_f32_32x32x16_bf16 v[112:127], a[4:7], v[192:195], v[112:127]
  ds_read_b64_tr_b16 v[204:205], v209 offset:45056
  ds_read_b64_tr_b16 v[206:207], v209 offset:45568
  v_mul_f32 v67, v67, v131
  v_mul_f32 v68, v68, v132
  v_mul_f32 v69, v69, v133
  s_waitcnt lgkmcnt(4)
  v_mfma_f32_32x32x16_bf16 v[96:111], a[8:11], v[196:199], v[96:111]
  v_mul_f32 v70, v70, v134
  v_mul_f32 v71, v71, v135
  v_cvt_pk_bf16_f32 v64, v64, v65
  v_cvt_pk_bf16_f32 v65, v66, v67
  v_cvt_pk_bf16_f32 v66, v68, v69
  v_mfma_f32_32x32x16_bf16 v[112:127], a[12:15], v[196:199], v[112:127]
  v_cvt_pk_bf16_f32 v67, v70, v71
  s_add_u32 s60, s50, 0
  buffer_store_dwordx4 v[64:67], v250, s[36:39], s60 offen sc1
  v_mul_f32 v72, v72, v136
  v_mul_f32 v73, v73, v137
  s_waitcnt lgkmcnt(2)
  v_mfma_f32_32x32x16_bf16 v[96:111], a[16:19], v[200:203], v[96:111]
  ds_read_b64_tr_b16 v[192:193], v209 offset:49152
  ds_read_b64_tr_b16 v[194:195], v209 offset:49664
  v_mul_f32 v74, v74, v138
  v_mul_f32 v75, v75, v139
  v_mul_f32 v76, v76, v140
  v_mfma_f32_32x32x16_bf16 v[112:127], a[20:23], v[200:203], v[112:127]
  ds_read_b64_tr_b16 v[196:197], v209 offset:53248
  ds_read_b64_tr_b16 v[198:199], v209 offset:53760
  v_mul_f32 v77, v77, v141
  v_mul_f32 v78, v78, v142
  v_mul_f32 v79, v79, v143
  s_waitcnt lgkmcnt(4)
  v_mfma_f32_32x32x16_bf16 v[96:111], a[24:27], v[204:207], v[96:111]
  v_cvt_pk_bf16_f32 v72, v72, v73
  v_cvt_pk_bf16_f32 v73, v74, v75
  v_cvt_pk_bf16_f32 v74, v76, v77
  v_cvt_pk_bf16_f32 v75, v78, v79
  s_add_u32 s61, s50, 0x5000
  v_mfma_f32_32x32x16_bf16 v[112:127], a[28:31], v[204:207], v[112:127]
  buffer_store_dwordx4 v[72:75], v250, s[36:39], s61 offen sc1
  v_mul_f32 v80, v80, v144
  v_mul_f32 v81, v81, v145
  v_mul_f32 v82, v82, v146
  v_mul_f32 v83, v83, v147
  s_waitcnt lgkmcnt(2)
  v_mfma_f32_32x32x16_bf16 v[96:111], a[32:35], v[192:195], v[96:111]
  ds_read_b64_tr_b16 v[200:201], v209 offset:57344
  ds_read_b64_tr_b16 v[202:203], v209 offset:57856
  v_mul_f32 v84, v84, v148
  v_mul_f32 v85, v85, v149
  v_mul_f32 v86, v86, v150
  v_mfma_f32_32x32x16_bf16 v[112:127], a[36:39], v[192:195], v[112:127]
  ds_read_b64_tr_b16 v[204:205], v209 offset:61440
  ds_read_b64_tr_b16 v[206:207], v209 offset:61952
  v_mul_f32 v87, v87, v151
  v_cvt_pk_bf16_f32 v80, v80, v81
  v_cvt_pk_bf16_f32 v81, v82, v83
  s_waitcnt lgkmcnt(4)
  v_mfma_f32_32x32x16_bf16 v[96:111], a[40:43], v[196:199], v[96:111]
  v_cvt_pk_bf16_f32 v82, v84, v85
  v_cvt_pk_bf16_f32 v83, v86, v87
  s_add_u32 s62, s50, 0xa000
  buffer_store_dwordx4 v[80:83], v250, s[36:39], s62 offen sc1
  v_mul_f32 v88, v88, v152
  v_mfma_f32_32x32x16_bf16 v[112:127], a[44:47], v[196:199], v[112:127]
  v_mul_f32 v89, v89, v153
  v_mul_f32 v90, v90, v154
  v_mul_f32 v91, v91, v155
  v_mul_f32 v92, v92, v156
  v_mul_f32 v93, v93, v157
  s_waitcnt lgkmcnt(2)
  v_mfma_f32_32x32x16_bf16 v[96:111], a[48:51], v[200:203], v[96:111]
  ds_read_b64_tr_b16 v[192:193], v211 offset:0
  ds_read_b64_tr_b16 v[194:195], v211 offset:512
  v_mul_f32 v94, v94, v158
  v_mul_f32 v95, v95, v159
  v_cvt_pk_bf16_f32 v88, v88, v89
  v_mfma_f32_32x32x16_bf16 v[112:127], a[52:55], v[200:203], v[112:127]
  ds_read_b64_tr_b16 v[196:197], v211 offset:4096
  ds_read_b64_tr_b16 v[198:199], v211 offset:4608
  v_cvt_pk_bf16_f32 v89, v90, v91
  v_cvt_pk_bf16_f32 v90, v92, v93
  v_cvt_pk_bf16_f32 v91, v94, v95
  s_waitcnt lgkmcnt(4)
  v_mfma_f32_32x32x16_bf16 v[96:111], a[56:59], v[204:207], v[96:111]
  s_add_u32 s63, s50, 0xf000
  buffer_store_dwordx4 v[88:91], v250, s[36:39], s63 offen sc1
  v_mfma_f32_32x32x16_bf16 v[112:127], a[60:63], v[204:207], v[112:127]
  s_waitcnt lgkmcnt(2)
  v_mfma_f32_32x32x16_bf16 v[96:111], a[64:67], v[192:195], v[96:111]
  ds_read_b64_tr_b16 v[200:201], v211 offset:8192
  ds_read_b64_tr_b16 v[202:203], v211 offset:8704
  v_mfma_f32_32x32x16_bf16 v[112:127], a[68:71], v[192:195], v[112:127]
  ds_read_b64_tr_b16 v[204:205], v211 offset:12288
  ds_read_b64_tr_b16 v[206:207], v211 offset:12800
  s_waitcnt lgkmcnt(4)
  v_mfma_f32_32x32x16_bf16 v[96:111], a[72:75], v[196:199], v[96:111]
  v_mfma_f32_32x32x16_bf16 v[112:127], a[76:79], v[196:199], v[112:127]
  s_waitcnt lgkmcnt(2)
  v_mfma_f32_32x32x16_bf16 v[96:111], a[80:83], v[200:203], v[96:111]
  ds_read_b64_tr_b16 v[192:193], v211 offset:16384
  ds_read_b64_tr_b16 v[194:195], v211 offset:16896
  v_mfma_f32_32x32x16_bf16 v[112:127], a[84:87], v[200:203], v[112:127]
  ds_read_b64_tr_b16 v[196:197], v211 offset:20480
  ds_read_b64_tr_b16 v[198:199], v211 offset:20992
  s_waitcnt lgkmcnt(4)
  v_mfma_f32_32x32x16_bf16 v[96:111], a[88:91], v[204:207], v[96:111]
  v_mfma_f32_32x32x16_bf16 v[112:127], a[92:95], v[204:207], v[112:127]
  s_waitcnt lgkmcnt(2)
  v_mfma_f32_32x32x16_bf16 v[96:111], a[96:99], v[192:195], v[96:111]
  ds_read_b64_tr_b16 v[200:201], v211 offset:24576
  ds_read_b64_tr_b16 v[202:203], v211 offset:25088
  v_mfma_f32_32x32x16_bf16 v[112:127], a[100:103], v[192:195], v[112:127]
  ds_read_b64_tr_b16 v[204:205], v211 offset:28672
  ds_read_b64_tr_b16 v[206:207], v211 offset:29184
  s_waitcnt lgkmcnt(4)
  v_mfma_f32_32x32x16_bf16 v[96:111], a[104:107], v[196:199], v[96:111]
  v_mfma_f32_32x32x16_bf16 v[112:127], a[108:111], v[196:199], v[112:127]
  s_waitcnt lgkmcnt(2)
  v_mfma_f32_32x32x16_bf16 v[96:111], a[112:115], v[200:203], v[96:111]
  ds_read_b64_tr_b16 v[192:193], v211 offset:32768
  ds_read_b64_tr_b16 v[194:195], v211 offset:33280
  v_mfma_f32_32x32x16_bf16 v[112:127], a[116:119], v[200:203], v[112:127]
  ds_read_b64_tr_b16 v[196:197], v211 offset:36864
  ds_read_b64_tr_b16 v[198:199], v211 offset:37376
  s_waitcnt lgkmcnt(4)
  v_mfma_f32_32x32x16_bf16 v[96:111], a[120:123], v[204:207], v[96:111]
  v_mfma_f32_32x32x16_bf16 v[112:127], a[124:127], v[204:207], v[112:127]
  s_waitcnt lgkmcnt(2)
  v_mfma_f32_32x32x16_bf16 v[96:111], a[128:131], v[192:195], v[96:111]
  ds_read_b64_tr_b16 v[200:201], v211 offset:40960
  ds_read_b64_tr_b16 v[202:203], v211 offset:41472
  v_mfma_f32_32x32x16_bf16 v[112:127], a[132:135], v[192:195], v[112:127]
  ds_read_b64_tr_b16 v[204:205], v211 offset:45056
  ds_read_b64_tr_b16 v[206:207], v211 offset:45568
  s_waitcnt lgkmcnt(4)
  v_mfma_f32_32x32x16_bf16 v[96:111], a[136:139], v[196:199], v[96:111]
  v_mfma_f32_32x32x16_bf16 v[112:127], a[140:143], v[196:199], v[112:127]
  s_waitcnt lgkmcnt(2)
  v_mfma_f32_32x32x16_bf16 v[96:111], a[144:147], v[200:203], v[96:111]
  ds_read_b64_tr_b16 v[192:193], v211 offset:49152
  ds_read_b64_tr_b16 v[194:195], v211 offset:49664
  v_mfma_f32_32x32x16_bf16 v[112:127], a[148:151], v[200:203], v[112:127]
  ds_read_b64_tr_b16 v[196:197], v211 offset:53248
  ds_read_b64_tr_b16 v[198:199], v211 offset:53760
  s_waitcnt lgkmcnt(4)
  v_mfma_f32_32x32x16_bf16 v[96:111], a[152:155], v[204:207], v[96:111]
  v_mfma_f32_32x32x16_bf16 v[112:127], a[156:159], v[204:207], v[112:127]
  s_waitcnt lgkmcnt(2)
  v_mfma_f32_32x32x16_bf16 v[96:111], a[160:163], v[192:195], v[96:111]
  ds_read_b64_tr_b16 v[200:201], v211 offset:57344
  ds_read_b64_tr_b16 v[202:203], v211 offset:57856
  v_mfma_f32_32x32x16_bf16 v[112:127], a[164:167], v[192:195], v[112:127]
  ds_read_b64_tr_b16 v[204:205], v211 offset:61440
  ds_read_b64_tr_b16 v[206:207], v211 offset:61952
  s_waitcnt lgkmcnt(4)
  v_mfma_f32_32x32x16_bf16 v[96:111], a[168:171], v[196:199], v[96:111]
  v_mfma_f32_32x32x16_bf16 v[112:127], a[172:175], v[196:199], v[112:127]
  s_waitcnt lgkmcnt(2)
  v_mfma_f32_32x32x16_bf16 v[96:111], a[176:179], v[200:203], v[96:111]
  ds_read_b64_tr_b16 v[192:193], v213 offset:0
  ds_read_b64_tr_b16 v[194:195], v213 offset:512
  v_mfma_f32_32x32x16_bf16 v[112:127], a[180:183], v[200:203], v[112:127]
  ds_read_b64_tr_b16 v[196:197], v213 offset:4096
  ds_read_b64_tr_b16 v[198:199], v213 offset:4608
  s_waitcnt lgkmcnt(4)
  v_mfma_f32_32x32x16_bf16 v[96:111], a[184:187], v[204:207], v[96:111]
  v_mfma_f32_32x32x16_bf16 v[112:127], a[188:191], v[204:207], v[112:127]
  s_waitcnt lgkmcnt(2)
  v_mfma_f32_32x32x16_bf16 v[96:111], a[192:195], v[192:195], v[96:111]
  ds_read_b64_tr_b16 v[200:201], v213 offset:8192
  ds_read_b64_tr_b16 v[202:203], v213 offset:8704
  v_mfma_f32_32x32x16_bf16 v[112:127], a[196:199], v[192:195], v[112:127]
  ds_read_b64_tr_b16 v[204:205], v213 offset:12288
  ds_read_b64_tr_b16 v[206:207], v213 offset:12800
  s_waitcnt lgkmcnt(4)
  v_mfma_f32_32x32x16_bf16 v[96:111], a[200:203], v[196:199], v[96:111]
  v_mfma_f32_32x32x16_bf16 v[112:127], a[204:207], v[196:199], v[112:127]
  s_waitcnt lgkmcnt(2)
  v_mfma_f32_32x32x16_bf16 v[96:111], a[208:211], v[200:203], v[96:111]
  ds_read_b64_tr_b16 v[192:193], v213 offset:16384
  ds_read_b64_tr_b16 v[194:195], v213 offset:16896
  v_mfma_f32_32x32x16_bf16 v[112:127], a[212:215], v[200:203], v[112:127]
  ds_read_b64_tr_b16 v[196:197], v213 offset:20480
  ds_read_b64_tr_b16 v[198:199], v213 offset:20992
  s_waitcnt lgkmcnt(4)
  v_mfma_f32_32x32x16_bf16 v[96:111], a[216:219], v[204:207], v[96:111]
  v_mfma_f32_32x32x16_bf16 v[112:127], a[220:223], v[204:207], v[112:127]
  s_waitcnt lgkmcnt(2)
  v_mfma_f32_32x32x16_bf16 v[96:111], a[224:227], v[192:195], v[96:111]
  ds_read_b64_tr_b16 v[200:201], v213 offset:24576
  ds_read_b64_tr_b16 v[202:203], v213 offset:25088
  v_mfma_f32_32x32x16_bf16 v[112:127], a[228:231], v[192:195], v[112:127]
  ds_read_b64_tr_b16 v[204:205], v213 offset:28672
  ds_read_b64_tr_b16 v[206:207], v213 offset:29184
  s_waitcnt lgkmcnt(4)
  v_mfma_f32_32x32x16_bf16 v[96:111], a[232:235], v[196:199], v[96:111]
  v_mfma_f32_32x32x16_bf16 v[112:127], a[236:239], v[196:199], v[112:127]
  s_waitcnt lgkmcnt(2)
  v_mfma_f32_32x32x16_bf16 v[96:111], a[240:243], v[200:203], v[96:111]
  v_mfma_f32_32x32x16_bf16 v[112:127], a[244:247], v[200:203], v[112:127]
  s_waitcnt lgkmcnt(0)
  v_mfma_f32_32x32x16_bf16 v[96:111], a[248:251], v[204:207], v[96:111]
  v_mfma_f32_32x32x16_bf16 v[112:127], a[252:255], v[204:207], v[112:127]
  s_nop 10
  v_pk_mul_f32 v[96:97], v[96:97], v[128:129]
  v_pk_mul_f32 v[98:99], v[98:99], v[130:131]
  v_pk_mul_f32 v[100:101], v[100:101], v[132:133]
  v_pk_mul_f32 v[102:103], v[102:103], v[134:135]
  v_cvt_pk_bf16_f32 v96, v96, v97
  v_cvt_pk_bf16_f32 v97, v98, v99
  v_cvt_pk_bf16_f32 v98, v100, v101
  v_cvt_pk_bf16_f32 v99, v102, v103
  s_add_u32 s60, s53, 0
  buffer_store_dwordx4 v[96:99], v250, s[36:39], s60 offen sc1
  v_pk_mul_f32 v[104:105], v[104:105], v[136:137]
  v_pk_mul_f32 v[106:107], v[106:107], v[138:139]
  v_pk_mul_f32 v[108:109], v[108:109], v[140:141]
  v_pk_mul_f32 v[110:111], v[110:111], v[142:143]
  v_cvt_pk_bf16_f32 v104, v104, v105
  v_cvt_pk_bf16_f32 v105, v106, v107
  v_cvt_pk_bf16_f32 v106, v108, v109
  v_cvt_pk_bf16_f32 v107, v110, v111
  s_add_u32 s61, s53, 0x5000
  buffer_store_dwordx4 v[104:107], v250, s[36:39], s61 offen sc1
  v_pk_mul_f32 v[112:113], v[112:113], v[144:145]
  v_pk_mul_f32 v[114:115], v[114:115], v[146:147]
  v_pk_mul_f32 v[116:117], v[116:117], v[148:149]
  v_pk_mul_f32 v[118:119], v[118:119], v[150:151]
  v_cvt_pk_bf16_f32 v112, v112, v113
  v_cvt_pk_bf16_f32 v113, v114, v115
  v_cvt_pk_bf16_f32 v114, v116, v117
  v_cvt_pk_bf16_f32 v115, v118, v119
  s_add_u32 s62, s53, 0xa000
  buffer_store_dwordx4 v[112:115], v250, s[36:39], s62 offen sc1
  v_pk_mul_f32 v[120:121], v[120:121], v[152:153]
  v_pk_mul_f32 v[122:123], v[122:123], v[154:155]
  v_pk_mul_f32 v[124:125], v[124:125], v[156:157]
  v_pk_mul_f32 v[126:127], v[126:127], v[158:159]
  v_cvt_pk_bf16_f32 v120, v120, v121
  v_cvt_pk_bf16_f32 v121, v122, v123
  v_cvt_pk_bf16_f32 v122, v124, v125
  v_cvt_pk_bf16_f32 v123, v126, v127
  s_add_u32 s63, s53, 0xf000
  buffer_store_dwordx4 v[120:123], v250, s[36:39], s63 offen sc1
  s_endpgm
qkv_poll0:
  s_mov_b32 s66, 0x4000
qkv_poll0_l:
  s_sleep 8
  buffer_load_dword v255, v254, s[8:11], 0 offen offset:0 sc1
  s_waitcnt vmcnt(0)
  v_readlane_b32 s100, v255, 0
  v_readlane_b32 s101, v255, 1
  s_nop 0
  s_min_u32 s100, s100, s101
  v_readlane_b32 s101, v255, 2
  s_nop 0
  s_min_u32 s100, s100, s101
  s_sub_u32 s66, s66, 1
  s_cbranch_scc1 qkv_poll0_d
  s_cmp_lt_u32 s100, 10
  s_cbranch_scc1 qkv_poll0_l
  s_branch qkv_poll0_d
qkv_cs1:
  s_mov_b32 s66, 0x4000
qkv_cs1_l:
  s_sleep 4
  s_add_u32 s67, s55, 0x1400
  buffer_load_dword v238, v219, s[36:39], s67 offen offset:0 sc1
  buffer_load_dword v239, v219, s[36:39], s67 offen offset:128 sc1
  s_waitcnt vmcnt(0)
  s_sub_u32 s66, s66, 1
  s_cbranch_scc1 qkv_cs1_d
  v_max_u32 v226, v238, v239
  v_cmp_eq_u32 vcc, -1, v226
  s_nop 0
  s_cmp_lg_u64 vcc, 0
  s_cbranch_scc1 qkv_cs1_l
  s_branch qkv_cs1_d
qkv_cs2:
  s_mov_b32 s66, 0x4000
qkv_cs2_l:
  s_sleep 4
  s_add_u32 s67, s55, 0x2800
  buffer_load_dword v240, v219, s[36:39], s67 offen offset:0 sc1
  buffer_load_dword v241, v219, s[36:39], s67 offen offset:128 sc1
  s_waitcnt vmcnt(0)
  s_sub_u32 s66, s66, 1
  s_cbranch_scc1 qkv_cs2_d
  v_max_u32 v226, v240, v241
  v_cmp_eq_u32 vcc, -1, v226
  s_nop 0
  s_cmp_lg_u64 vcc, 0
  s_cbranch_scc1 qkv_cs2_l
  s_branch qkv_cs2_d
k1_side:
  v_and_b32 v1, 63, v0
  v_lshrrev_b32 v6, 6, v0
  s_nop 0
  v_readfirstlane_b32 s41, v6
  s_cmp_ge_u32 s2, 0x100
  s_cbranch_scc1 k1_exit
  s_getpc_b64 s[60:61]
k1_spf_pc:
  s_sub_u32 s60, s60, k1_spf_pc-k1_kernel
  s_subb_u32 s61, s61, 0
  v_and_b32 v251, 7, v0
  s_lshr_b32 s62, s2, 3
  s_lshl_b32 s62, s62, 2
  s_add_u32 s62, s62, s41
  s_mul_i32 s62, s62, 8
  s_sub_u32 s62, s62, 0x1c0
  v_add_u32 v250, s62, v251
  v_lshlrev_b32 v250, 7, v250
  v_min_u32 v250, code_end-k1_kernel-4, v250
  global_load_dword v252, v250, s[60:61]
  s_sub_u32 s40, s2, 0xe0
  s_lshr_b32 s42, s40, 1
  s_and_b32 s43, s40, 1
  s_waitcnt lgkmcnt(0)
  s_mov_b32 s36, s22
  s_mov_b32 s37, s23
  s_mov_b32 s38, 0x10000000
  s_mov_b32 s39, 0x20000
  s_cmp_ge_u32 s40, 28
  s_cbranch_scc1 k1_side_f
  s_mov_b32 s32, s20
  s_mov_b32 s33, s21
  s_mov_b32 s34, 0x100
  s_mov_b32 s35, 0x20000
  s_cmp_lg_u32 s41, 0
  s_cbranch_scc1 k1_side_s
  v_lshrrev_b32 v6, 5, v1
  v_mul_u32_u24 v5, 0x500, v6
  v_and_b32 v6, 31, v1
  v_lshl_add_u32 v5, v6, 2, v5
  s_mul_i32 s45, s42, 0x3c00
  s_add_u32 s45, s45, 0x1405400
  s_lshl_b32 s60, s43, 7
  s_add_u32 s45, s45, s60
  s_add_u32 s60, s45, 0x1400
  s_sub_u32 s62, s45, 0x1400
  v_mov_b32 v6, -1
  buffer_store_dword v6, v5, s[36:39], s45 offen offset:0 sc1
  buffer_store_dword v6, v5, s[36:39], s45 offen offset:2560 sc1
  buffer_store_dword v6, v5, s[36:39], s60 offen offset:0 sc1
  buffer_store_dword v6, v5, s[36:39], s60 offen offset:2560 sc1
  s_lshr_b32 s61, s42, 1
  s_lshl_b32 s61, s61, 4
  s_lshl_b32 s46, s42, 3
  s_add_u32 s46, s46, s61
  s_add_u32 s46, s46, 8
  v_mov_b32 v8, s46
  v_mov_b32 v7, 5
  s_waitcnt vmcnt(0)
  s_mov_b64 exec, 1
  buffer_atomic_add v7, v8, s[32:35], 0 offen offset:4 sc1
  s_mov_b64 exec, -1
  s_sleep 40
  s_branch k1_side_t
k1_side_s:
  s_sleep 0x55
k1_side_t:
  s_cmp_lt_u32 s42, 5
  s_cbranch_scc1 k1_side_q
  s_mov_b32 s24, s12
  s_mov_b32 s25, s13
  s_mov_b32 s26, 0x21c000
  s_mov_b32 s27, 0x20000
  s_mov_b32 s28, s14
  s_mov_b32 s29, s15
  s_mov_b32 s30, 0x21c000
  s_mov_b32 s31, 0x20000
  s_mov_b32 s44, 0xd80
  s_sub_u32 s48, s42, 5
  s_mul_i32 s48, s48, 0x180
  s_add_u32 s49, s48, 0x80
  s_add_u32 s50, s48, 0x100
  s_branch k1_side_j
k1_side_q:
  s_mov_b32 s24, s6
  s_mov_b32 s25, s7
  s_mov_b32 s26, 0x258000
  s_mov_b32 s27, 0x20000
  s_add_u32 s28, s6, 0x80
  s_addc_u32 s29, s7, 0
  s_mov_b32 s30, 0x257f80
  s_mov_b32 s31, 0x20000
  s_mov_b32 s44, 0xf00
  s_lshl_b32 s48, s42, 9
  s_add_u32 s49, s48, 0x100
  s_lshl_b32 s50, s42, 8
  s_add_u32 s50, s50, 0xa00
k1_side_j:
  s_mul_i32 s60, s43, 0x140
  s_mul_i32 s61, s41, 0x50
  s_add_u32 s60, s60, s61
  v_lshrrev_b32 v6, 3, v1
  v_add_u32 v6, s60, v6
  v_mul_lo_u32 v6, v6, s44
  v_and_b32 v2, 7, v1
  v_lshl_add_u32 v2, v2, 4, v6
  s_lshl_b32 s44, s44, 3
  buffer_load_dwordx4 v[88:91], v2, s[24:27], s49 offen
  buffer_load_dwordx4 v[92:95], v2, s[28:31], s49 offen
  s_add_u32 s49, s49, s44
  buffer_load_dwordx4 v[96:99], v2, s[24:27], s49 offen
  buffer_load_dwordx4 v[100:103], v2, s[28:31], s49 offen
  s_add_u32 s49, s49, s44
  buffer_load_dwordx4 v[104:107], v2, s[24:27], s49 offen
  buffer_load_dwordx4 v[108:111], v2, s[28:31], s49 offen
  s_add_u32 s49, s49, s44
  buffer_load_dwordx4 v[112:115], v2, s[24:27], s49 offen
  buffer_load_dwordx4 v[116:119], v2, s[28:31], s49 offen
  s_add_u32 s49, s49, s44
  buffer_load_dwordx4 v[120:123], v2, s[24:27], s49 offen
  buffer_load_dwordx4 v[124:127], v2, s[28:31], s49 offen
  s_add_u32 s49, s49, s44
  buffer_load_dwordx4 v[128:131], v2, s[24:27], s49 offen
  buffer_load_dwordx4 v[132:135], v2, s[28:31], s49 offen
  s_add_u32 s49, s49, s44
  buffer_load_dwordx4 v[136:139], v2, s[24:27], s49 offen
  buffer_load_dwordx4 v[140:143], v2, s[28:31], s49 offen
  s_add_u32 s49, s49, s44
  buffer_load_dwordx4 v[144:147], v2, s[24:27], s49 offen
  buffer_load_dwordx4 v[148:151], v2, s[28:31], s49 offen
  s_add_u32 s49, s49, s44
  buffer_load_dwordx4 v[152:155], v2, s[24:27], s49 offen
  buffer_load_dwordx4 v[156:159], v2, s[28:31], s49 offen
  s_add_u32 s49, s49, s44
  buffer_load_dwordx4 v[160:163], v2, s[24:27], s49 offen
  buffer_load_dwordx4 v[164:167], v2, s[28:31], s49 offen
  s_add_u32 s49, s49, s44
  s_mov_b32 s62, 0x3f80
  s_mov_b32 s63, 0x3f800000
  s_lshl_b32 s60, s41, 11
  v_lshlrev_b32 v3, 5, v1
  v_add_u32 v3, s60, v3
  v_bfe_u32 v4, v1, 4, 1
  v_mul_u32_u24 v4, 0x2040, v4
  v_lshrrev_b32 v6, 5, v1
  v_lshl_add_u32 v4, v6, 6, v4
  v_mul_u32_u24 v5, 0x500, v6
  v_bfe_u32 v6, v1, 2, 1
  v_lshl_add_u32 v4, v6, 5, v4
  v_bfe_u32 v6, v1, 3, 1
  v_lshl_add_u32 v4, v6, 4, v4
  v_and_b32 v6, 3, v1
  v_lshl_add_u32 v4, v6, 2, v4
  v_and_b32 v6, 31, v1
  v_lshl_add_u32 v5, v6, 2, v5
  s_mul_i32 s45, s42, 0x3c00
  s_add_u32 s45, s45, 0x1405400
  s_lshl_b32 s60, s43, 7
  s_add_u32 s45, s45, s60
  s_lshr_b32 s60, s42, 1
  s_lshl_b32 s60, s60, 4
  s_lshl_b32 s46, s42, 3
  s_add_u32 s46, s46, s60
  s_add_u32 s46, s46, 8
  v_mov_b32 v6, s46
  v_mov_b32 v7, 5
  s_cmp_eq_u32 s41, 0
  s_cbranch_scc1 k1_side_w0
  s_waitcnt vmcnt(19)
  v_dot2_f32_bf16 v8, v88, s62, 0
  v_dot2_f32_bf16 v9, v88, s63, 0
  v_dot2_f32_bf16 v10, v89, s62, 0
  v_dot2_f32_bf16 v11, v89, s63, 0
  v_dot2_f32_bf16 v12, v90, s62, 0
  v_dot2_f32_bf16 v13, v90, s63, 0
  v_dot2_f32_bf16 v14, v91, s62, 0
  v_dot2_f32_bf16 v15, v91, s63, 0
  buffer_load_dwordx4 v[88:91], v2, s[24:27], s50 offen
  s_waitcnt vmcnt(19)
  v_dot2_f32_bf16 v16, v92, s62, 0
  v_dot2_f32_bf16 v17, v92, s63, 0
  v_dot2_f32_bf16 v18, v93, s62, 0
  v_dot2_f32_bf16 v19, v93, s63, 0
  v_dot2_f32_bf16 v20, v94, s62, 0
  v_dot2_f32_bf16 v21, v94, s63, 0
  v_dot2_f32_bf16 v22, v95, s62, 0
  v_dot2_f32_bf16 v23, v95, s63, 0
  buffer_load_dwordx4 v[92:95], v2, s[28:31], s50 offen
  s_add_u32 s50, s50, s44
  s_waitcnt vmcnt(19)
  v_dot2_f32_bf16 v8, v96, s62, v8
  v_dot2_f32_bf16 v9, v96, s63, v9
  v_dot2_f32_bf16 v10, v97, s62, v10
  v_dot2_f32_bf16 v11, v97, s63, v11
  v_dot2_f32_bf16 v12, v98, s62, v12
  v_dot2_f32_bf16 v13, v98, s63, v13
  v_dot2_f32_bf16 v14, v99, s62, v14
  v_dot2_f32_bf16 v15, v99, s63, v15
  buffer_load_dwordx4 v[96:99], v2, s[24:27], s50 offen
  s_waitcnt vmcnt(19)
  v_dot2_f32_bf16 v16, v100, s62, v16
  v_dot2_f32_bf16 v17, v100, s63, v17
  v_dot2_f32_bf16 v18, v101, s62, v18
  v_dot2_f32_bf16 v19, v101, s63, v19
  v_dot2_f32_bf16 v20, v102, s62, v20
  v_dot2_f32_bf16 v21, v102, s63, v21
  v_dot2_f32_bf16 v22, v103, s62, v22
  v_dot2_f32_bf16 v23, v103, s63, v23
  buffer_load_dwordx4 v[100:103], v2, s[28:31], s50 offen
  s_add_u32 s50, s50, s44
  s_waitcnt vmcnt(19)
  v_dot2_f32_bf16 v8, v104, s62, v8
  v_dot2_f32_bf16 v9, v104, s63, v9
  v_dot2_f32_bf16 v10, v105, s62, v10
  v_dot2_f32_bf16 v11, v105, s63, v11
  v_dot2_f32_bf16 v12, v106, s62, v12
  v_dot2_f32_bf16 v13, v106, s63, v13
  v_dot2_f32_bf16 v14, v107, s62, v14
  v_dot2_f32_bf16 v15, v107, s63, v15
  buffer_load_dwordx4 v[104:107], v2, s[24:27], s50 offen
  s_waitcnt vmcnt(19)
  v_dot2_f32_bf16 v16, v108, s62, v16
  v_dot2_f32_bf16 v17, v108, s63, v17
  v_dot2_f32_bf16 v18, v109, s62, v18
  v_dot2_f32_bf16 v19, v109, s63, v19
  v_dot2_f32_bf16 v20, v110, s62, v20
  v_dot2_f32_bf16 v21, v110, s63, v21
  v_dot2_f32_bf16 v22, v111, s62, v22
  v_dot2_f32_bf16 v23, v111, s63, v23
  buffer_load_dwordx4 v[108:111], v2, s[28:31], s50 offen
  s_add_u32 s50, s50, s44
  s_waitcnt vmcnt(19)
  v_dot2_f32_bf16 v8, v112, s62, v8
  v_dot2_f32_bf16 v9, v112, s63, v9
  v_dot2_f32_bf16 v10, v113, s62, v10
  v_dot2_f32_bf16 v11, v113, s63, v11
  v_dot2_f32_bf16 v12, v114, s62, v12
  v_dot2_f32_bf16 v13, v114, s63, v13
  v_dot2_f32_bf16 v14, v115, s62, v14
  v_dot2_f32_bf16 v15, v115, s63, v15
  buffer_load_dwordx4 v[112:115], v2, s[24:27], s50 offen
  s_waitcnt vmcnt(19)
  v_dot2_f32_bf16 v16, v116, s62, v16
  v_dot2_f32_bf16 v17, v116, s63, v17
  v_dot2_f32_bf16 v18, v117, s62, v18
  v_dot2_f32_bf16 v19, v117, s63, v19
  v_dot2_f32_bf16 v20, v118, s62, v20
  v_dot2_f32_bf16 v21, v118, s63, v21
  v_dot2_f32_bf16 v22, v119, s62, v22
  v_dot2_f32_bf16 v23, v119, s63, v23
  buffer_load_dwordx4 v[116:119], v2, s[28:31], s50 offen
  s_add_u32 s50, s50, s44
  s_waitcnt vmcnt(19)
  v_dot2_f32_bf16 v8, v120, s62, v8
  v_dot2_f32_bf16 v9, v120, s63, v9
  v_dot2_f32_bf16 v10, v121, s62, v10
  v_dot2_f32_bf16 v11, v121, s63, v11
  v_dot2_f32_bf16 v12, v122, s62, v12
  v_dot2_f32_bf16 v13, v122, s63, v13
  v_dot2_f32_bf16 v14, v123, s62, v14
  v_dot2_f32_bf16 v15, v123, s63, v15
  buffer_load_dwordx4 v[120:123], v2, s[24:27], s50 offen
  s_waitcnt vmcnt(19)
  v_dot2_f32_bf16 v16, v124, s62, v16
  v_dot2_f32_bf16 v17, v124, s63, v17
  v_dot2_f32_bf16 v18, v125, s62, v18
  v_dot2_f32_bf16 v19, v125, s63, v19
  v_dot2_f32_bf16 v20, v126, s62, v20
  v_dot2_f32_bf16 v21, v126, s63, v21
  v_dot2_f32_bf16 v22, v127, s62, v22
  v_dot2_f32_bf16 v23, v127, s63, v23
  buffer_load_dwordx4 v[124:127], v2, s[28:31], s50 offen
  s_add_u32 s50, s50, s44
  s_waitcnt vmcnt(19)
  v_dot2_f32_bf16 v8, v128, s62, v8
  v_dot2_f32_bf16 v9, v128, s63, v9
  v_dot2_f32_bf16 v10, v129, s62, v10
  v_dot2_f32_bf16 v11, v129, s63, v11
  v_dot2_f32_bf16 v12, v130, s62, v12
  v_dot2_f32_bf16 v13, v130, s63, v13
  v_dot2_f32_bf16 v14, v131, s62, v14
  v_dot2_f32_bf16 v15, v131, s63, v15
  buffer_load_dwordx4 v[128:131], v2, s[24:27], s50 offen
  s_waitcnt vmcnt(19)
  v_dot2_f32_bf16 v16, v132, s62, v16
  v_dot2_f32_bf16 v17, v132, s63, v17
  v_dot2_f32_bf16 v18, v133, s62, v18
  v_dot2_f32_bf16 v19, v133, s63, v19
  v_dot2_f32_bf16 v20, v134, s62, v20
  v_dot2_f32_bf16 v21, v134, s63, v21
  v_dot2_f32_bf16 v22, v135, s62, v22
  v_dot2_f32_bf16 v23, v135, s63, v23
  buffer_load_dwordx4 v[132:135], v2, s[28:31], s50 offen
  s_add_u32 s50, s50, s44
  s_waitcnt vmcnt(19)
  v_dot2_f32_bf16 v8, v136, s62, v8
  v_dot2_f32_bf16 v9, v136, s63, v9
  v_dot2_f32_bf16 v10, v137, s62, v10
  v_dot2_f32_bf16 v11, v137, s63, v11
  v_dot2_f32_bf16 v12, v138, s62, v12
  v_dot2_f32_bf16 v13, v138, s63, v13
  v_dot2_f32_bf16 v14, v139, s62, v14
  v_dot2_f32_bf16 v15, v139, s63, v15
  buffer_load_dwordx4 v[136:139], v2, s[24:27], s50 offen
  s_waitcnt vmcnt(19)
  v_dot2_f32_bf16 v16, v140, s62, v16
  v_dot2_f32_bf16 v17, v140, s63, v17
  v_dot2_f32_bf16 v18, v141, s62, v18
  v_dot2_f32_bf16 v19, v141, s63, v19
  v_dot2_f32_bf16 v20, v142, s62, v20
  v_dot2_f32_bf16 v21, v142, s63, v21
  v_dot2_f32_bf16 v22, v143, s62, v22
  v_dot2_f32_bf16 v23, v143, s63, v23
  buffer_load_dwordx4 v[140:143], v2, s[28:31], s50 offen
  s_add_u32 s50, s50, s44
  s_waitcnt vmcnt(19)
  v_dot2_f32_bf16 v8, v144, s62, v8
  v_dot2_f32_bf16 v9, v144, s63, v9
  v_dot2_f32_bf16 v10, v145, s62, v10
  v_dot2_f32_bf16 v11, v145, s63, v11
  v_dot2_f32_bf16 v12, v146, s62, v12
  v_dot2_f32_bf16 v13, v146, s63, v13
  v_dot2_f32_bf16 v14, v147, s62, v14
  v_dot2_f32_bf16 v15, v147, s63, v15
  buffer_load_dwordx4 v[144:147], v2, s[24:27], s50 offen
  s_waitcnt vmcnt(19)
  v_dot2_f32_bf16 v16, v148, s62, v16
  v_dot2_f32_bf16 v17, v148, s63, v17
  v_dot2_f32_bf16 v18, v149, s62, v18
  v_dot2_f32_bf16 v19, v149, s63, v19
  v_dot2_f32_bf16 v20, v150, s62, v20
  v_dot2_f32_bf16 v21, v150, s63, v21
  v_dot2_f32_bf16 v22, v151, s62, v22
  v_dot2_f32_bf16 v23, v151, s63, v23
  buffer_load_dwordx4 v[148:151], v2, s[28:31], s50 offen
  s_add_u32 s50, s50, s44
  s_waitcnt vmcnt(19)
  v_dot2_f32_bf16 v8, v152, s62, v8
  v_dot2_f32_bf16 v9, v152, s63, v9
  v_dot2_f32_bf16 v10, v153, s62, v10
  v_dot2_f32_bf16 v11, v153, s63, v11
  v_dot2_f32_bf16 v12, v154, s62, v12
  v_dot2_f32_bf16 v13, v154, s63, v13
  v_dot2_f32_bf16 v14, v155, s62, v14
  v_dot2_f32_bf16 v15, v155, s63, v15
  buffer_load_dwordx4 v[152:155], v2, s[24:27], s50 offen
  s_waitcnt vmcnt(19)
  v_dot2_f32_bf16 v16, v156, s62, v16
  v_dot2_f32_bf16 v17, v156, s63, v17
  v_dot2_f32_bf16 v18, v157, s62, v18
  v_dot2_f32_bf16 v19, v157, s63, v19
  v_dot2_f32_bf16 v20, v158, s62, v20
  v_dot2_f32_bf16 v21, v158, s63, v21
  v_dot2_f32_bf16 v22, v159, s62, v22
  v_dot2_f32_bf16 v23, v159, s63, v23
  buffer_load_dwordx4 v[156:159], v2, s[28:31], s50 offen
  s_add_u32 s50, s50, s44
  s_waitcnt vmcnt(19)
  v_dot2_f32_bf16 v8, v160, s62, v8
  v_dot2_f32_bf16 v9, v160, s63, v9
  v_dot2_f32_bf16 v10, v161, s62, v10
  v_dot2_f32_bf16 v11, v161, s63, v11
  v_dot2_f32_bf16 v12, v162, s62, v12
  v_dot2_f32_bf16 v13, v162, s63, v13
  v_dot2_f32_bf16 v14, v163, s62, v14
  v_dot2_f32_bf16 v15, v163, s63, v15
  buffer_load_dwordx4 v[160:163], v2, s[24:27], s50 offen
  s_waitcnt vmcnt(19)
  v_dot2_f32_bf16 v16, v164, s62, v16
  v_dot2_f32_bf16 v17, v164, s63, v17
  v_dot2_f32_bf16 v18, v165, s62, v18
  v_dot2_f32_bf16 v19, v165, s63, v19
  v_dot2_f32_bf16 v20, v166, s62, v20
  v_dot2_f32_bf16 v21, v166, s63, v21
  v_dot2_f32_bf16 v22, v167, s62, v22
  v_dot2_f32_bf16 v23, v167, s63, v23
  buffer_load_dwordx4 v[164:167], v2, s[28:31], s50 offen
  s_add_u32 s50, s50, s44
  ds_write_b128 v3, v[8:11] offset:16640
  ds_write_b128 v3, v[12:15] offset:16656
  ds_write_b128 v3, v[16:19] offset:24896
  ds_write_b128 v3, v[20:23] offset:24912
  s_waitcnt lgkmcnt(0)
  s_barrier
  s_waitcnt vmcnt(19)
  v_dot2_f32_bf16 v8, v88, s62, 0
  v_dot2_f32_bf16 v9, v88, s63, 0
  v_dot2_f32_bf16 v10, v89, s62, 0
  v_dot2_f32_bf16 v11, v89, s63, 0
  v_dot2_f32_bf16 v12, v90, s62, 0
  v_dot2_f32_bf16 v13, v90, s63, 0
  v_dot2_f32_bf16 v14, v91, s62, 0
  v_dot2_f32_bf16 v15, v91, s63, 0
  s_waitcnt vmcnt(18)
  v_dot2_f32_bf16 v16, v92, s62, 0
  v_dot2_f32_bf16 v17, v92, s63, 0
  v_dot2_f32_bf16 v18, v93, s62, 0
  v_dot2_f32_bf16 v19, v93, s63, 0
  v_dot2_f32_bf16 v20, v94, s62, 0
  v_dot2_f32_bf16 v21, v94, s63, 0
  v_dot2_f32_bf16 v22, v95, s62, 0
  v_dot2_f32_bf16 v23, v95, s63, 0
  s_waitcnt vmcnt(17)
  v_dot2_f32_bf16 v8, v96, s62, v8
  v_dot2_f32_bf16 v9, v96, s63, v9
  v_dot2_f32_bf16 v10, v97, s62, v10
  v_dot2_f32_bf16 v11, v97, s63, v11
  v_dot2_f32_bf16 v12, v98, s62, v12
  v_dot2_f32_bf16 v13, v98, s63, v13
  v_dot2_f32_bf16 v14, v99, s62, v14
  v_dot2_f32_bf16 v15, v99, s63, v15
  s_waitcnt vmcnt(16)
  v_dot2_f32_bf16 v16, v100, s62, v16
  v_dot2_f32_bf16 v17, v100, s63, v17
  v_dot2_f32_bf16 v18, v101, s62, v18
  v_dot2_f32_bf16 v19, v101, s63, v19
  v_dot2_f32_bf16 v20, v102, s62, v20
  v_dot2_f32_bf16 v21, v102, s63, v21
  v_dot2_f32_bf16 v22, v103, s62, v22
  v_dot2_f32_bf16 v23, v103, s63, v23
  s_waitcnt vmcnt(15)
  v_dot2_f32_bf16 v8, v104, s62, v8
  v_dot2_f32_bf16 v9, v104, s63, v9
  v_dot2_f32_bf16 v10, v105, s62, v10
  v_dot2_f32_bf16 v11, v105, s63, v11
  v_dot2_f32_bf16 v12, v106, s62, v12
  v_dot2_f32_bf16 v13, v106, s63, v13
  v_dot2_f32_bf16 v14, v107, s62, v14
  v_dot2_f32_bf16 v15, v107, s63, v15
  s_waitcnt vmcnt(14)
  v_dot2_f32_bf16 v16, v108, s62, v16
  v_dot2_f32_bf16 v17, v108, s63, v17
  v_dot2_f32_bf16 v18, v109, s62, v18
  v_dot2_f32_bf16 v19, v109, s63, v19
  v_dot2_f32_bf16 v20, v110, s62, v20
  v_dot2_f32_bf16 v21, v110, s63, v21
  v_dot2_f32_bf16 v22, v111, s62, v22
  v_dot2_f32_bf16 v23, v111, s63, v23
  s_waitcnt vmcnt(13)
  v_dot2_f32_bf16 v8, v112, s62, v8
  v_dot2_f32_bf16 v9, v112, s63, v9
  v_dot2_f32_bf16 v10, v113, s62, v10
  v_dot2_f32_bf16 v11, v113, s63, v11
  v_dot2_f32_bf16 v12, v114, s62, v12
  v_dot2_f32_bf16 v13, v114, s63, v13
  v_dot2_f32_bf16 v14, v115, s62, v14
  v_dot2_f32_bf16 v15, v115, s63, v15
  s_waitcnt vmcnt(12)
  v_dot2_f32_bf16 v16, v116, s62, v16
  v_dot2_f32_bf16 v17, v116, s63, v17
  v_dot2_f32_bf16 v18, v117, s62, v18
  v_dot2_f32_bf16 v19, v117, s63, v19
  v_dot2_f32_bf16 v20, v118, s62, v20
  v_dot2_f32_bf16 v21, v118, s63, v21
  v_dot2_f32_bf16 v22, v119, s62, v22
  v_dot2_f32_bf16 v23, v119, s63, v23
  s_waitcnt vmcnt(11)
  v_dot2_f32_bf16 v8, v120, s62, v8
  v_dot2_f32_bf16 v9, v120, s63, v9
  v_dot2_f32_bf16 v10, v121, s62, v10
  v_dot2_f32_bf16 v11, v121, s63, v11
  v_dot2_f32_bf16 v12, v122, s62, v12
  v_dot2_f32_bf16 v13, v122, s63, v13
  v_dot2_f32_bf16 v14, v123, s62, v14
  v_dot2_f32_bf16 v15, v123, s63, v15
  s_waitcnt vmcnt(10)
  v_dot2_f32_bf16 v16, v124, s62, v16
  v_dot2_f32_bf16 v17, v124, s63, v17
  v_dot2_f32_bf16 v18, v125, s62, v18
  v_dot2_f32_bf16 v19, v125, s63, v19
  v_dot2_f32_bf16 v20, v126, s62, v20
  v_dot2_f32_bf16 v21, v126, s63, v21
  v_dot2_f32_bf16 v22, v127, s62, v22
  v_dot2_f32_bf16 v23, v127, s63, v23
  s_waitcnt vmcnt(9)
  v_dot2_f32_bf16 v8, v128, s62, v8
  v_dot2_f32_bf16 v9, v128, s63, v9
  v_dot2_f32_bf16 v10, v129, s62, v10
  v_dot2_f32_bf16 v11, v129, s63, v11
  v_dot2_f32_bf16 v12, v130, s62, v12
  v_dot2_f32_bf16 v13, v130, s63, v13
  v_dot2_f32_bf16 v14, v131, s62, v14
  v_dot2_f32_bf16 v15, v131, s63, v15
  s_waitcnt vmcnt(8)
  v_dot2_f32_bf16 v16, v132, s62, v16
  v_dot2_f32_bf16 v17, v132, s63, v17
  v_dot2_f32_bf16 v18, v133, s62, v18
  v_dot2_f32_bf16 v19, v133, s63, v19
  v_dot2_f32_bf16 v20, v134, s62, v20
  v_dot2_f32_bf16 v21, v134, s63, v21
  v_dot2_f32_bf16 v22, v135, s62, v22
  v_dot2_f32_bf16 v23, v135, s63, v23
  s_waitcnt vmcnt(7)
  v_dot2_f32_bf16 v8, v136, s62, v8
  v_dot2_f32_bf16 v9, v136, s63, v9
  v_dot2_f32_bf16 v10, v137, s62, v10
  v_dot2_f32_bf16 v11, v137, s63, v11
  v_dot2_f32_bf16 v12, v138, s62, v12
  v_dot2_f32_bf16 v13, v138, s63, v13
  v_dot2_f32_bf16 v14, v139, s62, v14
  v_dot2_f32_bf16 v15, v139, s63, v15
  s_waitcnt vmcnt(6)
  v_dot2_f32_bf16 v16, v140, s62, v16
  v_dot2_f32_bf16 v17, v140, s63, v17
  v_dot2_f32_bf16 v18, v141, s62, v18
  v_dot2_f32_bf16 v19, v141, s63, v19
  v_dot2_f32_bf16 v20, v142, s62, v20
  v_dot2_f32_bf16 v21, v142, s63, v21
  v_dot2_f32_bf16 v22, v143, s62, v22
  v_dot2_f32_bf16 v23, v143, s63, v23
  s_waitcnt vmcnt(5)
  v_dot2_f32_bf16 v8, v144, s62, v8
  v_dot2_f32_bf16 v9, v144, s63, v9
  v_dot2_f32_bf16 v10, v145, s62, v10
  v_dot2_f32_bf16 v11, v145, s63, v11
  v_dot2_f32_bf16 v12, v146, s62, v12
  v_dot2_f32_bf16 v13, v146, s63, v13
  v_dot2_f32_bf16 v14, v147, s62, v14
  v_dot2_f32_bf16 v15, v147, s63, v15
  s_waitcnt vmcnt(4)
  v_dot2_f32_bf16 v16, v148, s62, v16
  v_dot2_f32_bf16 v17, v148, s63, v17
  v_dot2_f32_bf16 v18, v149, s62, v18
  v_dot2_f32_bf16 v19, v149, s63, v19
  v_dot2_f32_bf16 v20, v150, s62, v20
  v_dot2_f32_bf16 v21, v150, s63, v21
  v_dot2_f32_bf16 v22, v151, s62, v22
  v_dot2_f32_bf16 v23, v151, s63, v23
  s_waitcnt vmcnt(3)
  v_dot2_f32_bf16 v8, v152, s62, v8
  v_dot2_f32_bf16 v9, v152, s63, v9
  v_dot2_f32_bf16 v10, v153, s62, v10
  v_dot2_f32_bf16 v11, v153, s63, v11
  v_dot2_f32_bf16 v12, v154, s62, v12
  v_dot2_f32_bf16 v13, v154, s63, v13
  v_dot2_f32_bf16 v14, v155, s62, v14
  v_dot2_f32_bf16 v15, v155, s63, v15
  s_waitcnt vmcnt(2)
  v_dot2_f32_bf16 v16, v156, s62, v16
  v_dot2_f32_bf16 v17, v156, s63, v17
  v_dot2_f32_bf16 v18, v157, s62, v18
  v_dot2_f32_bf16 v19, v157, s63, v19
  v_dot2_f32_bf16 v20, v158, s62, v20
  v_dot2_f32_bf16 v21, v158, s63, v21
  v_dot2_f32_bf16 v22, v159, s62, v22
  v_dot2_f32_bf16 v23, v159, s63, v23
  s_waitcnt vmcnt(1)
  v_dot2_f32_bf16 v8, v160, s62, v8
  v_dot2_f32_bf16 v9, v160, s63, v9
  v_dot2_f32_bf16 v10, v161, s62, v10
  v_dot2_f32_bf16 v11, v161, s63, v11
  v_dot2_f32_bf16 v12, v162, s62, v12
  v_dot2_f32_bf16 v13, v162, s63, v13
  v_dot2_f32_bf16 v14, v163, s62, v14
  v_dot2_f32_bf16 v15, v163, s63, v15
  s_waitcnt vmcnt(0)
  v_dot2_f32_bf16 v16, v164, s62, v16
  v_dot2_f32_bf16 v17, v164, s63, v17
  v_dot2_f32_bf16 v18, v165, s62, v18
  v_dot2_f32_bf16 v19, v165, s63, v19
  v_dot2_f32_bf16 v20, v166, s62, v20
  v_dot2_f32_bf16 v21, v166, s63, v21
  v_dot2_f32_bf16 v22, v167, s62, v22
  v_dot2_f32_bf16 v23, v167, s63, v23
  ds_write_b128 v3, v[8:11] offset:33280
  ds_write_b128 v3, v[12:15] offset:33296
  ds_write_b128 v3, v[16:19] offset:41536
  ds_write_b128 v3, v[20:23] offset:41552
  s_waitcnt lgkmcnt(0)
  s_barrier
  s_branch k1_side_m
k1_side_w0:
  s_setprio 3
  s_waitcnt vmcnt(19)
  v_dot2_f32_bf16 v8, v88, s62, 0
  v_dot2_f32_bf16 v9, v88, s63, 0
  v_dot2_f32_bf16 v10, v89, s62, 0
  v_dot2_f32_bf16 v11, v89, s63, 0
  v_dot2_f32_bf16 v12, v90, s62, 0
  v_dot2_f32_bf16 v13, v90, s63, 0
  v_dot2_f32_bf16 v14, v91, s62, 0
  v_dot2_f32_bf16 v15, v91, s63, 0
  s_waitcnt vmcnt(18)
  v_dot2_f32_bf16 v16, v92, s62, 0
  v_dot2_f32_bf16 v17, v92, s63, 0
  v_dot2_f32_bf16 v18, v93, s62, 0
  v_dot2_f32_bf16 v19, v93, s63, 0
  v_dot2_f32_bf16 v20, v94, s62, 0
  v_dot2_f32_bf16 v21, v94, s63, 0
  v_dot2_f32_bf16 v22, v95, s62, 0
  v_dot2_f32_bf16 v23, v95, s63, 0
  s_waitcnt vmcnt(17)
  v_dot2_f32_bf16 v8, v96, s62, v8
  v_dot2_f32_bf16 v9, v96, s63, v9
  v_dot2_f32_bf16 v10, v97, s62, v10
  v_dot2_f32_bf16 v11, v97, s63, v11
  v_dot2_f32_bf16 v12, v98, s62, v12
  v_dot2_f32_bf16 v13, v98, s63, v13
  v_dot2_f32_bf16 v14, v99, s62, v14
  v_dot2_f32_bf16 v15, v99, s63, v15
  s_waitcnt vmcnt(16)
  v_dot2_f32_bf16 v16, v100, s62, v16
  v_dot2_f32_bf16 v17, v100, s63, v17
  v_dot2_f32_bf16 v18, v101, s62, v18
  v_dot2_f32_bf16 v19, v101, s63, v19
  v_dot2_f32_bf16 v20, v102, s62, v20
  v_dot2_f32_bf16 v21, v102, s63, v21
  v_dot2_f32_bf16 v22, v103, s62, v22
  v_dot2_f32_bf16 v23, v103, s63, v23
  s_waitcnt vmcnt(15)
  v_dot2_f32_bf16 v8, v104, s62, v8
  v_dot2_f32_bf16 v9, v104, s63, v9
  v_dot2_f32_bf16 v10, v105, s62, v10
  v_dot2_f32_bf16 v11, v105, s63, v11
  v_dot2_f32_bf16 v12, v106, s62, v12
  v_dot2_f32_bf16 v13, v106, s63, v13
  v_dot2_f32_bf16 v14, v107, s62, v14
  v_dot2_f32_bf16 v15, v107, s63, v15
  s_waitcnt vmcnt(14)
  v_dot2_f32_bf16 v16, v108, s62, v16
  v_dot2_f32_bf16 v17, v108, s63, v17
  v_dot2_f32_bf16 v18, v109, s62, v18
  v_dot2_f32_bf16 v19, v109, s63, v19
  v_dot2_f32_bf16 v20, v110, s62, v20
  v_dot2_f32_bf16 v21, v110, s63, v21
  v_dot2_f32_bf16 v22, v111, s62, v22
  v_dot2_f32_bf16 v23, v111, s63, v23
  s_waitcnt vmcnt(13)
  v_dot2_f32_bf16 v8, v112, s62, v8
  v_dot2_f32_bf16 v9, v112, s63, v9
  v_dot2_f32_bf16 v10, v113, s62, v10
  v_dot2_f32_bf16 v11, v113, s63, v11
  v_dot2_f32_bf16 v12, v114, s62, v12
  v_dot2_f32_bf16 v13, v114, s63, v13
  v_dot2_f32_bf16 v14, v115, s62, v14
  v_dot2_f32_bf16 v15, v115, s63, v15
  s_waitcnt vmcnt(12)
  v_dot2_f32_bf16 v16, v116, s62, v16
  v_dot2_f32_bf16 v17, v116, s63, v17
  v_dot2_f32_bf16 v18, v117, s62, v18
  v_dot2_f32_bf16 v19, v117, s63, v19
  v_dot2_f32_bf16 v20, v118, s62, v20
  v_dot2_f32_bf16 v21, v118, s63, v21
  v_dot2_f32_bf16 v22, v119, s62, v22
  v_dot2_f32_bf16 v23, v119, s63, v23
  s_waitcnt vmcnt(11)
  v_dot2_f32_bf16 v8, v120, s62, v8
  v_dot2_f32_bf16 v9, v120, s63, v9
  v_dot2_f32_bf16 v10, v121, s62, v10
  v_dot2_f32_bf16 v11, v121, s63, v11
  v_dot2_f32_bf16 v12, v122, s62, v12
  v_dot2_f32_bf16 v13, v122, s63, v13
  v_dot2_f32_bf16 v14, v123, s62, v14
  v_dot2_f32_bf16 v15, v123, s63, v15
  s_waitcnt vmcnt(10)
  v_dot2_f32_bf16 v16, v124, s62, v16
  v_dot2_f32_bf16 v17, v124, s63, v17
  v_dot2_f32_bf16 v18, v125, s62, v18
  v_dot2_f32_bf16 v19, v125, s63, v19
  v_dot2_f32_bf16 v20, v126, s62, v20
  v_dot2_f32_bf16 v21, v126, s63, v21
  v_dot2_f32_bf16 v22, v127, s62, v22
  v_dot2_f32_bf16 v23, v127, s63, v23
  s_waitcnt vmcnt(9)
  v_dot2_f32_bf16 v8, v128, s62, v8
  v_dot2_f32_bf16 v9, v128, s63, v9
  v_dot2_f32_bf16 v10, v129, s62, v10
  v_dot2_f32_bf16 v11, v129, s63, v11
  v_dot2_f32_bf16 v12, v130, s62, v12
  v_dot2_f32_bf16 v13, v130, s63, v13
  v_dot2_f32_bf16 v14, v131, s62, v14
  v_dot2_f32_bf16 v15, v131, s63, v15
  s_waitcnt vmcnt(8)
  v_dot2_f32_bf16 v16, v132, s62, v16
  v_dot2_f32_bf16 v17, v132, s63, v17
  v_dot2_f32_bf16 v18, v133, s62, v18
  v_dot2_f32_bf16 v19, v133, s63, v19
  v_dot2_f32_bf16 v20, v134, s62, v20
  v_dot2_f32_bf16 v21, v134, s63, v21
  v_dot2_f32_bf16 v22, v135, s62, v22
  v_dot2_f32_bf16 v23, v135, s63, v23
  s_waitcnt vmcnt(7)
  v_dot2_f32_bf16 v8, v136, s62, v8
  v_dot2_f32_bf16 v9, v136, s63, v9
  v_dot2_f32_bf16 v10, v137, s62, v10
  v_dot2_f32_bf16 v11, v137, s63, v11
  v_dot2_f32_bf16 v12, v138, s62, v12
  v_dot2_f32_bf16 v13, v138, s63, v13
  v_dot2_f32_bf16 v14, v139, s62, v14
  v_dot2_f32_bf16 v15, v139, s63, v15
  s_waitcnt vmcnt(6)
  v_dot2_f32_bf16 v16, v140, s62, v16
  v_dot2_f32_bf16 v17, v140, s63, v17
  v_dot2_f32_bf16 v18, v141, s62, v18
  v_dot2_f32_bf16 v19, v141, s63, v19
  v_dot2_f32_bf16 v20, v142, s62, v20
  v_dot2_f32_bf16 v21, v142, s63, v21
  v_dot2_f32_bf16 v22, v143, s62, v22
  v_dot2_f32_bf16 v23, v143, s63, v23
  s_waitcnt vmcnt(5)
  v_dot2_f32_bf16 v8, v144, s62, v8
  v_dot2_f32_bf16 v9, v144, s63, v9
  v_dot2_f32_bf16 v10, v145, s62, v10
  v_dot2_f32_bf16 v11, v145, s63, v11
  v_dot2_f32_bf16 v12, v146, s62, v12
  v_dot2_f32_bf16 v13, v146, s63, v13
  v_dot2_f32_bf16 v14, v147, s62, v14
  v_dot2_f32_bf16 v15, v147, s63, v15
  s_waitcnt vmcnt(4)
  v_dot2_f32_bf16 v16, v148, s62, v16
  v_dot2_f32_bf16 v17, v148, s63, v17
  v_dot2_f32_bf16 v18, v149, s62, v18
  v_dot2_f32_bf16 v19, v149, s63, v19
  v_dot2_f32_bf16 v20, v150, s62, v20
  v_dot2_f32_bf16 v21, v150, s63, v21
  v_dot2_f32_bf16 v22, v151, s62, v22
  v_dot2_f32_bf16 v23, v151, s63, v23
  s_waitcnt vmcnt(3)
  v_dot2_f32_bf16 v8, v152, s62, v8
  v_dot2_f32_bf16 v9, v152, s63, v9
  v_dot2_f32_bf16 v10, v153, s62, v10
  v_dot2_f32_bf16 v11, v153, s63, v11
  v_dot2_f32_bf16 v12, v154, s62, v12
  v_dot2_f32_bf16 v13, v154, s63, v13
  v_dot2_f32_bf16 v14, v155, s62, v14
  v_dot2_f32_bf16 v15, v155, s63, v15
  s_waitcnt vmcnt(2)
  v_dot2_f32_bf16 v16, v156, s62, v16
  v_dot2_f32_bf16 v17, v156, s63, v17
  v_dot2_f32_bf16 v18, v157, s62, v18
  v_dot2_f32_bf16 v19, v157, s63, v19
  v_dot2_f32_bf16 v20, v158, s62, v20
  v_dot2_f32_bf16 v21, v158, s63, v21
  v_dot2_f32_bf16 v22, v159, s62, v22
  v_dot2_f32_bf16 v23, v159, s63, v23
  s_waitcnt vmcnt(1)
  v_dot2_f32_bf16 v8, v160, s62, v8
  v_dot2_f32_bf16 v9, v160, s63, v9
  v_dot2_f32_bf16 v10, v161, s62, v10
  v_dot2_f32_bf16 v11, v161, s63, v11
  v_dot2_f32_bf16 v12, v162, s62, v12
  v_dot2_f32_bf16 v13, v162, s63, v13
  v_dot2_f32_bf16 v14, v163, s62, v14
  v_dot2_f32_bf16 v15, v163, s63, v15
  s_waitcnt vmcnt(0)
  v_dot2_f32_bf16 v16, v164, s62, v16
  v_dot2_f32_bf16 v17, v164, s63, v17
  v_dot2_f32_bf16 v18, v165, s62, v18
  v_dot2_f32_bf16 v19, v165, s63, v19
  v_dot2_f32_bf16 v20, v166, s62, v20
  v_dot2_f32_bf16 v21, v166, s63, v21
  v_dot2_f32_bf16 v22, v167, s62, v22
  v_dot2_f32_bf16 v23, v167, s63, v23
  ds_write_b128 v3, v[8:11] offset:16640
  ds_write_b128 v3, v[12:15] offset:16656
  ds_write_b128 v3, v[16:19] offset:24896
  ds_write_b128 v3, v[20:23] offset:24912
  s_waitcnt lgkmcnt(0)
  s_barrier
  ds_read_b32 v24, v4 offset:16640
  ds_read_b32 v25, v4 offset:16896
  ds_read_b32 v26, v4 offset:17152
  ds_read_b32 v27, v4 offset:17408
  ds_read_b32 v28, v4 offset:17664
  ds_read_b32 v29, v4 offset:17920
  ds_read_b32 v30, v4 offset:18176
  ds_read_b32 v31, v4 offset:18432
  ds_read_b32 v32, v4 offset:18688
  ds_read_b32 v33, v4 offset:18944
  ds_read_b32 v34, v4 offset:19200
  ds_read_b32 v35, v4 offset:19456
  ds_read_b32 v36, v4 offset:19712
  ds_read_b32 v37, v4 offset:19968
  ds_read_b32 v38, v4 offset:20224
  ds_read_b32 v39, v4 offset:20480
  ds_read_b32 v40, v4 offset:20736
  ds_read_b32 v41, v4 offset:20992
  ds_read_b32 v42, v4 offset:21248
  ds_read_b32 v43, v4 offset:21504
  ds_read_b32 v44, v4 offset:21760
  ds_read_b32 v45, v4 offset:22016
  ds_read_b32 v46, v4 offset:22272
  ds_read_b32 v47, v4 offset:22528
  ds_read_b32 v48, v4 offset:22784
  ds_read_b32 v49, v4 offset:23040
  ds_read_b32 v50, v4 offset:23296
  ds_read_b32 v51, v4 offset:23552
  ds_read_b32 v52, v4 offset:23808
  ds_read_b32 v53, v4 offset:24064
  ds_read_b32 v54, v4 offset:24320
  ds_read_b32 v55, v4 offset:24576
  ds_read_b32 v56, v4 offset:16768
  ds_read_b32 v57, v4 offset:17024
  ds_read_b32 v58, v4 offset:17280
  ds_read_b32 v59, v4 offset:17536
  ds_read_b32 v60, v4 offset:17792
  ds_read_b32 v61, v4 offset:18048
  ds_read_b32 v62, v4 offset:18304
  ds_read_b32 v63, v4 offset:18560
  ds_read_b32 v64, v4 offset:18816
  ds_read_b32 v65, v4 offset:19072
  ds_read_b32 v66, v4 offset:19328
  ds_read_b32 v67, v4 offset:19584
  ds_read_b32 v68, v4 offset:19840
  ds_read_b32 v69, v4 offset:20096
  ds_read_b32 v70, v4 offset:20352
  ds_read_b32 v71, v4 offset:20608
  ds_read_b32 v72, v4 offset:20864
  ds_read_b32 v73, v4 offset:21120
  ds_read_b32 v74, v4 offset:21376
  ds_read_b32 v75, v4 offset:21632
  ds_read_b32 v76, v4 offset:21888
  ds_read_b32 v77, v4 offset:22144
  ds_read_b32 v78, v4 offset:22400
  ds_read_b32 v79, v4 offset:22656
  ds_read_b32 v80, v4 offset:22912
  ds_read_b32 v81, v4 offset:23168
  ds_read_b32 v82, v4 offset:23424
  ds_read_b32 v83, v4 offset:23680
  ds_read_b32 v84, v4 offset:23936
  ds_read_b32 v85, v4 offset:24192
  ds_read_b32 v86, v4 offset:24448
  ds_read_b32 v87, v4 offset:24704
  s_waitcnt lgkmcnt(15)
  v_add_f32 v24, v24, v40
  v_add_f32 v25, v25, v41
  v_add_f32 v26, v26, v42
  v_add_f32 v27, v27, v43
  v_add_f32 v28, v28, v44
  v_add_f32 v29, v29, v45
  v_add_f32 v30, v30, v46
  v_add_f32 v31, v31, v47
  v_add_f32 v32, v32, v48
  v_add_f32 v33, v33, v49
  v_add_f32 v34, v34, v50
  v_add_f32 v35, v35, v51
  v_add_f32 v36, v36, v52
  v_add_f32 v37, v37, v53
  v_add_f32 v38, v38, v54
  v_add_f32 v39, v39, v55
  v_add_f32 v24, v24, v32
  v_add_f32 v25, v25, v33
  v_add_f32 v26, v26, v34
  v_add_f32 v27, v27, v35
  v_add_f32 v28, v28, v36
  v_add_f32 v29, v29, v37
  v_add_f32 v30, v30, v38
  v_add_f32 v31, v31, v39
  v_add_f32 v24, v24, v28
  v_add_f32 v25, v25, v29
  v_add_f32 v26, v26, v30
  v_add_f32 v27, v27, v31
  v_add_f32 v24, v24, v26
  v_add_f32 v25, v25, v27
  v_add_f32 v24, v24, v25
  v_min_u32 v24, -2, v24
  buffer_store_dword v24, v5, s[36:39], s45 offen offset:0 sc1
  v_add_f32 v56, v56, v72
  s_waitcnt lgkmcnt(14)
  v_add_f32 v57, v57, v73
  s_waitcnt lgkmcnt(13)
  v_add_f32 v58, v58, v74
  s_waitcnt lgkmcnt(12)
  v_add_f32 v59, v59, v75
  s_waitcnt lgkmcnt(11)
  v_add_f32 v60, v60, v76
  s_waitcnt lgkmcnt(10)
  v_add_f32 v61, v61, v77
  s_waitcnt lgkmcnt(9)
  v_add_f32 v62, v62, v78
  s_waitcnt lgkmcnt(8)
  v_add_f32 v63, v63, v79
  s_waitcnt lgkmcnt(7)
  v_add_f32 v64, v64, v80
  s_waitcnt lgkmcnt(6)
  v_add_f32 v65, v65, v81
  s_waitcnt lgkmcnt(5)
  v_add_f32 v66, v66, v82
  s_waitcnt lgkmcnt(4)
  v_add_f32 v67, v67, v83
  s_waitcnt lgkmcnt(3)
  v_add_f32 v68, v68, v84
  s_waitcnt lgkmcnt(2)
  v_add_f32 v69, v69, v85
  s_waitcnt lgkmcnt(1)
  v_add_f32 v70, v70, v86
  s_waitcnt lgkmcnt(0)
  v_add_f32 v71, v71, v87
  v_add_f32 v56, v56, v64
  v_add_f32 v57, v57, v65
  v_add_f32 v58, v58, v66
  v_add_f32 v59, v59, v67
  v_add_f32 v60, v60, v68
  v_add_f32 v61, v61, v69
  v_add_f32 v62, v62, v70
  v_add_f32 v63, v63, v71
  v_add_f32 v56, v56, v60
  v_add_f32 v57, v57, v61
  v_add_f32 v58, v58, v62
  v_add_f32 v59, v59, v63
  v_add_f32 v56, v56, v58
  v_add_f32 v57, v57, v59
  v_add_f32 v56, v56, v57
  v_min_u32 v56, -2, v56
  buffer_store_dword v56, v5, s[36:39], s45 offen offset:2560 sc1
  s_add_u32 s45, s45, 0x1400
  buffer_load_dwordx4 v[88:91], v2, s[24:27], s50 offen
  buffer_load_dwordx4 v[92:95], v2, s[28:31], s50 offen
  s_add_u32 s50, s50, s44
  buffer_load_dwordx4 v[96:99], v2, s[24:27], s50 offen
  buffer_load_dwordx4 v[100:103], v2, s[28:31], s50 offen
  s_add_u32 s50, s50, s44
  buffer_load_dwordx4 v[104:107], v2, s[24:27], s50 offen
  buffer_load_dwordx4 v[108:111], v2, s[28:31], s50 offen
  s_add_u32 s50, s50, s44
  buffer_load_dwordx4 v[112:115], v2, s[24:27], s50 offen
  buffer_load_dwordx4 v[116:119], v2, s[28:31], s50 offen
  s_add_u32 s50, s50, s44
  buffer_load_dwordx4 v[120:123], v2, s[24:27], s50 offen
  buffer_load_dwordx4 v[124:127], v2, s[28:31], s50 offen
  s_add_u32 s50, s50, s44
  buffer_load_dwordx4 v[128:131], v2, s[24:27], s50 offen
  buffer_load_dwordx4 v[132:135], v2, s[28:31], s50 offen
  s_add_u32 s50, s50, s44
  buffer_load_dwordx4 v[136:139], v2, s[24:27], s50 offen
  buffer_load_dwordx4 v[140:143], v2, s[28:31], s50 offen
  s_add_u32 s50, s50, s44
  buffer_load_dwordx4 v[144:147], v2, s[24:27], s50 offen
  buffer_load_dwordx4 v[148:151], v2, s[28:31], s50 offen
  s_add_u32 s50, s50, s44
  buffer_load_dwordx4 v[152:155], v2, s[24:27], s50 offen
  buffer_load_dwordx4 v[156:159], v2, s[28:31], s50 offen
  s_add_u32 s50, s50, s44
  buffer_load_dwordx4 v[160:163], v2, s[24:27], s50 offen
  buffer_load_dwordx4 v[164:167], v2, s[28:31], s50 offen
  s_add_u32 s50, s50, s44
  s_waitcnt vmcnt(19)
  v_dot2_f32_bf16 v8, v88, s62, 0
  v_dot2_f32_bf16 v9, v88, s63, 0
  v_dot2_f32_bf16 v10, v89, s62, 0
  v_dot2_f32_bf16 v11, v89, s63, 0
  v_dot2_f32_bf16 v12, v90, s62, 0
  v_dot2_f32_bf16 v13, v90, s63, 0
  v_dot2_f32_bf16 v14, v91, s62, 0
  v_dot2_f32_bf16 v15, v91, s63, 0
  s_waitcnt vmcnt(18)
  v_dot2_f32_bf16 v16, v92, s62, 0
  v_dot2_f32_bf16 v17, v92, s63, 0
  v_dot2_f32_bf16 v18, v93, s62, 0
  v_dot2_f32_bf16 v19, v93, s63, 0
  v_dot2_f32_bf16 v20, v94, s62, 0
  v_dot2_f32_bf16 v21, v94, s63, 0
  v_dot2_f32_bf16 v22, v95, s62, 0
  v_dot2_f32_bf16 v23, v95, s63, 0
  s_waitcnt vmcnt(17)
  v_dot2_f32_bf16 v8, v96, s62, v8
  v_dot2_f32_bf16 v9, v96, s63, v9
  v_dot2_f32_bf16 v10, v97, s62, v10
  v_dot2_f32_bf16 v11, v97, s63, v11
  v_dot2_f32_bf16 v12, v98, s62, v12
  v_dot2_f32_bf16 v13, v98, s63, v13
  v_dot2_f32_bf16 v14, v99, s62, v14
  v_dot2_f32_bf16 v15, v99, s63, v15
  s_waitcnt vmcnt(16)
  v_dot2_f32_bf16 v16, v100, s62, v16
  v_dot2_f32_bf16 v17, v100, s63, v17
  v_dot2_f32_bf16 v18, v101, s62, v18
  v_dot2_f32_bf16 v19, v101, s63, v19
  v_dot2_f32_bf16 v20, v102, s62, v20
  v_dot2_f32_bf16 v21, v102, s63, v21
  v_dot2_f32_bf16 v22, v103, s62, v22
  v_dot2_f32_bf16 v23, v103, s63, v23
  s_waitcnt vmcnt(15)
  v_dot2_f32_bf16 v8, v104, s62, v8
  v_dot2_f32_bf16 v9, v104, s63, v9
  v_dot2_f32_bf16 v10, v105, s62, v10
  v_dot2_f32_bf16 v11, v105, s63, v11
  v_dot2_f32_bf16 v12, v106, s62, v12
  v_dot2_f32_bf16 v13, v106, s63, v13
  v_dot2_f32_bf16 v14, v107, s62, v14
  v_dot2_f32_bf16 v15, v107, s63, v15
  s_waitcnt vmcnt(14)
  v_dot2_f32_bf16 v16, v108, s62, v16
  v_dot2_f32_bf16 v17, v108, s63, v17
  v_dot2_f32_bf16 v18, v109, s62, v18
  v_dot2_f32_bf16 v19, v109, s63, v19
  v_dot2_f32_bf16 v20, v110, s62, v20
  v_dot2_f32_bf16 v21, v110, s63, v21
  v_dot2_f32_bf16 v22, v111, s62, v22
  v_dot2_f32_bf16 v23, v111, s63, v23
  s_waitcnt vmcnt(13)
  v_dot2_f32_bf16 v8, v112, s62, v8
  v_dot2_f32_bf16 v9, v112, s63, v9
  v_dot2_f32_bf16 v10, v113, s62, v10
  v_dot2_f32_bf16 v11, v113, s63, v11
  v_dot2_f32_bf16 v12, v114, s62, v12
  v_dot2_f32_bf16 v13, v114, s63, v13
  v_dot2_f32_bf16 v14, v115, s62, v14
  v_dot2_f32_bf16 v15, v115, s63, v15
  s_waitcnt vmcnt(12)
  v_dot2_f32_bf16 v16, v116, s62, v16
  v_dot2_f32_bf16 v17, v116, s63, v17
  v_dot2_f32_bf16 v18, v117, s62, v18
  v_dot2_f32_bf16 v19, v117, s63, v19
  v_dot2_f32_bf16 v20, v118, s62, v20
  v_dot2_f32_bf16 v21, v118, s63, v21
  v_dot2_f32_bf16 v22, v119, s62, v22
  v_dot2_f32_bf16 v23, v119, s63, v23
  s_waitcnt vmcnt(11)
  v_dot2_f32_bf16 v8, v120, s62, v8
  v_dot2_f32_bf16 v9, v120, s63, v9
  v_dot2_f32_bf16 v10, v121, s62, v10
  v_dot2_f32_bf16 v11, v121, s63, v11
  v_dot2_f32_bf16 v12, v122, s62, v12
  v_dot2_f32_bf16 v13, v122, s63, v13
  v_dot2_f32_bf16 v14, v123, s62, v14
  v_dot2_f32_bf16 v15, v123, s63, v15
  s_waitcnt vmcnt(10)
  v_dot2_f32_bf16 v16, v124, s62, v16
  v_dot2_f32_bf16 v17, v124, s63, v17
  v_dot2_f32_bf16 v18, v125, s62, v18
  v_dot2_f32_bf16 v19, v125, s63, v19
  v_dot2_f32_bf16 v20, v126, s62, v20
  v_dot2_f32_bf16 v21, v126, s63, v21
  v_dot2_f32_bf16 v22, v127, s62, v22
  v_dot2_f32_bf16 v23, v127, s63, v23
  s_waitcnt vmcnt(9)
  v_dot2_f32_bf16 v8, v128, s62, v8
  v_dot2_f32_bf16 v9, v128, s63, v9
  v_dot2_f32_bf16 v10, v129, s62, v10
  v_dot2_f32_bf16 v11, v129, s63, v11
  v_dot2_f32_bf16 v12, v130, s62, v12
  v_dot2_f32_bf16 v13, v130, s63, v13
  v_dot2_f32_bf16 v14, v131, s62, v14
  v_dot2_f32_bf16 v15, v131, s63, v15
  s_waitcnt vmcnt(8)
  v_dot2_f32_bf16 v16, v132, s62, v16
  v_dot2_f32_bf16 v17, v132, s63, v17
  v_dot2_f32_bf16 v18, v133, s62, v18
  v_dot2_f32_bf16 v19, v133, s63, v19
  v_dot2_f32_bf16 v20, v134, s62, v20
  v_dot2_f32_bf16 v21, v134, s63, v21
  v_dot2_f32_bf16 v22, v135, s62, v22
  v_dot2_f32_bf16 v23, v135, s63, v23
  s_waitcnt vmcnt(7)
  v_dot2_f32_bf16 v8, v136, s62, v8
  v_dot2_f32_bf16 v9, v136, s63, v9
  v_dot2_f32_bf16 v10, v137, s62, v10
  v_dot2_f32_bf16 v11, v137, s63, v11
  v_dot2_f32_bf16 v12, v138, s62, v12
  v_dot2_f32_bf16 v13, v138, s63, v13
  v_dot2_f32_bf16 v14, v139, s62, v14
  v_dot2_f32_bf16 v15, v139, s63, v15
  s_waitcnt vmcnt(6)
  v_dot2_f32_bf16 v16, v140, s62, v16
  v_dot2_f32_bf16 v17, v140, s63, v17
  v_dot2_f32_bf16 v18, v141, s62, v18
  v_dot2_f32_bf16 v19, v141, s63, v19
  v_dot2_f32_bf16 v20, v142, s62, v20
  v_dot2_f32_bf16 v21, v142, s63, v21
  v_dot2_f32_bf16 v22, v143, s62, v22
  v_dot2_f32_bf16 v23, v143, s63, v23
  s_waitcnt vmcnt(5)
  v_dot2_f32_bf16 v8, v144, s62, v8
  v_dot2_f32_bf16 v9, v144, s63, v9
  v_dot2_f32_bf16 v10, v145, s62, v10
  v_dot2_f32_bf16 v11, v145, s63, v11
  v_dot2_f32_bf16 v12, v146, s62, v12
  v_dot2_f32_bf16 v13, v146, s63, v13
  v_dot2_f32_bf16 v14, v147, s62, v14
  v_dot2_f32_bf16 v15, v147, s63, v15
  s_waitcnt vmcnt(4)
  v_dot2_f32_bf16 v16, v148, s62, v16
  v_dot2_f32_bf16 v17, v148, s63, v17
  v_dot2_f32_bf16 v18, v149, s62, v18
  v_dot2_f32_bf16 v19, v149, s63, v19
  v_dot2_f32_bf16 v20, v150, s62, v20
  v_dot2_f32_bf16 v21, v150, s63, v21
  v_dot2_f32_bf16 v22, v151, s62, v22
  v_dot2_f32_bf16 v23, v151, s63, v23
  s_waitcnt vmcnt(3)
  v_dot2_f32_bf16 v8, v152, s62, v8
  v_dot2_f32_bf16 v9, v152, s63, v9
  v_dot2_f32_bf16 v10, v153, s62, v10
  v_dot2_f32_bf16 v11, v153, s63, v11
  v_dot2_f32_bf16 v12, v154, s62, v12
  v_dot2_f32_bf16 v13, v154, s63, v13
  v_dot2_f32_bf16 v14, v155, s62, v14
  v_dot2_f32_bf16 v15, v155, s63, v15
  s_waitcnt vmcnt(2)
  v_dot2_f32_bf16 v16, v156, s62, v16
  v_dot2_f32_bf16 v17, v156, s63, v17
  v_dot2_f32_bf16 v18, v157, s62, v18
  v_dot2_f32_bf16 v19, v157, s63, v19
  v_dot2_f32_bf16 v20, v158, s62, v20
  v_dot2_f32_bf16 v21, v158, s63, v21
  v_dot2_f32_bf16 v22, v159, s62, v22
  v_dot2_f32_bf16 v23, v159, s63, v23
  s_waitcnt vmcnt(1)
  v_dot2_f32_bf16 v8, v160, s62, v8
  v_dot2_f32_bf16 v9, v160, s63, v9
  v_dot2_f32_bf16 v10, v161, s62, v10
  v_dot2_f32_bf16 v11, v161, s63, v11
  v_dot2_f32_bf16 v12, v162, s62, v12
  v_dot2_f32_bf16 v13, v162, s63, v13
  v_dot2_f32_bf16 v14, v163, s62, v14
  v_dot2_f32_bf16 v15, v163, s63, v15
  s_waitcnt vmcnt(0)
  v_dot2_f32_bf16 v16, v164, s62, v16
  v_dot2_f32_bf16 v17, v164, s63, v17
  v_dot2_f32_bf16 v18, v165, s62, v18
  v_dot2_f32_bf16 v19, v165, s63, v19
  v_dot2_f32_bf16 v20, v166, s62, v20
  v_dot2_f32_bf16 v21, v166, s63, v21
  v_dot2_f32_bf16 v22, v167, s62, v22
  v_dot2_f32_bf16 v23, v167, s63, v23
  ds_write_b128 v3, v[8:11] offset:33280
  ds_write_b128 v3, v[12:15] offset:33296
  ds_write_b128 v3, v[16:19] offset:41536
  ds_write_b128 v3, v[20:23] offset:41552
  s_waitcnt lgkmcnt(0)
  s_barrier
  ds_read_b32 v24, v4 offset:33280
  ds_read_b32 v25, v4 offset:33536
  ds_read_b32 v26, v4 offset:33792
  ds_read_b32 v27, v4 offset:34048
  ds_read_b32 v28, v4 offset:34304
  ds_read_b32 v29, v4 offset:34560
  ds_read_b32 v30, v4 offset:34816
  ds_read_b32 v31, v4 offset:35072
  ds_read_b32 v32, v4 offset:35328
  ds_read_b32 v33, v4 offset:35584
  ds_read_b32 v34, v4 offset:35840
  ds_read_b32 v35, v4 offset:36096
  ds_read_b32 v36, v4 offset:36352
  ds_read_b32 v37, v4 offset:36608
  ds_read_b32 v38, v4 offset:36864
  ds_read_b32 v39, v4 offset:37120
  ds_read_b32 v40, v4 offset:37376
  ds_read_b32 v41, v4 offset:37632
  ds_read_b32 v42, v4 offset:37888
  ds_read_b32 v43, v4 offset:38144
  ds_read_b32 v44, v4 offset:38400
  ds_read_b32 v45, v4 offset:38656
  ds_read_b32 v46, v4 offset:38912
  ds_read_b32 v47, v4 offset:39168
  ds_read_b32 v48, v4 offset:39424
  ds_read_b32 v49, v4 offset:39680
  ds_read_b32 v50, v4 offset:39936
  ds_read_b32 v51, v4 offset:40192
  ds_read_b32 v52, v4 offset:40448
  ds_read_b32 v53, v4 offset:40704
  ds_read_b32 v54, v4 offset:40960
  ds_read_b32 v55, v4 offset:41216
  ds_read_b32 v56, v4 offset:33408
  ds_read_b32 v57, v4 offset:33664
  ds_read_b32 v58, v4 offset:33920
  ds_read_b32 v59, v4 offset:34176
  ds_read_b32 v60, v4 offset:34432
  ds_read_b32 v61, v4 offset:34688
  ds_read_b32 v62, v4 offset:34944
  ds_read_b32 v63, v4 offset:35200
  ds_read_b32 v64, v4 offset:35456
  ds_read_b32 v65, v4 offset:35712
  ds_read_b32 v66, v4 offset:35968
  ds_read_b32 v67, v4 offset:36224
  ds_read_b32 v68, v4 offset:36480
  ds_read_b32 v69, v4 offset:36736
  ds_read_b32 v70, v4 offset:36992
  ds_read_b32 v71, v4 offset:37248
  ds_read_b32 v72, v4 offset:37504
  ds_read_b32 v73, v4 offset:37760
  ds_read_b32 v74, v4 offset:38016
  ds_read_b32 v75, v4 offset:38272
  ds_read_b32 v76, v4 offset:38528
  ds_read_b32 v77, v4 offset:38784
  ds_read_b32 v78, v4 offset:39040
  ds_read_b32 v79, v4 offset:39296
  ds_read_b32 v80, v4 offset:39552
  ds_read_b32 v81, v4 offset:39808
  ds_read_b32 v82, v4 offset:40064
  ds_read_b32 v83, v4 offset:40320
  ds_read_b32 v84, v4 offset:40576
  ds_read_b32 v85, v4 offset:40832
  ds_read_b32 v86, v4 offset:41088
  ds_read_b32 v87, v4 offset:41344
  s_waitcnt lgkmcnt(15)
  v_add_f32 v24, v24, v40
  v_add_f32 v25, v25, v41
  v_add_f32 v26, v26, v42
  v_add_f32 v27, v27, v43
  v_add_f32 v28, v28, v44
  v_add_f32 v29, v29, v45
  v_add_f32 v30, v30, v46
  v_add_f32 v31, v31, v47
  v_add_f32 v32, v32, v48
  v_add_f32 v33, v33, v49
  v_add_f32 v34, v34, v50
  v_add_f32 v35, v35, v51
  v_add_f32 v36, v36, v52
  v_add_f32 v37, v37, v53
  v_add_f32 v38, v38, v54
  v_add_f32 v39, v39, v55
  v_add_f32 v24, v24, v32
  v_add_f32 v25, v25, v33
  v_add_f32 v26, v26, v34
  v_add_f32 v27, v27, v35
  v_add_f32 v28, v28, v36
  v_add_f32 v29, v29, v37
  v_add_f32 v30, v30, v38
  v_add_f32 v31, v31, v39
  v_add_f32 v24, v24, v28
  v_add_f32 v25, v25, v29
  v_add_f32 v26, v26, v30
  v_add_f32 v27, v27, v31
  v_add_f32 v24, v24, v26
  v_add_f32 v25, v25, v27
  v_add_f32 v24, v24, v25
  v_min_u32 v24, -2, v24
  buffer_store_dword v24, v5, s[36:39], s45 offen offset:0 sc1
  v_add_f32 v56, v56, v72
  s_waitcnt lgkmcnt(14)
  v_add_f32 v57, v57, v73
  s_waitcnt lgkmcnt(13)
  v_add_f32 v58, v58, v74
  s_waitcnt lgkmcnt(12)
  v_add_f32 v59, v59, v75
  s_waitcnt lgkmcnt(11)
  v_add_f32 v60, v60, v76
  s_waitcnt lgkmcnt(10)
  v_add_f32 v61, v61, v77
  s_waitcnt lgkmcnt(9)
  v_add_f32 v62, v62, v78
  s_waitcnt lgkmcnt(8)
  v_add_f32 v63, v63, v79
  s_waitcnt lgkmcnt(7)
  v_add_f32 v64, v64, v80
  s_waitcnt lgkmcnt(6)
  v_add_f32 v65, v65, v81
  s_waitcnt lgkmcnt(5)
  v_add_f32 v66, v66, v82
  s_waitcnt lgkmcnt(4)
  v_add_f32 v67, v67, v83
  s_waitcnt lgkmcnt(3)
  v_add_f32 v68, v68, v84
  s_waitcnt lgkmcnt(2)
  v_add_f32 v69, v69, v85
  s_waitcnt lgkmcnt(1)
  v_add_f32 v70, v70, v86
  s_waitcnt lgkmcnt(0)
  v_add_f32 v71, v71, v87
  v_add_f32 v56, v56, v64
  v_add_f32 v57, v57, v65
  v_add_f32 v58, v58, v66
  v_add_f32 v59, v59, v67
  v_add_f32 v60, v60, v68
  v_add_f32 v61, v61, v69
  v_add_f32 v62, v62, v70
  v_add_f32 v63, v63, v71
  v_add_f32 v56, v56, v60
  v_add_f32 v57, v57, v61
  v_add_f32 v58, v58, v62
  v_add_f32 v59, v59, v63
  v_add_f32 v56, v56, v58
  v_add_f32 v57, v57, v59
  v_add_f32 v56, v56, v57
  v_min_u32 v56, -2, v56
  buffer_store_dword v56, v5, s[36:39], s45 offen offset:2560 sc1
  s_add_u32 s45, s45, 0x1400
  s_branch k1_side_x
k1_side_f:
  s_sub_u32 s52, s40, 28
  s_lshl_b32 s52, s52, 2
  s_add_u32 s52, s52, s41
  s_branch k1_side_r
k1_side_m:
  s_add_u32 s52, s40, 16
  s_cmp_ge_u32 s52, 40
  s_cbranch_scc1 k1_side_x
  s_cmp_lg_u32 s41, 1
  s_cbranch_scc1 k1_side_x
k1_side_r:
  s_mul_i32 s56, s41, 0x5000
  s_add_u32 s56, s56, 0x10000
  v_lshrrev_b32 v5, 5, v1
  v_bfe_u32 v6, v1, 2, 2
  v_lshl_add_u32 v5, v5, 3, v6
  v_mul_u32_u24 v5, 0x500, v5
  v_bfe_u32 v6, v1, 4, 1
  v_lshl_add_u32 v5, v6, 5, v5
  v_and_b32 v6, 1, v1
  v_lshl_add_u32 v5, v6, 4, v5
  v_bfe_u32 v6, v1, 1, 1
  v_lshl_add_u32 v5, v6, 3, v5
  v_add_u32 v4, s56, v5
  v_lshlrev_b32 v3, 4, v1
  s_mov_b32 s53, 4
  s_mov_b32 s54, 0
  s_mov_b32 s24, s8
  s_mov_b32 s25, s9
  s_mov_b32 s26, 0xc8000
  s_mov_b32 s27, 0x20000
  s_mul_i32 s55, s52, 0x6400
  s_cmp_lt_u32 s52, 32
  s_cbranch_scc1 k1_side_g
  s_sub_u32 s60, s52, 32
  s_mul_i32 s55, s60, 0x19000
  s_mov_b32 s53, 20
  s_mov_b32 s54, 16
k1_side_g:
  v_add_u32 v24, 0, v1
  v_mul_u32_u24 v25, 0xccd, v24
  v_lshrrev_b32 v25, 18, v25
  v_mul_u32_u24 v26, 0x50, v25
  v_sub_u32 v24, v24, v26
  v_lshrrev_b32 v26, 2, v25
  v_mul_u32_u24 v26, s53, v26
  v_and_b32 v25, 3, v25
  v_add3_u32 v25, v25, v26, s54
  v_mul_u32_u24 v25, 0x500, v25
  v_lshl_add_u32 v24, v24, 4, v25
  s_add_u32 m0, s56, 0
  s_nop 0
  buffer_load_dwordx4 v24, s[24:27], s55 offen lds
  v_add_u32 v27, 64, v1
  v_mul_u32_u24 v28, 0xccd, v27
  v_lshrrev_b32 v28, 18, v28
  v_mul_u32_u24 v29, 0x50, v28
  v_sub_u32 v27, v27, v29
  v_lshrrev_b32 v29, 2, v28
  v_mul_u32_u24 v29, s53, v29
  v_and_b32 v28, 3, v28
  v_add3_u32 v28, v28, v29, s54
  v_mul_u32_u24 v28, 0x500, v28
  v_lshl_add_u32 v27, v27, 4, v28
  s_add_u32 m0, s56, 0x400
  s_nop 0
  buffer_load_dwordx4 v27, s[24:27], s55 offen lds
  v_add_u32 v30, 0x80, v1
  v_mul_u32_u24 v31, 0xccd, v30
  v_lshrrev_b32 v31, 18, v31
  v_mul_u32_u24 v32, 0x50, v31
  v_sub_u32 v30, v30, v32
  v_lshrrev_b32 v32, 2, v31
  v_mul_u32_u24 v32, s53, v32
  v_and_b32 v31, 3, v31
  v_add3_u32 v31, v31, v32, s54
  v_mul_u32_u24 v31, 0x500, v31
  v_lshl_add_u32 v30, v30, 4, v31
  s_add_u32 m0, s56, 0x800
  s_nop 0
  buffer_load_dwordx4 v30, s[24:27], s55 offen lds
  v_add_u32 v33, 0xc0, v1
  v_mul_u32_u24 v34, 0xccd, v33
  v_lshrrev_b32 v34, 18, v34
  v_mul_u32_u24 v35, 0x50, v34
  v_sub_u32 v33, v33, v35
  v_lshrrev_b32 v35, 2, v34
  v_mul_u32_u24 v35, s53, v35
  v_and_b32 v34, 3, v34
  v_add3_u32 v34, v34, v35, s54
  v_mul_u32_u24 v34, 0x500, v34
  v_lshl_add_u32 v33, v33, 4, v34
  s_add_u32 m0, s56, 0xc00
  s_nop 0
  buffer_load_dwordx4 v33, s[24:27], s55 offen lds
  v_add_u32 v24, 0x100, v1
  v_mul_u32_u24 v25, 0xccd, v24
  v_lshrrev_b32 v25, 18, v25
  v_mul_u32_u24 v26, 0x50, v25
  v_sub_u32 v24, v24, v26
  v_lshrrev_b32 v26, 2, v25
  v_mul_u32_u24 v26, s53, v26
  v_and_b32 v25, 3, v25
  v_add3_u32 v25, v25, v26, s54
  v_mul_u32_u24 v25, 0x500, v25
  v_lshl_add_u32 v24, v24, 4, v25
  s_add_u32 m0, s56, 0x1000
  s_nop 0
  buffer_load_dwordx4 v24, s[24:27], s55 offen lds
  v_add_u32 v27, 0x140, v1
  v_mul_u32_u24 v28, 0xccd, v27
  v_lshrrev_b32 v28, 18, v28
  v_mul_u32_u24 v29, 0x50, v28
  v_sub_u32 v27, v27, v29
  v_lshrrev_b32 v29, 2, v28
  v_mul_u32_u24 v29, s53, v29
  v_and_b32 v28, 3, v28
  v_add3_u32 v28, v28, v29, s54
  v_mul_u32_u24 v28, 0x500, v28
  v_lshl_add_u32 v27, v27, 4, v28
  s_add_u32 m0, s56, 0x1400
  s_nop 0
  buffer_load_dwordx4 v27, s[24:27], s55 offen lds
  v_add_u32 v30, 0x180, v1
  v_mul_u32_u24 v31, 0xccd, v30
  v_lshrrev_b32 v31, 18, v31
  v_mul_u32_u24 v32, 0x50, v31
  v_sub_u32 v30, v30, v32
  v_lshrrev_b32 v32, 2, v31
  v_mul_u32_u24 v32, s53, v32
  v_and_b32 v31, 3, v31
  v_add3_u32 v31, v31, v32, s54
  v_mul_u32_u24 v31, 0x500, v31
  v_lshl_add_u32 v30, v30, 4, v31
  s_add_u32 m0, s56, 0x1800
  s_nop 0
  buffer_load_dwordx4 v30, s[24:27], s55 offen lds
  v_add_u32 v33, 0x1c0, v1
  v_mul_u32_u24 v34, 0xccd, v33
  v_lshrrev_b32 v34, 18, v34
  v_mul_u32_u24 v35, 0x50, v34
  v_sub_u32 v33, v33, v35
  v_lshrrev_b32 v35, 2, v34
  v_mul_u32_u24 v35, s53, v35
  v_and_b32 v34, 3, v34
  v_add3_u32 v34, v34, v35, s54
  v_mul_u32_u24 v34, 0x500, v34
  v_lshl_add_u32 v33, v33, 4, v34
  s_add_u32 m0, s56, 0x1c00
  s_nop 0
  buffer_load_dwordx4 v33, s[24:27], s55 offen lds
  v_add_u32 v24, 0x200, v1
  v_mul_u32_u24 v25, 0xccd, v24
  v_lshrrev_b32 v25, 18, v25
  v_mul_u32_u24 v26, 0x50, v25
  v_sub_u32 v24, v24, v26
  v_lshrrev_b32 v26, 2, v25
  v_mul_u32_u24 v26, s53, v26
  v_and_b32 v25, 3, v25
  v_add3_u32 v25, v25, v26, s54
  v_mul_u32_u24 v25, 0x500, v25
  v_lshl_add_u32 v24, v24, 4, v25
  s_add_u32 m0, s56, 0x2000
  s_nop 0
  buffer_load_dwordx4 v24, s[24:27], s55 offen lds
  v_add_u32 v27, 0x240, v1
  v_mul_u32_u24 v28, 0xccd, v27
  v_lshrrev_b32 v28, 18, v28
  v_mul_u32_u24 v29, 0x50, v28
  v_sub_u32 v27, v27, v29
  v_lshrrev_b32 v29, 2, v28
  v_mul_u32_u24 v29, s53, v29
  v_and_b32 v28, 3, v28
  v_add3_u32 v28, v28, v29, s54
  v_mul_u32_u24 v28, 0x500, v28
  v_lshl_add_u32 v27, v27, 4, v28
  s_add_u32 m0, s56, 0x2400
  s_nop 0
  buffer_load_dwordx4 v27, s[24:27], s55 offen lds
  v_add_u32 v30, 0x280, v1
  v_mul_u32_u24 v31, 0xccd, v30
  v_lshrrev_b32 v31, 18, v31
  v_mul_u32_u24 v32, 0x50, v31
  v_sub_u32 v30, v30, v32
  v_lshrrev_b32 v32, 2, v31
  v_mul_u32_u24 v32, s53, v32
  v_and_b32 v31, 3, v31
  v_add3_u32 v31, v31, v32, s54
  v_mul_u32_u24 v31, 0x500, v31
  v_lshl_add_u32 v30, v30, 4, v31
  s_add_u32 m0, s56, 0x2800
  s_nop 0
  buffer_load_dwordx4 v30, s[24:27], s55 offen lds
  v_add_u32 v33, 0x2c0, v1
  v_mul_u32_u24 v34, 0xccd, v33
  v_lshrrev_b32 v34, 18, v34
  v_mul_u32_u24 v35, 0x50, v34
  v_sub_u32 v33, v33, v35
  v_lshrrev_b32 v35, 2, v34
  v_mul_u32_u24 v35, s53, v35
  v_and_b32 v34, 3, v34
  v_add3_u32 v34, v34, v35, s54
  v_mul_u32_u24 v34, 0x500, v34
  v_lshl_add_u32 v33, v33, 4, v34
  s_add_u32 m0, s56, 0x2c00
  s_nop 0
  buffer_load_dwordx4 v33, s[24:27], s55 offen lds
  v_add_u32 v24, 0x300, v1
  v_mul_u32_u24 v25, 0xccd, v24
  v_lshrrev_b32 v25, 18, v25
  v_mul_u32_u24 v26, 0x50, v25
  v_sub_u32 v24, v24, v26
  v_lshrrev_b32 v26, 2, v25
  v_mul_u32_u24 v26, s53, v26
  v_and_b32 v25, 3, v25
  v_add3_u32 v25, v25, v26, s54
  v_mul_u32_u24 v25, 0x500, v25
  v_lshl_add_u32 v24, v24, 4, v25
  s_add_u32 m0, s56, 0x3000
  s_nop 0
  buffer_load_dwordx4 v24, s[24:27], s55 offen lds
  v_add_u32 v27, 0x340, v1
  v_mul_u32_u24 v28, 0xccd, v27
  v_lshrrev_b32 v28, 18, v28
  v_mul_u32_u24 v29, 0x50, v28
  v_sub_u32 v27, v27, v29
  v_lshrrev_b32 v29, 2, v28
  v_mul_u32_u24 v29, s53, v29
  v_and_b32 v28, 3, v28
  v_add3_u32 v28, v28, v29, s54
  v_mul_u32_u24 v28, 0x500, v28
  v_lshl_add_u32 v27, v27, 4, v28
  s_add_u32 m0, s56, 0x3400
  s_nop 0
  buffer_load_dwordx4 v27, s[24:27], s55 offen lds
  v_add_u32 v30, 0x380, v1
  v_mul_u32_u24 v31, 0xccd, v30
  v_lshrrev_b32 v31, 18, v31
  v_mul_u32_u24 v32, 0x50, v31
  v_sub_u32 v30, v30, v32
  v_lshrrev_b32 v32, 2, v31
  v_mul_u32_u24 v32, s53, v32
  v_and_b32 v31, 3, v31
  v_add3_u32 v31, v31, v32, s54
  v_mul_u32_u24 v31, 0x500, v31
  v_lshl_add_u32 v30, v30, 4, v31
  s_add_u32 m0, s56, 0x3800
  s_nop 0
  buffer_load_dwordx4 v30, s[24:27], s55 offen lds
  v_add_u32 v33, 0x3c0, v1
  v_mul_u32_u24 v34, 0xccd, v33
  v_lshrrev_b32 v34, 18, v34
  v_mul_u32_u24 v35, 0x50, v34
  v_sub_u32 v33, v33, v35
  v_lshrrev_b32 v35, 2, v34
  v_mul_u32_u24 v35, s53, v35
  v_and_b32 v34, 3, v34
  v_add3_u32 v34, v34, v35, s54
  v_mul_u32_u24 v34, 0x500, v34
  v_lshl_add_u32 v33, v33, 4, v34
  s_add_u32 m0, s56, 0x3c00
  s_nop 0
  buffer_load_dwordx4 v33, s[24:27], s55 offen lds
  v_add_u32 v24, 0x400, v1
  v_mul_u32_u24 v25, 0xccd, v24
  v_lshrrev_b32 v25, 18, v25
  v_mul_u32_u24 v26, 0x50, v25
  v_sub_u32 v24, v24, v26
  v_lshrrev_b32 v26, 2, v25
  v_mul_u32_u24 v26, s53, v26
  v_and_b32 v25, 3, v25
  v_add3_u32 v25, v25, v26, s54
  v_mul_u32_u24 v25, 0x500, v25
  v_lshl_add_u32 v24, v24, 4, v25
  s_add_u32 m0, s56, 0x4000
  s_nop 0
  buffer_load_dwordx4 v24, s[24:27], s55 offen lds
  v_add_u32 v27, 0x440, v1
  v_mul_u32_u24 v28, 0xccd, v27
  v_lshrrev_b32 v28, 18, v28
  v_mul_u32_u24 v29, 0x50, v28
  v_sub_u32 v27, v27, v29
  v_lshrrev_b32 v29, 2, v28
  v_mul_u32_u24 v29, s53, v29
  v_and_b32 v28, 3, v28
  v_add3_u32 v28, v28, v29, s54
  v_mul_u32_u24 v28, 0x500, v28
  v_lshl_add_u32 v27, v27, 4, v28
  s_add_u32 m0, s56, 0x4400
  s_nop 0
  buffer_load_dwordx4 v27, s[24:27], s55 offen lds
  v_add_u32 v30, 0x480, v1
  v_mul_u32_u24 v31, 0xccd, v30
  v_lshrrev_b32 v31, 18, v31
  v_mul_u32_u24 v32, 0x50, v31
  v_sub_u32 v30, v30, v32
  v_lshrrev_b32 v32, 2, v31
  v_mul_u32_u24 v32, s53, v32
  v_and_b32 v31, 3, v31
  v_add3_u32 v31, v31, v32, s54
  v_mul_u32_u24 v31, 0x500, v31
  v_lshl_add_u32 v30, v30, 4, v31
  s_add_u32 m0, s56, 0x4800
  s_nop 0
  buffer_load_dwordx4 v30, s[24:27], s55 offen lds
  v_add_u32 v33, 0x4c0, v1
  v_mul_u32_u24 v34, 0xccd, v33
  v_lshrrev_b32 v34, 18, v34
  v_mul_u32_u24 v35, 0x50, v34
  v_sub_u32 v33, v33, v35
  v_lshrrev_b32 v35, 2, v34
  v_mul_u32_u24 v35, s53, v35
  v_and_b32 v34, 3, v34
  v_add3_u32 v34, v34, v35, s54
  v_mul_u32_u24 v34, 0x500, v34
  v_lshl_add_u32 v33, v33, 4, v34
  s_add_u32 m0, s56, 0x4c00
  s_nop 0
  buffer_load_dwordx4 v33, s[24:27], s55 offen lds
  s_mul_i32 s60, s52, 0x1400
  s_add_u32 s60, s60, 0x1800000
  s_waitcnt vmcnt(0)
  ds_read_b64_tr_b16 v[88:89], v4 offset:0
  ds_read_b64_tr_b16 v[90:91], v4 offset:5120
  ds_read_b64_tr_b16 v[92:93], v4 offset:64
  ds_read_b64_tr_b16 v[94:95], v4 offset:5184
  ds_read_b64_tr_b16 v[96:97], v4 offset:128
  ds_read_b64_tr_b16 v[98:99], v4 offset:5248
  ds_read_b64_tr_b16 v[100:101], v4 offset:192
  ds_read_b64_tr_b16 v[102:103], v4 offset:5312
  ds_read_b64_tr_b16 v[104:105], v4 offset:256
  ds_read_b64_tr_b16 v[106:107], v4 offset:5376
  ds_read_b64_tr_b16 v[108:109], v4 offset:320
  ds_read_b64_tr_b16 v[110:111], v4 offset:5440
  ds_read_b64_tr_b16 v[112:113], v4 offset:384
  ds_read_b64_tr_b16 v[114:115], v4 offset:5504
  ds_read_b64_tr_b16 v[116:117], v4 offset:448
  ds_read_b64_tr_b16 v[118:119], v4 offset:5568
  ds_read_b64_tr_b16 v[120:121], v4 offset:512
  ds_read_b64_tr_b16 v[122:123], v4 offset:5632
  ds_read_b64_tr_b16 v[124:125], v4 offset:576
  ds_read_b64_tr_b16 v[126:127], v4 offset:5696
  ds_read_b64_tr_b16 v[128:129], v4 offset:640
  ds_read_b64_tr_b16 v[130:131], v4 offset:5760
  ds_read_b64_tr_b16 v[132:133], v4 offset:704
  ds_read_b64_tr_b16 v[134:135], v4 offset:5824
  ds_read_b64_tr_b16 v[136:137], v4 offset:768
  ds_read_b64_tr_b16 v[138:139], v4 offset:5888
  ds_read_b64_tr_b16 v[140:141], v4 offset:832
  ds_read_b64_tr_b16 v[142:143], v4 offset:5952
  ds_read_b64_tr_b16 v[144:145], v4 offset:896
  ds_read_b64_tr_b16 v[146:147], v4 offset:6016
  ds_read_b64_tr_b16 v[148:149], v4 offset:960
  ds_read_b64_tr_b16 v[150:151], v4 offset:6080
  ds_read_b64_tr_b16 v[152:153], v4 offset:1024
  ds_read_b64_tr_b16 v[154:155], v4 offset:6144
  ds_read_b64_tr_b16 v[156:157], v4 offset:1088
  ds_read_b64_tr_b16 v[158:159], v4 offset:6208
  ds_read_b64_tr_b16 v[160:161], v4 offset:1152
  ds_read_b64_tr_b16 v[162:163], v4 offset:6272
  ds_read_b64_tr_b16 v[164:165], v4 offset:1216
  ds_read_b64_tr_b16 v[166:167], v4 offset:6336
  s_waitcnt lgkmcnt(15)
  buffer_store_dwordx4 v[88:91], v3, s[36:39], s60 offen offset:0 sc1
  buffer_store_dwordx4 v[92:95], v3, s[36:39], s60 offen offset:1024 sc1
  buffer_store_dwordx4 v[96:99], v3, s[36:39], s60 offen offset:2048 sc1
  buffer_store_dwordx4 v[100:103], v3, s[36:39], s60 offen offset:3072 sc1
  s_add_u32 s61, s60, 0x1000
  buffer_store_dwordx4 v[104:107], v3, s[36:39], s61 offen offset:0 sc1
  s_add_u32 s60, s60, 0x32000
  buffer_store_dwordx4 v[108:111], v3, s[36:39], s60 offen offset:0 sc1
  buffer_store_dwordx4 v[112:115], v3, s[36:39], s60 offen offset:1024 sc1
  buffer_store_dwordx4 v[116:119], v3, s[36:39], s60 offen offset:2048 sc1
  buffer_store_dwordx4 v[120:123], v3, s[36:39], s60 offen offset:3072 sc1
  s_add_u32 s61, s60, 0x1000
  buffer_store_dwordx4 v[124:127], v3, s[36:39], s61 offen offset:0 sc1
  s_add_u32 s60, s60, 0x32000
  buffer_store_dwordx4 v[128:131], v3, s[36:39], s60 offen offset:0 sc1
  buffer_store_dwordx4 v[132:135], v3, s[36:39], s60 offen offset:1024 sc1
  s_waitcnt lgkmcnt(14)
  buffer_store_dwordx4 v[136:139], v3, s[36:39], s60 offen offset:2048 sc1
  s_waitcnt lgkmcnt(12)
  buffer_store_dwordx4 v[140:143], v3, s[36:39], s60 offen offset:3072 sc1
  s_add_u32 s61, s60, 0x1000
  s_waitcnt lgkmcnt(10)
  buffer_store_dwordx4 v[144:147], v3, s[36:39], s61 offen offset:0 sc1
  s_add_u32 s60, s60, 0x32000
  s_waitcnt lgkmcnt(8)
  buffer_store_dwordx4 v[148:151], v3, s[36:39], s60 offen offset:0 sc1
  s_waitcnt lgkmcnt(6)
  buffer_store_dwordx4 v[152:155], v3, s[36:39], s60 offen offset:1024 sc1
  s_waitcnt lgkmcnt(4)
  buffer_store_dwordx4 v[156:159], v3, s[36:39], s60 offen offset:2048 sc1
  s_waitcnt lgkmcnt(2)
  buffer_store_dwordx4 v[160:163], v3, s[36:39], s60 offen offset:3072 sc1
  s_add_u32 s61, s60, 0x1000
  s_waitcnt lgkmcnt(0)
  buffer_store_dwordx4 v[164:167], v3, s[36:39], s61 offen offset:0 sc1
  s_add_u32 s60, s60, 0x32000
k1_side_x:
k1_exit:
  s_endpgm
.text
.globl k2_kernel
.p2align 8
.type k2_kernel,@function
k2_kernel:
  s_cmp_ge_u32 s2, 0x100
  s_cbranch_scc1 k2_exit
  s_load_dwordx16 s[4:19], s[0:1], 0
  s_load_dwordx4 s[20:23], s[0:1], 64
  s_and_b32 s3, s2, 7
  s_lshr_b32 s65, s2, 6
  v_lshrrev_b32 v120, 6, v0
  s_nop 0
  v_readfirstlane_b32 s28, v120
  s_nop 0
  s_cmp_ge_u32 s28, 8
  s_cbranch_scc1 k2_gemm
  v_and_b32 v129, 63, v0
  v_lshlrev_b32 v128, 4, v129
  s_mov_b32 s64, 0
k2_att:
  s_lshl_b32 s29, s3, 2
  s_add_u32 s29, s29, s65
  s_setprio 2
  s_lshr_b32 s35, s28, 2
  s_and_b32 s56, s28, 3
  s_lshl_b32 s31, s56, 1
  s_add_u32 s31, s31, s35
  s_mul_i32 s62, s29, 5
  s_lshr_b32 s62, s62, 1
  s_and_b32 s63, s29, 1
  s_mov_b32 s50, 0
  s_mov_b32 s51, -1
  s_mov_b64 s[46:47], 0
  s_mov_b64 s[48:49], 0
  s_mov_b32 s61, 2
  s_mul_i32 s34, s56, 0xc00
  s_lshr_b32 s52, s56, 1
  s_lshl_b32 s52, s52, 5
  s_and_b32 s53, s56, 1
  s_lshl_b32 s53, s53, 1
  s_add_u32 s58, s52, s53
  s_cmp_lt_u32 s28, 4
  s_cbranch_scc0 k2_kw
  s_add_u32 s34, s34, 0x3000
  v_add_u32 v120, 0, v129
  v_mul_u32_u24 v121, 0xaab, v120
  v_lshrrev_b32 v121, 16, v121
  v_mul_u32_u24 v122, 24, v121
  v_sub_u32 v122, v120, v122
  v_cmp_gt_u32 s[36:37], 20, v122
  v_mul_u32_u24 v121, 0x2800, v121
  v_lshl_add_u32 v121, v122, 4, v121
  v_add_u32 v110, 0x2000, v121
  v_add_u32 v120, 64, v129
  v_mul_u32_u24 v121, 0xaab, v120
  v_lshrrev_b32 v121, 16, v121
  v_mul_u32_u24 v122, 24, v121
  v_sub_u32 v122, v120, v122
  v_cmp_gt_u32 s[38:39], 20, v122
  v_mul_u32_u24 v121, 0x2800, v121
  v_lshl_add_u32 v121, v122, 4, v121
  v_add_u32 v111, 0x1c00, v121
  v_add_u32 v120, 0x80, v129
  v_mul_u32_u24 v121, 0xaab, v120
  v_lshrrev_b32 v121, 16, v121
  v_mul_u32_u24 v122, 24, v121
  v_sub_u32 v122, v120, v122
  v_cmp_gt_u32 s[40:41], 20, v122
  v_mul_u32_u24 v121, 0x2800, v121
  v_lshl_add_u32 v121, v122, 4, v121
  v_add_u32 v112, 0x1800, v121
  s_mul_i32 s32, s58, 0xa000
  s_mul_i32 s57, s29, 0x140
  s_add_u32 s32, s32, s57
  s_add_u32 s32, s32, 0x500000
  s_mov_b32 s33, 0x28000
  s_branch k2_dj
k2_kw:
  v_add_u32 v120, 0, v129
  v_cmp_le_u32 vcc, 0x60, v120
  v_lshlrev_b32 v121, 4, v120
  v_add_u32 v122, 0x13a00, v121
  v_cndmask_b32 v121, v121, v122, vcc
  v_add_u32 v110, 0x2000, v121
  s_mov_b64 s[36:37], -1
  v_add_u32 v120, 64, v129
  v_cmp_le_u32 vcc, 0x60, v120
  v_lshlrev_b32 v121, 4, v120
  v_add_u32 v122, 0x13a00, v121
  v_cndmask_b32 v121, v121, v122, vcc
  v_add_u32 v111, 0x1c00, v121
  s_mov_b64 s[38:39], -1
  v_add_u32 v120, 0x80, v129
  v_cmp_le_u32 vcc, 0x60, v120
  v_lshlrev_b32 v121, 4, v120
  v_add_u32 v122, 0x13a00, v121
  v_cndmask_b32 v121, v121, v122, vcc
  v_add_u32 v112, 0x1800, v121
  s_mov_b64 s[40:41], -1
  s_mul_i32 s32, s58, 0x14000
  s_add_u32 s57, s62, 0x50
  s_lshl_b32 s57, s57, 9
  s_add_u32 s32, s32, s57
  s_mov_b32 s33, 0x50000
k2_dj:
  s_waitcnt lgkmcnt(0)
  s_sub_u32 s24, s22, 0x2000
  s_subb_u32 s25, s23, 0
  s_mov_b32 s26, 0x10002000
  s_mov_b32 s27, 0x20000
  s_mov_b32 s44, 0
  s_mov_b32 s43, 0
  s_add_u32 m0, s34, s44
  s_mov_b64 exec, s[36:37]
  buffer_load_dwordx4 v110, s[24:27], s32 offen offset:0 lds
  s_mov_b64 exec, s[38:39]
  buffer_load_dwordx4 v111, s[24:27], s32 offen offset:1024 lds
  s_mov_b64 exec, s[40:41]
  buffer_load_dwordx4 v112, s[24:27], s32 offen offset:2048 lds
  s_mov_b64 exec, -1
  s_add_u32 s32, s32, s33
  s_add_u32 s44, s44, 0x6000
  s_cmp_ge_u32 s44, 0x18000
  s_cselect_b32 s44, 0, s44
  s_add_u32 s57, s62, s63
  s_lshl_b32 s57, s57, 9
  s_lshl_b32 s58, s63, 1
  s_sub_u32 s58, 2, s58
  s_lshl_b32 s58, s58, 9
  s_lshl_b32 s59, s63, 3
  s_add_u32 s58, s58, s59
  s_lshl_b32 s59, s62, 9
  s_add_u32 s59, s59, s58
  v_and_b32 v123, 0x1ff, v128
k2_known:
  s_and_b32 s52, s2, 56
  s_add_u32 s31, s31, s52
  s_xor_b32 s52, s31, 1
  s_mul_i32 s52, s52, 0x14000
  s_add_u32 s52, s52, 0x2000
  s_add_u32 s53, s52, s57
  s_add_u32 s54, s52, s59
  buffer_load_dwordx4 v[92:95], v128, s[24:27], s53 offen
  buffer_load_dwordx2 v[100:101], v123, s[24:27], s54 offen
  s_xor_b32 s52, s31, 0
  s_mul_i32 s52, s52, 0x14000
  s_add_u32 s52, s52, 0x2000
  s_add_u32 s53, s52, s57
  s_add_u32 s54, s52, s59
  buffer_load_dwordx4 v[96:99], v128, s[24:27], s53 offen
  buffer_load_dwordx2 v[102:103], v123, s[24:27], s54 offen
  s_mul_i32 s55, s35, 0x1800
  s_lshl_b32 s56, s63, 9
  s_add_u32 s56, s56, s55
  v_add_u32 v107, s56, v128
  v_add_u32 v120, s58, v123
  v_mov_b32 v121, 0x3140
  v_cndmask_b32 v120, v120, v121, s[50:51]
  v_add_u32 v108, s55, v120
  v_and_b32 v120, 31, v129
  v_and_b32 v121, 3, v120
  v_bfe_u32 v122, v120, 2, 1
  v_lshl_add_u32 v121, v122, 3, v121
  v_bfe_u32 v122, v120, 3, 1
  v_lshl_add_u32 v121, v122, 2, v121
  v_cmp_gt_u32 vcc, 16, v120
  v_min_u32 v120, 23, v120
  s_nop 0
  v_cndmask_b32 v121, v120, v121, vcc
  v_lshrrev_b32 v122, 5, v129
  v_mul_u32_u24 v122, 0x180, v122
  v_lshl_add_u32 v121, v121, 4, v122
  s_add_u32 s55, s55, 0x3000
  v_add_u32 v109, s55, v121
  v_mov_b32 v104, v107
  v_mov_b32 v105, v108
  v_mov_b32 v106, v109
  v_lshrrev_b32 v120, 7, v0
  v_mul_u32_u24 v120, 0x6000, v120
  v_bfe_u32 v121, v0, 2, 5
  v_mul_u32_u24 v121, 0x180, v121
  v_add_u32 v120, v120, v121
  v_and_b32 v121, 3, v0
  v_lshl_add_u32 v120, v121, 4, v120
  v_add_u32 v120, 0x3140, v120
  v_cmp_eq_u32 vcc, 0, v121
  v_mov_b32 v122, 0x3f803f80
  s_nop 0
  v_cndmask_b32 v64, 0, v122, vcc
  v_mov_b32 v65, v64
  v_mov_b32 v66, v64
  v_mov_b32 v67, v64
  v_mov_b32 v117, 0x18000
  v_mov_b32 v119, 1
  v_mov_b32 v88, 0
  s_cmp_ge_u32 s28, 8
  s_cbranch_scc1 k2_noones
  ds_write_b128 v120, v[64:67]
k2_noones:
  v_lshrrev_b32 v121, 2, v128
  v_add_u32 v121, 0x18000, v121
  ds_write_b32 v121, v88
  s_mul_i32 s52, s28, 0xc00
  s_add_u32 s52, s52, 0xc000
  v_add_u32 v130, s52, v128
  s_xor_b32 s52, s28, 4
  s_mul_i32 s52, s52, 0xc00
  s_add_u32 s52, s52, 0xc000
  v_add_u32 v131, s52, v128
  s_lshl_b32 s52, s28, 8
  s_add_u32 s52, s52, 0x100
  v_add_u32 v132, s52, v121
  s_xor_b32 s52, s28, 4
  s_lshl_b32 s52, s52, 8
  s_add_u32 s52, s52, 0x100
  v_add_u32 v133, s52, v121
  v_mov_b32 v134, -1
  ds_write_b32 v132, v134
  v_mov_b32 v135, 0x207
  s_mov_b32 s68, 0x6e000000
  v_mov_b32 v89, 0
  v_mov_b32 v90, 0
  v_mov_b32 v91, 0
  v_mov_b32 v68, 0
  v_mov_b32 v69, 0
  v_mfma_f32_32x32x16_bf16 v[32:47], v[88:91], v[88:91], 0
  v_mfma_f32_32x32x16_bf16 v[48:63], v[88:91], v[88:91], 0
  s_mov_b32 s45, 8
  s_mov_b32 s42, 0
  s_mul_i32 s52, s31, 0xa000
  s_add_u32 s52, s52, 0x1002000
  s_lshl_b32 s66, s29, 10
  s_add_u32 s66, s66, s52
  s_lshr_b32 s67, s29, 1
  s_lshl_b32 s67, s67, 9
  s_lshl_b32 s54, s63, 3
  s_add_u32 s67, s67, s54
  s_add_u32 s67, s67, s52
  s_add_u32 s67, s67, 0x8000
  v_mov_b32 v134, 0x7f800000
  s_add_u32 m0, s34, s44
  s_mov_b64 exec, s[36:37]
  buffer_load_dwordx4 v110, s[24:27], s32 offen offset:0 lds
  s_mov_b64 exec, s[38:39]
  buffer_load_dwordx4 v111, s[24:27], s32 offen offset:1024 lds
  s_mov_b64 exec, s[40:41]
  buffer_load_dwordx4 v112, s[24:27], s32 offen offset:2048 lds
  s_mov_b64 exec, -1
  s_add_u32 s32, s32, s33
  s_add_u32 s44, s44, 0x6000
  s_cmp_ge_u32 s44, 0x18000
  s_cselect_b32 s44, 0, s44
  s_waitcnt vmcnt(3) lgkmcnt(0)
  v_cndmask_b32 v100, v100, 0, s[50:51]
  v_cndmask_b32 v101, v101, 0, s[50:51]
  v_cndmask_b32 v102, v102, 0, s[50:51]
  v_cndmask_b32 v103, v103, 0, s[50:51]
  s_barrier
  ds_read_b128 v[72:75], v104 offset:0
  ds_read_b64 v[76:77], v105 offset:0
  ds_read_b128 v[80:83], v106 offset:0
  s_waitcnt lgkmcnt(2)
  v_mfma_f32_32x32x16_bf16 v[0:15], v[72:75], v[92:95], 0
  s_waitcnt lgkmcnt(1)
  v_mfma_f32_32x32x8_bf16 v[0:15], v[76:77], v[100:101], v[0:15]
  v_mfma_f32_32x32x16_bf16 v[16:31], v[72:75], v[96:99], 0
  v_mfma_f32_32x32x8_bf16 v[16:31], v[76:77], v[102:103], v[16:31]
  s_add_u32 m0, s34, s44
  s_mov_b64 exec, s[36:37]
  buffer_load_dwordx4 v110, s[24:27], s32 offen offset:0 lds
  s_mov_b64 exec, s[38:39]
  buffer_load_dwordx4 v111, s[24:27], s32 offen offset:1024 lds
  s_mov_b64 exec, s[40:41]
  buffer_load_dwordx4 v112, s[24:27], s32 offen offset:2048 lds
  s_mov_b64 exec, -1
  s_add_u32 s32, s32, s33
  s_add_u32 s44, s44, 0x6000
  s_cmp_ge_u32 s44, 0x18000
  s_cselect_b32 s44, 0, s44
  v_max3_f32 v120, v0, v1, v2
  v_max3_f32 v121, v3, v4, v5
  v_max3_f32 v120, v120, v6, v7
  v_max3_f32 v121, v121, v8, v9
  v_max3_f32 v120, v120, v10, v11
  v_max3_f32 v121, v121, v12, v13
  v_max3_f32 v120, v120, v14, v15
  v_max_f32 v120, v120, v121
  v_mov_b32 v121, v120
  v_max3_f32 v122, v16, v17, v18
  v_max3_f32 v123, v19, v20, v21
  v_permlane32_swap_b32 v120, v121
  v_max_f32 v120, v120, v121
  v_add_f32 v120, 0x42a00000, v120
  v_rndne_f32 v120, -v120
  v_and_b32 v113, 0xffff0000, v120
  v_lshrrev_b32 v127, 16, v113
  v_cndmask_b32 v100, v100, v127, s[50:51]
  v_max3_f32 v122, v122, v22, v23
  v_max3_f32 v123, v123, v24, v25
  v_max3_f32 v122, v122, v26, v27
  v_max3_f32 v123, v123, v28, v29
  v_max3_f32 v122, v122, v30, v31
  v_max_f32 v122, v122, v123
  v_mov_b32 v123, v122
  v_mfma_f32_32x32x16_bf16 v[0:15], v[72:75], v[92:95], 0
  v_mov_b32 v28, 0
  v_mov_b32 v29, 0
  v_permlane32_swap_b32 v122, v123
  v_max_f32 v122, v122, v123
  v_add_f32 v122, 0x42a00000, v122
  v_mfma_f32_32x32x8_bf16 v[0:15], v[76:77], v[100:101], v[0:15]
  v_rndne_f32 v122, -v122
  v_and_b32 v114, 0xffff0000, v122
  v_lshrrev_b32 v127, 16, v114
  v_cndmask_b32 v102, v102, v127, s[50:51]
  v_mov_b32 v30, 0
  v_mov_b32 v31, 0
  s_nop 9
k2_loop:
  s_setprio 2
  v_cvt_pk_bf16_f32 v70, v28, v29
  v_cvt_pk_bf16_f32 v71, v30, v31
  v_exp_f32 v0, v0
  v_exp_f32 v1, v1
  v_exp_f32 v2, v2
  v_exp_f32 v3, v3
  v_mfma_f32_32x32x16_bf16 v[16:31], v[72:75], v[96:99], 0
  v_cvt_pk_bf16_f32 v64, v0, v1
  v_cvt_pk_bf16_f32 v65, v2, v3
  v_exp_f32 v4, v4
  v_exp_f32 v5, v5
  v_exp_f32 v6, v6
  v_exp_f32 v7, v7
  v_mfma_f32_32x32x8_bf16 v[16:31], v[76:77], v[102:103], v[16:31]
  v_cvt_pk_bf16_f32 v66, v4, v5
  v_cvt_pk_bf16_f32 v67, v6, v7
  v_exp_f32 v8, v8
  v_exp_f32 v9, v9
  v_exp_f32 v10, v10
  v_exp_f32 v11, v11
  v_mfma_f32_32x32x16_bf16 v[48:63], v[88:91], v[68:71], v[48:63]
  ds_read_b128 v[72:75], v104 offset:1536
  ds_read_b64 v[76:77], v105 offset:1536
  ds_read_b128 v[88:91], v106 offset:768
  ds_read_b128 v[84:87], v106 offset:1536
  v_cvt_pk_bf16_f32 v68, v8, v9
  v_cvt_pk_bf16_f32 v69, v10, v11
  v_exp_f32 v12, v12
  v_exp_f32 v13, v13
  v_exp_f32 v14, v14
  v_exp_f32 v15, v15
  s_waitcnt lgkmcnt(4)
  v_mfma_f32_32x32x16_bf16 v[32:47], v[80:83], v[64:67], v[32:47]
  v_cvt_pk_bf16_f32 v70, v12, v13
  v_cvt_pk_bf16_f32 v71, v14, v15
  v_exp_f32 v16, v16
  v_exp_f32 v17, v17
  v_exp_f32 v18, v18
  v_exp_f32 v19, v19
  s_waitcnt lgkmcnt(0)
  v_mfma_f32_32x32x16_bf16 v[0:15], v[72:75], v[92:95], 0
  v_cvt_pk_bf16_f32 v64, v16, v17
  v_cvt_pk_bf16_f32 v65, v18, v19
  v_exp_f32 v20, v20
  v_exp_f32 v21, v21
  v_exp_f32 v22, v22
  v_exp_f32 v23, v23
  v_mfma_f32_32x32x8_bf16 v[0:15], v[76:77], v[100:101], v[0:15]
  v_cvt_pk_bf16_f32 v66, v20, v21
  v_cvt_pk_bf16_f32 v67, v22, v23
  v_exp_f32 v24, v24
  v_exp_f32 v25, v25
  v_exp_f32 v26, v26
  v_exp_f32 v27, v27
  v_mfma_f32_32x32x16_bf16 v[32:47], v[88:91], v[68:71], v[32:47]
  v_cvt_pk_bf16_f32 v68, v24, v25
  v_cvt_pk_bf16_f32 v69, v26, v27
  v_exp_f32 v28, v28
  v_exp_f32 v29, v29
  v_exp_f32 v30, v30
  v_exp_f32 v31, v31
  v_mfma_f32_32x32x16_bf16 v[48:63], v[80:83], v[64:67], v[48:63]
  s_setprio 1
  v_cvt_pk_bf16_f32 v70, v28, v29
  v_cvt_pk_bf16_f32 v71, v30, v31
  v_exp_f32 v0, v0
  v_exp_f32 v1, v1
  v_exp_f32 v2, v2
  v_exp_f32 v3, v3
  v_mfma_f32_32x32x16_bf16 v[16:31], v[72:75], v[96:99], 0
  v_cvt_pk_bf16_f32 v64, v0, v1
  v_cvt_pk_bf16_f32 v65, v2, v3
  v_exp_f32 v4, v4
  v_exp_f32 v5, v5
  v_exp_f32 v6, v6
  v_exp_f32 v7, v7
  v_mfma_f32_32x32x8_bf16 v[16:31], v[76:77], v[102:103], v[16:31]
  v_cvt_pk_bf16_f32 v66, v4, v5
  v_cvt_pk_bf16_f32 v67, v6, v7
  v_exp_f32 v8, v8
  v_exp_f32 v9, v9
  v_exp_f32 v10, v10
  v_exp_f32 v11, v11
  v_mfma_f32_32x32x16_bf16 v[48:63], v[88:91], v[68:71], v[48:63]
  ds_read_b128 v[72:75], v104 offset:3072
  ds_read_b64 v[76:77], v105 offset:3072
  ds_read_b128 v[88:91], v106 offset:2304
  ds_read_b128 v[80:83], v106 offset:3072
  s_waitcnt vmcnt(3)
  s_cmp_lt_u32 s42, 6
  s_cbranch_scc1 k2_nodrain
  s_waitcnt vmcnt(0)
k2_nodrain:
  s_mov_b64 exec, 1
  ds_add_u32 v117, v119
  s_mov_b64 exec, -1
  v_cvt_pk_bf16_f32 v68, v8, v9
  v_cvt_pk_bf16_f32 v69, v10, v11
  v_exp_f32 v12, v12
  v_exp_f32 v13, v13
  v_exp_f32 v14, v14
  v_exp_f32 v15, v15
  v_mfma_f32_32x32x16_bf16 v[32:47], v[84:87], v[64:67], v[32:47]
  v_cvt_pk_bf16_f32 v70, v12, v13
  v_cvt_pk_bf16_f32 v71, v14, v15
  v_exp_f32 v16, v16
  v_exp_f32 v17, v17
  v_exp_f32 v18, v18
  v_exp_f32 v19, v19
  s_waitcnt lgkmcnt(0)
  v_mfma_f32_32x32x16_bf16 v[0:15], v[72:75], v[92:95], 0
  v_cvt_pk_bf16_f32 v64, v16, v17
  v_cvt_pk_bf16_f32 v65, v18, v19
  v_exp_f32 v20, v20
  v_exp_f32 v21, v21
  v_exp_f32 v22, v22
  v_exp_f32 v23, v23
  v_mfma_f32_32x32x8_bf16 v[0:15], v[76:77], v[100:101], v[0:15]
  v_cvt_pk_bf16_f32 v66, v20, v21
  v_cvt_pk_bf16_f32 v67, v22, v23
  v_exp_f32 v24, v24
  v_exp_f32 v25, v25
  v_exp_f32 v26, v26
  v_exp_f32 v27, v27
  v_mfma_f32_32x32x16_bf16 v[32:47], v[88:91], v[68:71], v[32:47]
  v_cvt_pk_bf16_f32 v68, v24, v25
  v_cvt_pk_bf16_f32 v69, v26, v27
  v_exp_f32 v28, v28
  v_exp_f32 v29, v29
  v_exp_f32 v30, v30
  v_exp_f32 v31, v31
  v_mfma_f32_32x32x16_bf16 v[48:63], v[84:87], v[64:67], v[48:63]
  s_setprio 0
  v_cvt_pk_bf16_f32 v70, v28, v29
  v_cvt_pk_bf16_f32 v71, v30, v31
  v_exp_f32 v0, v0
  v_exp_f32 v1, v1
  v_exp_f32 v2, v2
  v_exp_f32 v3, v3
  v_mfma_f32_32x32x16_bf16 v[16:31], v[72:75], v[96:99], 0
  v_cvt_pk_bf16_f32 v64, v0, v1
  v_cvt_pk_bf16_f32 v65, v2, v3
  v_exp_f32 v4, v4
  v_exp_f32 v5, v5
  v_exp_f32 v6, v6
  v_exp_f32 v7, v7
  v_mfma_f32_32x32x8_bf16 v[16:31], v[76:77], v[102:103], v[16:31]
  v_cvt_pk_bf16_f32 v66, v4, v5
  v_cvt_pk_bf16_f32 v67, v6, v7
  v_exp_f32 v8, v8
  v_exp_f32 v9, v9
  v_exp_f32 v10, v10
  v_exp_f32 v11, v11
  v_mfma_f32_32x32x16_bf16 v[48:63], v[88:91], v[68:71], v[48:63]
  ds_read_b128 v[72:75], v104 offset:4608
  ds_read_b64 v[76:77], v105 offset:4608
  ds_read_b128 v[88:91], v106 offset:3840
  ds_read_b128 v[84:87], v106 offset:4608
  ds_read_b32 v118, v117
  v_cvt_pk_bf16_f32 v68, v8, v9
  v_cvt_pk_bf16_f32 v69, v10, v11
  v_exp_f32 v12, v12
  v_exp_f32 v13, v13
  v_exp_f32 v14, v14
  v_exp_f32 v15, v15
  v_mfma_f32_32x32x16_bf16 v[32:47], v[80:83], v[64:67], v[32:47]
  v_cvt_pk_bf16_f32 v70, v12, v13
  v_cvt_pk_bf16_f32 v71, v14, v15
  v_exp_f32 v16, v16
  v_exp_f32 v17, v17
  v_exp_f32 v18, v18
  v_exp_f32 v19, v19
  s_bitcmp1_b32 s61, s42
  s_cbranch_scc0 k2_skip1
  s_nop 4
  v_mov_b32 v120, v40
  v_mov_b32 v121, v40
  v_mov_b32 v124, v113
  s_nop 0
  v_permlane32_swap_b32 v120, v121
  v_subrev_u32 v123, 0xd800000, v121
  v_log_f32 v122, v121
  v_cmp_lt_u32 vcc, 0x6e000000, v123
  s_nop 0
  s_or_b64 s[46:47], s[46:47], vcc
  v_sub_f32 v123, v113, v122
  v_add_f32 v123, 0xc2a00000, v123
  v_rndne_f32 v123, v123
  v_and_b32 v113, 0xffff0000, v123
  v_lshrrev_b32 v127, 16, v113
  v_cndmask_b32 v100, v100, v127, s[50:51]
  v_sub_f32 v124, v113, v124
  v_cvt_i32_f32 v115, v124
  s_nop 1
k2_skip1:
  s_waitcnt lgkmcnt(0)
  v_mfma_f32_32x32x16_bf16 v[0:15], v[72:75], v[92:95], 0
  v_cvt_pk_bf16_f32 v64, v16, v17
  v_cvt_pk_bf16_f32 v65, v18, v19
  v_exp_f32 v20, v20
  v_exp_f32 v21, v21
  v_readfirstlane_b32 s52, v118
  v_exp_f32 v22, v22
  v_exp_f32 v23, v23
  v_mfma_f32_32x32x8_bf16 v[0:15], v[76:77], v[100:101], v[0:15]
  v_cvt_pk_bf16_f32 v66, v20, v21
  v_cvt_pk_bf16_f32 v67, v22, v23
  v_exp_f32 v24, v24
  v_exp_f32 v25, v25
  v_exp_f32 v26, v26
  v_exp_f32 v27, v27
  v_mfma_f32_32x32x16_bf16 v[32:47], v[88:91], v[68:71], v[32:47]
  v_cvt_pk_bf16_f32 v68, v24, v25
  v_cvt_pk_bf16_f32 v69, v26, v27
  v_exp_f32 v28, v28
  v_exp_f32 v29, v29
  v_exp_f32 v30, v30
  v_exp_f32 v31, v31
  v_mfma_f32_32x32x16_bf16 v[48:63], v[80:83], v[64:67], v[48:63]
  s_setprio 3
  v_cvt_pk_bf16_f32 v70, v28, v29
  v_cvt_pk_bf16_f32 v71, v30, v31
  v_exp_f32 v0, v0
  v_exp_f32 v1, v1
  v_exp_f32 v2, v2
  v_exp_f32 v3, v3
  s_bitcmp1_b32 s61, s42
  s_cbranch_scc0 k2_skip2
  s_nop 3
  v_ldexp_f32 v32, v32, v115
  v_ldexp_f32 v33, v33, v115
  v_ldexp_f32 v34, v34, v115
  v_ldexp_f32 v35, v35, v115
  v_ldexp_f32 v36, v36, v115
  v_ldexp_f32 v37, v37, v115
  v_ldexp_f32 v38, v38, v115
  v_ldexp_f32 v39, v39, v115
  v_ldexp_f32 v40, v40, v115
  v_ldexp_f32 v41, v41, v115
  v_ldexp_f32 v42, v42, v115
  v_ldexp_f32 v43, v43, v115
  s_nop 1
k2_skip2:
  s_bitcmp1_b32 s61, s42
  s_cbranch_scc0 k2_skip3
  s_nop 4
  v_mov_b32 v120, v56
  v_mov_b32 v121, v56
  v_mov_b32 v124, v114
  s_nop 0
  v_permlane32_swap_b32 v120, v121
  v_subrev_u32 v123, 0xd800000, v121
  v_log_f32 v122, v121
  v_cmp_lt_u32 vcc, 0x6e000000, v123
  s_nop 0
  s_or_b64 s[48:49], s[48:49], vcc
  v_sub_f32 v123, v114, v122
  v_add_f32 v123, 0xc2a00000, v123
  v_rndne_f32 v123, v123
  v_and_b32 v114, 0xffff0000, v123
  v_lshrrev_b32 v127, 16, v114
  v_cndmask_b32 v102, v102, v127, s[50:51]
  v_sub_f32 v124, v114, v124
  v_cvt_i32_f32 v116, v124
  s_nop 1
k2_skip3:
  v_mfma_f32_32x32x16_bf16 v[16:31], v[72:75], v[96:99], 0
  v_cvt_pk_bf16_f32 v64, v0, v1
  v_cvt_pk_bf16_f32 v65, v2, v3
  v_exp_f32 v4, v4
  v_exp_f32 v5, v5
  v_exp_f32 v6, v6
  v_exp_f32 v7, v7
  v_mfma_f32_32x32x8_bf16 v[16:31], v[76:77], v[102:103], v[16:31]
  s_cmp_lt_u32 s52, s45
  s_cbranch_scc1 k2_spin
k2_spin_done:
  s_add_u32 s43, s43, 0x6000
  s_cmp_ge_u32 s43, 0x18000
  s_cselect_b32 s43, 0, s43
  s_add_u32 s45, s45, 8
  v_add_u32 v104, s43, v107
  v_add_u32 v105, s43, v108
  v_cvt_pk_bf16_f32 v66, v4, v5
  v_cvt_pk_bf16_f32 v67, v6, v7
  v_exp_f32 v8, v8
  v_exp_f32 v9, v9
  v_exp_f32 v10, v10
  v_exp_f32 v11, v11
  v_mfma_f32_32x32x16_bf16 v[48:63], v[88:91], v[68:71], v[48:63]
  ds_read_b128 v[72:75], v104 offset:0
  ds_read_b64 v[76:77], v105 offset:0
  ds_read_b128 v[88:91], v106 offset:5376
  v_add_u32 v106, s43, v109
  ds_read_b128 v[80:83], v106 offset:0
  s_add_u32 m0, s34, s44
  s_cmp_lt_u32 s42, 5
  s_cbranch_scc0 k2_wold
  s_mov_b64 exec, s[36:37]
  buffer_load_dwordx4 v110, s[24:27], s32 offen offset:0 lds
  s_mov_b64 exec, s[38:39]
  buffer_load_dwordx4 v111, s[24:27], s32 offen offset:1024 lds
  s_mov_b64 exec, s[40:41]
  buffer_load_dwordx4 v112, s[24:27], s32 offen offset:2048 lds
  s_mov_b64 exec, -1
  s_add_u32 s32, s32, s33
  s_add_u32 s44, s44, 0x6000
  s_cmp_ge_u32 s44, 0x18000
  s_cselect_b32 s44, 0, s44
k2_nodma:
  v_cvt_pk_bf16_f32 v68, v8, v9
  v_cvt_pk_bf16_f32 v69, v10, v11
  v_exp_f32 v12, v12
  v_exp_f32 v13, v13
  v_exp_f32 v14, v14
  v_exp_f32 v15, v15
  v_mfma_f32_32x32x16_bf16 v[32:47], v[84:87], v[64:67], v[32:47]
  v_cvt_pk_bf16_f32 v70, v12, v13
  v_cvt_pk_bf16_f32 v71, v14, v15
  v_exp_f32 v16, v16
  v_exp_f32 v17, v17
  v_exp_f32 v18, v18
  v_exp_f32 v19, v19
  s_bitcmp1_b32 s61, s42
  s_cbranch_scc0 k2_skip4
  s_nop 3
  v_ldexp_f32 v48, v48, v116
  v_ldexp_f32 v49, v49, v116
  v_ldexp_f32 v50, v50, v116
  v_ldexp_f32 v51, v51, v116
  v_ldexp_f32 v52, v52, v116
  v_ldexp_f32 v53, v53, v116
  v_ldexp_f32 v54, v54, v116
  v_ldexp_f32 v55, v55, v116
  v_ldexp_f32 v56, v56, v116
  v_ldexp_f32 v57, v57, v116
  v_ldexp_f32 v58, v58, v116
  v_ldexp_f32 v59, v59, v116
  s_nop 1
k2_skip4:
  s_waitcnt lgkmcnt(0)
  v_mfma_f32_32x32x16_bf16 v[0:15], v[72:75], v[92:95], 0
  v_cvt_pk_bf16_f32 v64, v16, v17
  v_cvt_pk_bf16_f32 v65, v18, v19
  v_exp_f32 v20, v20
  v_exp_f32 v21, v21
  v_exp_f32 v22, v22
  v_exp_f32 v23, v23
  v_mfma_f32_32x32x8_bf16 v[0:15], v[76:77], v[100:101], v[0:15]
  v_cvt_pk_bf16_f32 v66, v20, v21
  v_cvt_pk_bf16_f32 v67, v22, v23
  v_exp_f32 v24, v24
  v_exp_f32 v25, v25
  v_exp_f32 v26, v26
  v_exp_f32 v27, v27
  v_mfma_f32_32x32x16_bf16 v[32:47], v[88:91], v[68:71], v[32:47]
  v_cvt_pk_bf16_f32 v68, v24, v25
  v_cvt_pk_bf16_f32 v69, v26, v27
  v_exp_f32 v28, v28
  v_exp_f32 v29, v29
  v_exp_f32 v30, v30
  v_exp_f32 v31, v31
  v_mfma_f32_32x32x16_bf16 v[48:63], v[84:87], v[64:67], v[48:63]
  s_add_u32 s42, s42, 1
  s_cmp_lt_u32 s42, 8
  s_cbranch_scc1 k2_loop
k2_end:
  s_nop 1
  v_cndmask_b32 v40, v40, v134, s[46:47]
  v_cvt_pk_bf16_f32 v70, v28, v29
  v_cvt_pk_bf16_f32 v71, v30, v31
  ds_write_b128 v130, v[32:35] offset:0
  ds_write_b128 v130, v[36:39] offset:1024
  ds_write_b128 v130, v[40:43] offset:2048
  ds_write_b32 v132, v113
  v_mfma_f32_32x32x16_bf16 v[48:63], v[88:91], v[68:71], v[48:63]
  s_mov_b32 s60, 0x100000
k2_xw:
  ds_read_b32 v124, v133
  ds_read_b128 v[8:11], v131 offset:2048
  ds_read_b128 v[0:3], v131 offset:0
  ds_read_b128 v[4:7], v131 offset:1024
  s_sub_u32 s60, s60, 1
  s_cbranch_scc1 k2_xd
  s_waitcnt lgkmcnt(3)
  v_cmp_eq_u32 vcc, -1, v124
  s_nop 0
  s_cmp_lg_u64 vcc, 0
  s_cbranch_scc1 k2_xw
k2_xd:
  v_min_f32 v125, v114, v124
  v_sub_f32 v126, v125, v114
  v_sub_f32 v127, v125, v124
  v_cvt_i32_f32 v126, v126
  v_cvt_i32_f32 v127, v127
  v_ldexp_f32 v120, v56, v126
  s_waitcnt lgkmcnt(2)
  v_ldexp_f32 v121, v8, v127
  v_add_f32 v120, v120, v121
  v_mov_b32 v121, v120
  s_nop 1
  v_permlane32_swap_b32 v120, v121
  v_rcp_f32 v120, v121
  v_subrev_u32 v122, 0xd800000, v121
  v_cmp_lt_u32 s[54:55], s68, v122
  v_ldexp_f32 v136, v120, v126
  v_ldexp_f32 v137, v120, v127
  v_pk_mul_f32 v[48:49], v[48:49], v[136:137] op_sel_hi:[1,0]
  v_pk_mul_f32 v[50:51], v[50:51], v[136:137] op_sel_hi:[1,0]
  v_pk_mul_f32 v[52:53], v[52:53], v[136:137] op_sel_hi:[1,0]
  v_pk_mul_f32 v[54:55], v[54:55], v[136:137] op_sel_hi:[1,0]
  v_pk_mul_f32 v[56:57], v[56:57], v[136:137] op_sel_hi:[1,0]
  v_pk_mul_f32 v[58:59], v[58:59], v[136:137] op_sel_hi:[1,0]
  s_waitcnt lgkmcnt(0)
  s_mov_b64 exec, 1
  ds_add_u32 v117, v119 offset:4
  s_mov_b64 exec, -1
  v_pk_fma_f32 v[48:49], v[0:1], v[136:137], v[48:49] op_sel:[0,1,0] op_sel_hi:[1,1,1]
  v_pk_fma_f32 v[50:51], v[2:3], v[136:137], v[50:51] op_sel:[0,1,0] op_sel_hi:[1,1,1]
  v_pk_fma_f32 v[52:53], v[4:5], v[136:137], v[52:53] op_sel:[0,1,0] op_sel_hi:[1,1,1]
  v_pk_fma_f32 v[54:55], v[6:7], v[136:137], v[54:55] op_sel:[0,1,0] op_sel_hi:[1,1,1]
  v_pk_fma_f32 v[56:57], v[8:9], v[136:137], v[56:57] op_sel:[0,1,0] op_sel_hi:[1,1,1]
  v_pk_fma_f32 v[58:59], v[10:11], v[136:137], v[58:59] op_sel:[0,1,0] op_sel_hi:[1,1,1]
  s_or_b64 s[54:55], s[54:55], s[48:49]
  v_pk_add_f32 v[0:1], v[48:49], v[50:51]
  v_pk_add_f32 v[2:3], v[52:53], v[54:55]
  v_pk_add_f32 v[4:5], v[56:57], v[58:59]
  v_cvt_pk_bf16_f32 v48, v48, v49
  v_cvt_pk_bf16_f32 v49, v50, v51
  v_pk_add_f32 v[0:1], v[0:1], v[2:3]
  v_cvt_pk_bf16_f32 v50, v52, v53
  v_cvt_pk_bf16_f32 v51, v54, v55
  v_pk_add_f32 v[0:1], v[0:1], v[4:5]
  v_cvt_pk_bf16_f32 v52, v56, v57
  v_cvt_pk_bf16_f32 v53, v58, v59
  v_add_f32 v0, v0, v1
  v_cmp_class_f32 vcc, v0, v135
  s_nop 0
  s_or_b64 s[54:55], s[54:55], vcc
  s_cbranch_scc1 k2_slow
k2_store:
  buffer_store_dwordx4 v[48:51], v128, s[24:27], s66 offen sc1
  s_not_b64 exec, s[50:51]
  buffer_store_dwordx2 v[52:53], v128, s[24:27], s67 offen sc1
  s_mov_b64 exec, -1
  s_mov_b32 s60, 0x100000
k2_aw:
  ds_read_b32 v120, v117 offset:4
  s_waitcnt lgkmcnt(0)
  v_readfirstlane_b32 s52, v120
  s_sub_u32 s60, s60, 1
  s_cbranch_scc1 k2_awd
  s_cmp_lt_u32 s52, 8
  s_cbranch_scc1 k2_aw
k2_awd:
  s_waitcnt vmcnt(2)
  ds_write_b128 v138, v[140:143] offset:0
  ds_write_b128 v138, v[144:147] offset:2048
  ds_write_b128 v138, v[148:151] offset:4096
  ds_write_b128 v138, v[152:155] offset:6144
  ds_write_b128 v138, v[156:159] offset:8192
  ds_write_b128 v138, v[160:163] offset:10240
  s_mov_b64 exec, 1
  ds_add_u32 v139, v164
  s_mov_b64 exec, -1
  s_waitcnt lgkmcnt(0)
k2_exit:
  s_endpgm
k2_spin:
  s_mov_b32 s60, 0x100000
k2_spin_l:
  ds_read_b32 v118, v117
  s_waitcnt lgkmcnt(0)
  v_readfirstlane_b32 s52, v118
  s_sub_u32 s60, s60, 1
  s_cbranch_scc1 k2_spin_done
  s_cmp_lt_u32 s52, s45
  s_cbranch_scc1 k2_spin_l
  s_branch k2_spin_done
k2_wold:
  s_cmp_lg_u32 s42, 5
  s_cbranch_scc1 k2_nodma
  s_and_b32 s53, s28, 3
  s_mul_i32 s55, s65, 0x32000
  s_add_u32 s55, s55, 0x1802000
  s_mul_i32 s54, s53, 0xa000
  s_add_u32 s54, s54, s55
  s_mul_i32 s58, s53, 0x2800
  s_add_u32 s55, s55, s58
  s_add_u32 s55, s55, 0x28000
  s_add_u32 s56, s53, 3
  s_and_b32 s56, s56, 3
  s_lshl_b32 s56, s56, 10
  s_lshl_b32 s57, s53, 10
  s_cmp_eq_u32 s35, 0
  s_cbranch_scc0 k2_aw1
  s_add_u32 s58, s54, s56
  s_add_u32 s58, s58, 0x8c00
  buffer_load_dwordx4 v[140:143], v128, s[24:27], s58 offen
  s_add_u32 s58, s55, s56
  s_add_u32 s58, s58, 0x1400
  buffer_load_dwordx4 v[144:147], v128, s[24:27], s58 offen
  s_add_u32 s58, s54, s57
  s_add_u32 s58, s58, 0x5000
  buffer_load_dwordx4 v[148:151], v128, s[24:27], s58 offen
  s_add_u32 s58, s54, s57
  s_add_u32 s58, s58, 0x6400
  buffer_load_dwordx4 v[152:155], v128, s[24:27], s58 offen
  s_add_u32 s58, s54, s57
  s_add_u32 s58, s58, 0x7800
  buffer_load_dwordx4 v[156:159], v128, s[24:27], s58 offen
  s_add_u32 s58, s54, s57
  s_add_u32 s58, s58, 0x8c00
  buffer_load_dwordx4 v[160:163], v128, s[24:27], s58 offen
  s_branch k2_aw2
k2_aw1:
  s_add_u32 s58, s55, s56
  s_add_u32 s58, s58, 0
  buffer_load_dwordx4 v[140:143], v128, s[24:27], s58 offen
  s_add_u32 s58, s54, s57
  s_add_u32 s58, s58, 0
  buffer_load_dwordx4 v[144:147], v128, s[24:27], s58 offen
  s_add_u32 s58, s54, s57
  s_add_u32 s58, s58, 0x1400
  buffer_load_dwordx4 v[148:151], v128, s[24:27], s58 offen
  s_add_u32 s58, s54, s57
  s_add_u32 s58, s58, 0x2800
  buffer_load_dwordx4 v[152:155], v128, s[24:27], s58 offen
  s_add_u32 s58, s54, s57
  s_add_u32 s58, s58, 0x3c00
  buffer_load_dwordx4 v[156:159], v128, s[24:27], s58 offen
  s_add_u32 s58, s55, s57
  s_add_u32 s58, s58, 0
  buffer_load_dwordx4 v[160:163], v128, s[24:27], s58 offen
k2_aw2:
  s_mul_i32 s58, s53, 0x3000
  s_lshl_b32 s56, s35, 10
  s_add_u32 s58, s58, s56
  s_add_u32 s58, s58, 0xc000
  v_add_u32 v138, s58, v128
  s_lshl_b32 s53, s53, 2
  s_add_u32 s53, s53, 0x18010
  v_mov_b32 v139, s53
  v_mov_b32 v164, 1
  s_branch k2_nodma
k2_gemm:
  s_barrier
  v_and_b32 v167, 63, v0
  v_lshlrev_b32 v166, 4, v167
  s_sub_u32 s44, s28, 8
  s_mov_b32 s70, s44
  s_mul_i32 s47, s44, 0x3c00
  s_add_u32 s47, s47, 0x19000
  s_mul_i32 s56, s44, 0x3000
  s_lshl_b32 s62, s44, 2
  s_add_u32 s62, s62, 4
  v_add_u32 v144, 0, v167
  v_mul_u32_u24 v145, 0xccd, v144
  v_lshrrev_b32 v145, 16, v145
  v_mul_u32_u24 v146, 20, v145
  v_sub_u32 v146, v144, v146
  v_add_u32 v147, s62, v146
  v_and_b32 v147, 15, v147
  v_cmp_gt_u32 vcc, 16, v146
  s_nop 1
  v_cndmask_b32 v146, v146, v147, vcc
  v_mul_u32_u24 v147, 0x500, v145
  v_lshl_add_u32 v160, v146, 4, v147
  v_add_u32 v144, 64, v167
  v_mul_u32_u24 v145, 0xccd, v144
  v_lshrrev_b32 v145, 16, v145
  v_mul_u32_u24 v146, 20, v145
  v_sub_u32 v146, v144, v146
  v_add_u32 v147, s62, v146
  v_and_b32 v147, 15, v147
  v_cmp_gt_u32 vcc, 16, v146
  s_nop 1
  v_cndmask_b32 v146, v146, v147, vcc
  v_mul_u32_u24 v147, 0x500, v145
  v_lshl_add_u32 v161, v146, 4, v147
  v_add_u32 v144, 0x80, v167
  v_mul_u32_u24 v145, 0xccd, v144
  v_lshrrev_b32 v145, 16, v145
  v_mul_u32_u24 v146, 20, v145
  v_sub_u32 v146, v144, v146
  v_add_u32 v147, s62, v146
  v_and_b32 v147, 15, v147
  v_cmp_gt_u32 vcc, 16, v146
  s_nop 1
  v_cndmask_b32 v146, v146, v147, vcc
  v_mul_u32_u24 v147, 0x500, v145
  v_lshl_add_u32 v162, v146, 4, v147
  v_add_u32 v144, 0xc0, v167
  v_mul_u32_u24 v145, 0xccd, v144
  v_lshrrev_b32 v145, 16, v145
  v_mul_u32_u24 v146, 20, v145
  v_sub_u32 v146, v144, v146
  v_add_u32 v147, s62, v146
  v_and_b32 v147, 15, v147
  v_cmp_gt_u32 vcc, 16, v146
  s_nop 1
  v_cndmask_b32 v146, v146, v147, vcc
  v_mul_u32_u24 v147, 0x500, v145
  v_lshl_add_u32 v163, v146, 4, v147
  v_add_u32 v144, 0x100, v167
  v_mul_u32_u24 v145, 0xccd, v144
  v_lshrrev_b32 v145, 16, v145
  v_mul_u32_u24 v146, 20, v145
  v_sub_u32 v146, v144, v146
  v_add_u32 v147, s62, v146
  v_and_b32 v147, 15, v147
  v_cmp_gt_u32 vcc, 16, v146
  s_nop 1
  v_cndmask_b32 v146, v146, v147, vcc
  v_mul_u32_u24 v147, 0x500, v145
  v_lshl_add_u32 v164, v146, 4, v147
  v_lshrrev_b32 v144, 5, v167
  v_bfe_u32 v145, v167, 2, 2
  v_lshl_add_u32 v144, v144, 3, v145
  v_mul_u32_u24 v144, 0x140, v144
  v_bfe_u32 v145, v167, 4, 1
  v_lshl_add_u32 v144, v145, 5, v144
  v_and_b32 v145, 1, v167
  v_lshl_add_u32 v144, v145, 4, v144
  v_bfe_u32 v145, v167, 1, 1
  v_lshl_add_u32 v144, v145, 3, v144
  v_add_u32 v165, s47, v144
  s_and_b32 s45, s2, 63
  s_bfe_u32 s61, s2, 0x30003
  s_lshr_b32 s46, s2, 6
  s_mul_i32 s61, s61, 27
  s_lshr_b32 s61, s61, 3
  s_mul_i32 s65, s46, 0x140
  s_mul_i32 s49, s45, 0x1b000
  s_mul_i32 s60, s44, 0x6c00
  s_add_u32 s49, s49, s60
  s_add_u32 s49, s49, 0x800000
  s_add_u32 s50, s49, 0x6c00
  s_lshl_b32 s60, s61, 10
  s_add_u32 s48, s49, s60
  s_mul_i32 s62, s46, 0x32000
  s_add_u32 s62, s62, 0x1800000
  s_mul_i32 s52, s44, 0x87000
  s_add_u32 s52, s52, s65
  s_add_u32 s53, s52, 0x87000
  s_mul_i32 s60, s61, 0x5000
  s_add_u32 s51, s52, s60
  s_mul_i32 s58, s44, 0xa000
  s_add_u32 s58, s58, s62
  s_mul_i32 s59, s44, 0x2800
  s_add_u32 s59, s59, s62
  s_add_u32 s59, s59, 0x28000
  s_add_u32 s61, s44, 1
  s_and_b32 s61, s61, 3
  s_lshl_b32 s71, s61, 10
  s_add_u32 s61, s44, 2
  s_and_b32 s61, s61, 3
  s_lshl_b32 s72, s61, 10
  s_add_u32 s61, s44, 3
  s_and_b32 s61, s61, 3
  s_lshl_b32 s73, s61, 10
  s_add_u32 s61, s44, 4
  s_and_b32 s61, s61, 3
  s_lshl_b32 s74, s61, 10
  s_mov_b32 s75, 0x1000
  s_waitcnt lgkmcnt(0)
  s_mov_b32 s24, s22
  s_mov_b32 s25, s23
  s_mov_b32 s26, 0x10000000
  s_mov_b32 s27, 0x20000
  s_mov_b32 s28, s16
  s_mov_b32 s29, s17
  s_mov_b32 s30, 0x21c000
  s_mov_b32 s31, 0x20000
  s_mov_b32 s36, s4
  s_mov_b32 s37, s5
  s_mov_b32 s38, 0x280000
  s_mov_b32 s39, 0x20000
  s_mov_b32 s8, s4
  s_mov_b32 s9, s5
  s_mov_b32 s10, 0x280000
  s_mov_b32 s11, 0x20000
  s_cmp_eq_u32 s44, 0
  s_cselect_b32 s10, s10, 0
  s_mov_b32 s40, s18
  s_mov_b32 s41, s19
  s_mov_b32 s42, 0x280000
  s_mov_b32 s43, 0x20000
  s_mul_i32 s54, s45, 0xa000
  s_add_u32 s54, s54, 0x1000000
  s_lshl_b32 s60, s44, 11
  s_add_u32 s55, s54, s60
  s_add_u32 s55, s55, 0x8000
  s_lshl_b32 s60, s44, 13
  s_add_u32 s54, s54, s60
  s_mul_i32 s57, s45, 0xa000
  s_add_u32 s57, s57, s65
  buffer_load_dwordx4 v[120:123], v166, s[24:27], s48 offen
  s_add_u32 s48, s48, 0x400
  s_cmp_eq_u32 s48, s50
  s_cselect_b32 s48, s49, s48
  s_add_u32 m0, s47, 0
  s_nop 0
  buffer_load_dwordx4 v160, s[28:31], s51 offen lds
  s_add_u32 m0, s47, 0x400
  s_nop 0
  buffer_load_dwordx4 v161, s[28:31], s51 offen lds
  s_add_u32 m0, s47, 0x800
  s_nop 0
  buffer_load_dwordx4 v162, s[28:31], s51 offen lds
  s_add_u32 m0, s47, 0xc00
  s_nop 0
  buffer_load_dwordx4 v163, s[28:31], s51 offen lds
  s_add_u32 m0, s47, 0x1000
  s_nop 0
  buffer_load_dwordx4 v164, s[28:31], s51 offen lds
  s_add_u32 s51, s51, 0x5000
  s_cmp_eq_u32 s51, s53
  s_cselect_b32 s51, s52, s51
  buffer_load_dwordx4 v[124:127], v166, s[24:27], s48 offen
  s_add_u32 s48, s48, 0x400
  s_cmp_eq_u32 s48, s50
  s_cselect_b32 s48, s49, s48
  s_add_u32 m0, s47, 0x1400
  s_nop 0
  buffer_load_dwordx4 v160, s[28:31], s51 offen lds
  s_add_u32 m0, s47, 0x1800
  s_nop 0
  buffer_load_dwordx4 v161, s[28:31], s51 offen lds
  s_add_u32 m0, s47, 0x1c00
  s_nop 0
  buffer_load_dwordx4 v162, s[28:31], s51 offen lds
  s_add_u32 m0, s47, 0x2000
  s_nop 0
  buffer_load_dwordx4 v163, s[28:31], s51 offen lds
  s_add_u32 m0, s47, 0x2400
  s_nop 0
  buffer_load_dwordx4 v164, s[28:31], s51 offen lds
  s_add_u32 s51, s51, 0x5000
  s_cmp_eq_u32 s51, s53
  s_cselect_b32 s51, s52, s51
  buffer_load_dwordx4 v[128:131], v166, s[24:27], s48 offen
  s_add_u32 s48, s48, 0x400
  s_cmp_eq_u32 s48, s50
  s_cselect_b32 s48, s49, s48
  s_add_u32 m0, s47, 0x2800
  s_nop 0
  buffer_load_dwordx4 v160, s[28:31], s51 offen lds
  s_add_u32 m0, s47, 0x2c00
  s_nop 0
  buffer_load_dwordx4 v161, s[28:31], s51 offen lds
  s_add_u32 m0, s47, 0x3000
  s_nop 0
  buffer_load_dwordx4 v162, s[28:31], s51 offen lds
  s_add_u32 m0, s47, 0x3400
  s_nop 0
  buffer_load_dwordx4 v163, s[28:31], s51 offen lds
  s_add_u32 m0, s47, 0x3800
  s_nop 0
  buffer_load_dwordx4 v164, s[28:31], s51 offen lds
  s_add_u32 s51, s51, 0x5000
  s_cmp_eq_u32 s51, s53
  s_cselect_b32 s51, s52, s51
  buffer_load_dwordx4 v[132:135], v166, s[24:27], s48 offen
  s_add_u32 s48, s48, 0x400
  s_cmp_eq_u32 s48, s50
  s_cselect_b32 s48, s49, s48
  buffer_load_dwordx4 v[136:139], v166, s[24:27], s48 offen
  s_add_u32 s48, s48, 0x400
  s_cmp_eq_u32 s48, s50
  s_cselect_b32 s48, s49, s48
  buffer_load_dwordx4 v[140:143], v166, s[24:27], s48 offen
  s_add_u32 s48, s48, 0x400
  s_cmp_eq_u32 s48, s50
  s_cselect_b32 s48, s49, s48
  s_waitcnt vmcnt(15)
  ds_read_b64_tr_b16 v[80:81], v165 offset:0
  ds_read_b64_tr_b16 v[82:83], v165 offset:1280
  ds_read_b64_tr_b16 v[84:85], v165 offset:64
  ds_read_b64_tr_b16 v[86:87], v165 offset:1344
  ds_read_b64_tr_b16 v[88:89], v165 offset:128
  ds_read_b64_tr_b16 v[90:91], v165 offset:1408
  ds_read_b64_tr_b16 v[92:93], v165 offset:192
  ds_read_b64_tr_b16 v[94:95], v165 offset:1472
  ds_read_b64_tr_b16 v[96:97], v165 offset:256
  ds_read_b64_tr_b16 v[98:99], v165 offset:1536
  s_waitcnt lgkmcnt(0)
  v_mfma_f32_32x32x16_bf16 v[0:15], v[80:83], v[120:123], 0
  s_add_u32 m0, s47, 0
  s_nop 0
  buffer_load_dwordx4 v160, s[28:31], s51 offen lds
  s_add_u32 m0, s47, 0x400
  s_nop 0
  buffer_load_dwordx4 v161, s[28:31], s51 offen lds
  s_add_u32 m0, s47, 0x800
  s_nop 0
  buffer_load_dwordx4 v162, s[28:31], s51 offen lds
  s_add_u32 m0, s47, 0xc00
  s_nop 0
  buffer_load_dwordx4 v163, s[28:31], s51 offen lds
  s_add_u32 m0, s47, 0x1000
  s_nop 0
  buffer_load_dwordx4 v164, s[28:31], s51 offen lds
  s_add_u32 s51, s51, 0x5000
  s_cmp_eq_u32 s51, s53
  s_cselect_b32 s51, s52, s51
  v_mfma_f32_32x32x16_bf16 v[16:31], v[84:87], v[120:123], 0
  s_waitcnt vmcnt(14)
  ds_read_b64_tr_b16 v[100:101], v165 offset:5120
  ds_read_b64_tr_b16 v[102:103], v165 offset:6400
  ds_read_b64_tr_b16 v[104:105], v165 offset:5184
  ds_read_b64_tr_b16 v[106:107], v165 offset:6464
  v_mfma_f32_32x32x16_bf16 v[32:47], v[88:91], v[120:123], 0
  ds_read_b64_tr_b16 v[108:109], v165 offset:5248
  ds_read_b64_tr_b16 v[110:111], v165 offset:6528
  ds_read_b64_tr_b16 v[112:113], v165 offset:5312
  v_mfma_f32_32x32x16_bf16 v[48:63], v[92:95], v[120:123], 0
  ds_read_b64_tr_b16 v[114:115], v165 offset:6592
  ds_read_b64_tr_b16 v[116:117], v165 offset:5376
  ds_read_b64_tr_b16 v[118:119], v165 offset:6656
  v_mfma_f32_32x32x16_bf16 v[64:79], v[96:99], v[120:123], 0
  buffer_load_dwordx4 v[120:123], v166, s[24:27], s48 offen
  s_add_u32 s48, s48, 0x400
  s_cmp_eq_u32 s48, s50
  s_cselect_b32 s48, s49, s48
  s_waitcnt lgkmcnt(0)
  v_mfma_f32_32x32x16_bf16 v[0:15], v[100:103], v[124:127], v[0:15]
  s_add_u32 m0, s47, 0x1400
  s_nop 0
  buffer_load_dwordx4 v160, s[28:31], s51 offen lds
  s_add_u32 m0, s47, 0x1800
  s_nop 0
  buffer_load_dwordx4 v161, s[28:31], s51 offen lds
  s_add_u32 m0, s47, 0x1c00
  s_nop 0
  buffer_load_dwordx4 v162, s[28:31], s51 offen lds
  s_add_u32 m0, s47, 0x2000
  s_nop 0
  buffer_load_dwordx4 v163, s[28:31], s51 offen lds
  s_add_u32 m0, s47, 0x2400
  s_nop 0
  buffer_load_dwordx4 v164, s[28:31], s51 offen lds
  s_add_u32 s51, s51, 0x5000
  s_cmp_eq_u32 s51, s53
  s_cselect_b32 s51, s52, s51
  v_mfma_f32_32x32x16_bf16 v[16:31], v[104:107], v[124:127], v[16:31]
  s_waitcnt vmcnt(14)
  ds_read_b64_tr_b16 v[80:81], v165 offset:10240
  ds_read_b64_tr_b16 v[82:83], v165 offset:11520
  ds_read_b64_tr_b16 v[84:85], v165 offset:10304
  ds_read_b64_tr_b16 v[86:87], v165 offset:11584
  v_mfma_f32_32x32x16_bf16 v[32:47], v[108:111], v[124:127], v[32:47]
  ds_read_b64_tr_b16 v[88:89], v165 offset:10368
  ds_read_b64_tr_b16 v[90:91], v165 offset:11648
  ds_read_b64_tr_b16 v[92:93], v165 offset:10432
  v_mfma_f32_32x32x16_bf16 v[48:63], v[112:115], v[124:127], v[48:63]
  ds_read_b64_tr_b16 v[94:95], v165 offset:11712
  ds_read_b64_tr_b16 v[96:97], v165 offset:10496
  ds_read_b64_tr_b16 v[98:99], v165 offset:11776
  v_mfma_f32_32x32x16_bf16 v[64:79], v[116:119], v[124:127], v[64:79]
  buffer_load_dwordx4 v[124:127], v166, s[24:27], s48 offen
  s_add_u32 s48, s48, 0x400
  s_cmp_eq_u32 s48, s50
  s_cselect_b32 s48, s49, s48
  s_waitcnt lgkmcnt(0)
  v_mfma_f32_32x32x16_bf16 v[0:15], v[80:83], v[128:131], v[0:15]
  s_add_u32 m0, s47, 0x2800
  s_nop 0
  buffer_load_dwordx4 v160, s[28:31], s51 offen lds
  s_add_u32 m0, s47, 0x2c00
  s_nop 0
  buffer_load_dwordx4 v161, s[28:31], s51 offen lds
  s_add_u32 m0, s47, 0x3000
  s_nop 0
  buffer_load_dwordx4 v162, s[28:31], s51 offen lds
  s_add_u32 m0, s47, 0x3400
  s_nop 0
  buffer_load_dwordx4 v163, s[28:31], s51 offen lds
  s_add_u32 m0, s47, 0x3800
  s_nop 0
  buffer_load_dwordx4 v164, s[28:31], s51 offen lds
  s_add_u32 s51, s51, 0x5000
  s_cmp_eq_u32 s51, s53
  s_cselect_b32 s51, s52, s51
  v_mfma_f32_32x32x16_bf16 v[16:31], v[84:87], v[128:131], v[16:31]
  s_waitcnt vmcnt(12)
  ds_read_b64_tr_b16 v[100:101], v165 offset:0
  ds_read_b64_tr_b16 v[102:103], v165 offset:1280
  ds_read_b64_tr_b16 v[104:105], v165 offset:64
  ds_read_b64_tr_b16 v[106:107], v165 offset:1344
  v_mfma_f32_32x32x16_bf16 v[32:47], v[88:91], v[128:131], v[32:47]
  ds_read_b64_tr_b16 v[108:109], v165 offset:128
  ds_read_b64_tr_b16 v[110:111], v165 offset:1408
  ds_read_b64_tr_b16 v[112:113], v165 offset:192
  v_mfma_f32_32x32x16_bf16 v[48:63], v[92:95], v[128:131], v[48:63]
  ds_read_b64_tr_b16 v[114:115], v165 offset:1472
  ds_read_b64_tr_b16 v[116:117], v165 offset:256
  ds_read_b64_tr_b16 v[118:119], v165 offset:1536
  v_mfma_f32_32x32x16_bf16 v[64:79], v[96:99], v[128:131], v[64:79]
  buffer_load_dwordx4 v[128:131], v166, s[24:27], s48 offen
  s_add_u32 s48, s48, 0x400
  s_cmp_eq_u32 s48, s50
  s_cselect_b32 s48, s49, s48
  s_waitcnt lgkmcnt(0)
  v_mfma_f32_32x32x16_bf16 v[0:15], v[100:103], v[132:135], v[0:15]
  s_add_u32 m0, s47, 0
  s_nop 0
  buffer_load_dwordx4 v160, s[28:31], s51 offen lds
  s_add_u32 m0, s47, 0x400
  s_nop 0
  buffer_load_dwordx4 v161, s[28:31], s51 offen lds
  s_add_u32 m0, s47, 0x800
  s_nop 0
  buffer_load_dwordx4 v162, s[28:31], s51 offen lds
  s_add_u32 m0, s47, 0xc00
  s_nop 0
  buffer_load_dwordx4 v163, s[28:31], s51 offen lds
  s_add_u32 m0, s47, 0x1000
  s_nop 0
  buffer_load_dwordx4 v164, s[28:31], s51 offen lds
  s_add_u32 s51, s51, 0x5000
  s_cmp_eq_u32 s51, s53
  s_cselect_b32 s51, s52, s51
  v_mfma_f32_32x32x16_bf16 v[16:31], v[104:107], v[132:135], v[16:31]
  s_waitcnt vmcnt(12)
  ds_read_b64_tr_b16 v[80:81], v165 offset:5120
  ds_read_b64_tr_b16 v[82:83], v165 offset:6400
  ds_read_b64_tr_b16 v[84:85], v165 offset:5184
  ds_read_b64_tr_b16 v[86:87], v165 offset:6464
  v_mfma_f32_32x32x16_bf16 v[32:47], v[108:111], v[132:135], v[32:47]
  ds_read_b64_tr_b16 v[88:89], v165 offset:5248
  ds_read_b64_tr_b16 v[90:91], v165 offset:6528
  ds_read_b64_tr_b16 v[92:93], v165 offset:5312
  v_mfma_f32_32x32x16_bf16 v[48:63], v[112:115], v[132:135], v[48:63]
  ds_read_b64_tr_b16 v[94:95], v165 offset:6592
  ds_read_b64_tr_b16 v[96:97], v165 offset:5376
  ds_read_b64_tr_b16 v[98:99], v165 offset:6656
  v_mfma_f32_32x32x16_bf16 v[64:79], v[116:119], v[132:135], v[64:79]
  buffer_load_dwordx4 v[132:135], v166, s[24:27], s48 offen
  s_add_u32 s48, s48, 0x400
  s_cmp_eq_u32 s48, s50
  s_cselect_b32 s48, s49, s48
  s_waitcnt lgkmcnt(0)
  v_mfma_f32_32x32x16_bf16 v[0:15], v[80:83], v[136:139], v[0:15]
  s_add_u32 m0, s47, 0x1400
  s_nop 0
  buffer_load_dwordx4 v160, s[28:31], s51 offen lds
  s_add_u32 m0, s47, 0x1800
  s_nop 0
  buffer_load_dwordx4 v161, s[28:31], s51 offen lds
  s_add_u32 m0, s47, 0x1c00
  s_nop 0
  buffer_load_dwordx4 v162, s[28:31], s51 offen lds
  s_add_u32 m0, s47, 0x2000
  s_nop 0
  buffer_load_dwordx4 v163, s[28:31], s51 offen lds
  s_add_u32 m0, s47, 0x2400
  s_nop 0
  buffer_load_dwordx4 v164, s[28:31], s51 offen lds
  s_add_u32 s51, s51, 0x5000
  s_cmp_eq_u32 s51, s53
  s_cselect_b32 s51, s52, s51
  v_mfma_f32_32x32x16_bf16 v[16:31], v[84:87], v[136:139], v[16:31]
  s_waitcnt vmcnt(12)
  ds_read_b64_tr_b16 v[100:101], v165 offset:10240
  ds_read_b64_tr_b16 v[102:103], v165 offset:11520
  ds_read_b64_tr_b16 v[104:105], v165 offset:10304
  ds_read_b64_tr_b16 v[106:107], v165 offset:11584
  v_mfma_f32_32x32x16_bf16 v[32:47], v[88:91], v[136:139], v[32:47]
  ds_read_b64_tr_b16 v[108:109], v165 offset:10368
  ds_read_b64_tr_b16 v[110:111], v165 offset:11648
  ds_read_b64_tr_b16 v[112:113], v165 offset:10432
  v_mfma_f32_32x32x16_bf16 v[48:63], v[92:95], v[136:139], v[48:63]
  ds_read_b64_tr_b16 v[114:115], v165 offset:11712
  ds_read_b64_tr_b16 v[116:117], v165 offset:10496
  ds_read_b64_tr_b16 v[118:119], v165 offset:11776
  v_mfma_f32_32x32x16_bf16 v[64:79], v[96:99], v[136:139], v[64:79]
  buffer_load_dwordx4 v[136:139], v166, s[24:27], s48 offen
  s_add_u32 s48, s48, 0x400
  s_cmp_eq_u32 s48, s50
  s_cselect_b32 s48, s49, s48
  s_waitcnt lgkmcnt(0)
  v_mfma_f32_32x32x16_bf16 v[0:15], v[100:103], v[140:143], v[0:15]
  s_add_u32 m0, s47, 0x2800
  s_nop 0
  buffer_load_dwordx4 v160, s[28:31], s51 offen lds
  s_add_u32 m0, s47, 0x2c00
  s_nop 0
  buffer_load_dwordx4 v161, s[28:31], s51 offen lds
  s_add_u32 m0, s47, 0x3000
  s_nop 0
  buffer_load_dwordx4 v162, s[28:31], s51 offen lds
  s_add_u32 m0, s47, 0x3400
  s_nop 0
  buffer_load_dwordx4 v163, s[28:31], s51 offen lds
  s_add_u32 m0, s47, 0x3800
  s_nop 0
  buffer_load_dwordx4 v164, s[28:31], s51 offen lds
  s_add_u32 s51, s51, 0x5000
  s_cmp_eq_u32 s51, s53
  s_cselect_b32 s51, s52, s51
  v_mfma_f32_32x32x16_bf16 v[16:31], v[104:107], v[140:143], v[16:31]
  s_waitcnt vmcnt(12)
  ds_read_b64_tr_b16 v[80:81], v165 offset:0
  ds_read_b64_tr_b16 v[82:83], v165 offset:1280
  ds_read_b64_tr_b16 v[84:85], v165 offset:64
  ds_read_b64_tr_b16 v[86:87], v165 offset:1344
  v_mfma_f32_32x32x16_bf16 v[32:47], v[108:111], v[140:143], v[32:47]
  ds_read_b64_tr_b16 v[88:89], v165 offset:128
  ds_read_b64_tr_b16 v[90:91], v165 offset:1408
  ds_read_b64_tr_b16 v[92:93], v165 offset:192
  v_mfma_f32_32x32x16_bf16 v[48:63], v[112:115], v[140:143], v[48:63]
  ds_read_b64_tr_b16 v[94:95], v165 offset:1472
  ds_read_b64_tr_b16 v[96:97], v165 offset:256
  ds_read_b64_tr_b16 v[98:99], v165 offset:1536
  v_mfma_f32_32x32x16_bf16 v[64:79], v[116:119], v[140:143], v[64:79]
  buffer_load_dwordx4 v[140:143], v166, s[24:27], s48 offen
  s_add_u32 s48, s48, 0x400
  s_cmp_eq_u32 s48, s50
  s_cselect_b32 s48, s49, s48
  s_waitcnt lgkmcnt(0)
  v_mfma_f32_32x32x16_bf16 v[0:15], v[80:83], v[120:123], v[0:15]
  s_add_u32 m0, s47, 0
  s_nop 0
  buffer_load_dwordx4 v160, s[28:31], s51 offen lds
  s_add_u32 m0, s47, 0x400
  s_nop 0
  buffer_load_dwordx4 v161, s[28:31], s51 offen lds
  s_add_u32 m0, s47, 0x800
  s_nop 0
  buffer_load_dwordx4 v162, s[28:31], s51 offen lds
  s_add_u32 m0, s47, 0xc00
  s_nop 0
  buffer_load_dwordx4 v163, s[28:31], s51 offen lds
  s_add_u32 m0, s47, 0x1000
  s_nop 0
  buffer_load_dwordx4 v164, s[28:31], s51 offen lds
  s_add_u32 s51, s51, 0x5000
  s_cmp_eq_u32 s51, s53
  s_cselect_b32 s51, s52, s51
  v_mfma_f32_32x32x16_bf16 v[16:31], v[84:87], v[120:123], v[16:31]
  s_waitcnt vmcnt(12)
  ds_read_b64_tr_b16 v[100:101], v165 offset:5120
  ds_read_b64_tr_b16 v[102:103], v165 offset:6400
  ds_read_b64_tr_b16 v[104:105], v165 offset:5184
  ds_read_b64_tr_b16 v[106:107], v165 offset:6464
  v_mfma_f32_32x32x16_bf16 v[32:47], v[88:91], v[120:123], v[32:47]
  ds_read_b64_tr_b16 v[108:109], v165 offset:5248
  ds_read_b64_tr_b16 v[110:111], v165 offset:6528
  ds_read_b64_tr_b16 v[112:113], v165 offset:5312
  v_mfma_f32_32x32x16_bf16 v[48:63], v[92:95], v[120:123], v[48:63]
  ds_read_b64_tr_b16 v[114:115], v165 offset:6592
  ds_read_b64_tr_b16 v[116:117], v165 offset:5376
  ds_read_b64_tr_b16 v[118:119], v165 offset:6656
  v_mfma_f32_32x32x16_bf16 v[64:79], v[96:99], v[120:123], v[64:79]
  buffer_load_dwordx4 v[120:123], v166, s[24:27], s48 offen
  s_add_u32 s48, s48, 0x400
  s_cmp_eq_u32 s48, s50
  s_cselect_b32 s48, s49, s48
  s_waitcnt lgkmcnt(0)
  v_mfma_f32_32x32x16_bf16 v[0:15], v[100:103], v[124:127], v[0:15]
  s_add_u32 m0, s47, 0x1400
  s_nop 0
  buffer_load_dwordx4 v160, s[28:31], s51 offen lds
  s_add_u32 m0, s47, 0x1800
  s_nop 0
  buffer_load_dwordx4 v161, s[28:31], s51 offen lds
  s_add_u32 m0, s47, 0x1c00
  s_nop 0
  buffer_load_dwordx4 v162, s[28:31], s51 offen lds
  s_add_u32 m0, s47, 0x2000
  s_nop 0
  buffer_load_dwordx4 v163, s[28:31], s51 offen lds
  s_add_u32 m0, s47, 0x2400
  s_nop 0
  buffer_load_dwordx4 v164, s[28:31], s51 offen lds
  s_add_u32 s51, s51, 0x5000
  s_cmp_eq_u32 s51, s53
  s_cselect_b32 s51, s52, s51
  v_mfma_f32_32x32x16_bf16 v[16:31], v[104:107], v[124:127], v[16:31]
  s_waitcnt vmcnt(12)
  ds_read_b64_tr_b16 v[80:81], v165 offset:10240
  ds_read_b64_tr_b16 v[82:83], v165 offset:11520
  ds_read_b64_tr_b16 v[84:85], v165 offset:10304
  ds_read_b64_tr_b16 v[86:87], v165 offset:11584
  v_mfma_f32_32x32x16_bf16 v[32:47], v[108:111], v[124:127], v[32:47]
  ds_read_b64_tr_b16 v[88:89], v165 offset:10368
  ds_read_b64_tr_b16 v[90:91], v165 offset:11648
  ds_read_b64_tr_b16 v[92:93], v165 offset:10432
  v_mfma_f32_32x32x16_bf16 v[48:63], v[112:115], v[124:127], v[48:63]
  ds_read_b64_tr_b16 v[94:95], v165 offset:11712
  ds_read_b64_tr_b16 v[96:97], v165 offset:10496
  ds_read_b64_tr_b16 v[98:99], v165 offset:11776
  v_mfma_f32_32x32x16_bf16 v[64:79], v[116:119], v[124:127], v[64:79]
  buffer_load_dwordx4 v[124:127], v166, s[24:27], s48 offen
  s_add_u32 s48, s48, 0x400
  s_cmp_eq_u32 s48, s50
  s_cselect_b32 s48, s49, s48
  s_waitcnt lgkmcnt(0)
  v_mfma_f32_32x32x16_bf16 v[0:15], v[80:83], v[128:131], v[0:15]
  s_add_u32 m0, s47, 0x2800
  s_nop 0
  buffer_load_dwordx4 v160, s[28:31], s51 offen lds
  s_add_u32 m0, s47, 0x2c00
  s_nop 0
  buffer_load_dwordx4 v161, s[28:31], s51 offen lds
  s_add_u32 m0, s47, 0x3000
  s_nop 0
  buffer_load_dwordx4 v162, s[28:31], s51 offen lds
  s_add_u32 m0, s47, 0x3400
  s_nop 0
  buffer_load_dwordx4 v163, s[28:31], s51 offen lds
  s_add_u32 m0, s47, 0x3800
  s_nop 0
  buffer_load_dwordx4 v164, s[28:31], s51 offen lds
  s_add_u32 s51, s51, 0x5000
  s_cmp_eq_u32 s51, s53
  s_cselect_b32 s51, s52, s51
  v_mfma_f32_32x32x16_bf16 v[16:31], v[84:87], v[128:131], v[16:31]
  s_waitcnt vmcnt(12)
  ds_read_b64_tr_b16 v[100:101], v165 offset:0
  ds_read_b64_tr_b16 v[102:103], v165 offset:1280
  ds_read_b64_tr_b16 v[104:105], v165 offset:64
  ds_read_b64_tr_b16 v[106:107], v165 offset:1344
  v_mfma_f32_32x32x16_bf16 v[32:47], v[88:91], v[128:131], v[32:47]
  ds_read_b64_tr_b16 v[108:109], v165 offset:128
  ds_read_b64_tr_b16 v[110:111], v165 offset:1408
  ds_read_b64_tr_b16 v[112:113], v165 offset:192
  v_mfma_f32_32x32x16_bf16 v[48:63], v[92:95], v[128:131], v[48:63]
  ds_read_b64_tr_b16 v[114:115], v165 offset:1472
  ds_read_b64_tr_b16 v[116:117], v165 offset:256
  ds_read_b64_tr_b16 v[118:119], v165 offset:1536
  v_mfma_f32_32x32x16_bf16 v[64:79], v[96:99], v[128:131], v[64:79]
  buffer_load_dwordx4 v[128:131], v166, s[24:27], s48 offen
  s_add_u32 s48, s48, 0x400
  s_cmp_eq_u32 s48, s50
  s_cselect_b32 s48, s49, s48
  s_waitcnt lgkmcnt(0)
  v_mfma_f32_32x32x16_bf16 v[0:15], v[100:103], v[132:135], v[0:15]
  s_add_u32 m0, s47, 0
  s_nop 0
  buffer_load_dwordx4 v160, s[28:31], s51 offen lds
  s_add_u32 m0, s47, 0x400
  s_nop 0
  buffer_load_dwordx4 v161, s[28:31], s51 offen lds
  s_add_u32 m0, s47, 0x800
  s_nop 0
  buffer_load_dwordx4 v162, s[28:31], s51 offen lds
  s_add_u32 m0, s47, 0xc00
  s_nop 0
  buffer_load_dwordx4 v163, s[28:31], s51 offen lds
  s_add_u32 m0, s47, 0x1000
  s_nop 0
  buffer_load_dwordx4 v164, s[28:31], s51 offen lds
  s_add_u32 s51, s51, 0x5000
  s_cmp_eq_u32 s51, s53
  s_cselect_b32 s51, s52, s51
  v_mfma_f32_32x32x16_bf16 v[16:31], v[104:107], v[132:135], v[16:31]
  s_waitcnt vmcnt(12)
  ds_read_b64_tr_b16 v[80:81], v165 offset:5120
  ds_read_b64_tr_b16 v[82:83], v165 offset:6400
  ds_read_b64_tr_b16 v[84:85], v165 offset:5184
  ds_read_b64_tr_b16 v[86:87], v165 offset:6464
  v_mfma_f32_32x32x16_bf16 v[32:47], v[108:111], v[132:135], v[32:47]
  ds_read_b64_tr_b16 v[88:89], v165 offset:5248
  ds_read_b64_tr_b16 v[90:91], v165 offset:6528
  ds_read_b64_tr_b16 v[92:93], v165 offset:5312
  v_mfma_f32_32x32x16_bf16 v[48:63], v[112:115], v[132:135], v[48:63]
  ds_read_b64_tr_b16 v[94:95], v165 offset:6592
  ds_read_b64_tr_b16 v[96:97], v165 offset:5376
  ds_read_b64_tr_b16 v[98:99], v165 offset:6656
  v_mfma_f32_32x32x16_bf16 v[64:79], v[116:119], v[132:135], v[64:79]
  buffer_load_dwordx4 v[132:135], v166, s[24:27], s48 offen
  s_add_u32 s48, s48, 0x400
  s_cmp_eq_u32 s48, s50
  s_cselect_b32 s48, s49, s48
  s_waitcnt lgkmcnt(0)
  v_mfma_f32_32x32x16_bf16 v[0:15], v[80:83], v[136:139], v[0:15]
  s_add_u32 m0, s47, 0x1400
  s_nop 0
  buffer_load_dwordx4 v160, s[28:31], s51 offen lds
  s_add_u32 m0, s47, 0x1800
  s_nop 0
  buffer_load_dwordx4 v161, s[28:31], s51 offen lds
  s_add_u32 m0, s47, 0x1c00
  s_nop 0
  buffer_load_dwordx4 v162, s[28:31], s51 offen lds
  s_add_u32 m0, s47, 0x2000
  s_nop 0
  buffer_load_dwordx4 v163, s[28:31], s51 offen lds
  s_add_u32 m0, s47, 0x2400
  s_nop 0
  buffer_load_dwordx4 v164, s[28:31], s51 offen lds
  s_add_u32 s51, s51, 0x5000
  s_cmp_eq_u32 s51, s53
  s_cselect_b32 s51, s52, s51
  v_mfma_f32_32x32x16_bf16 v[16:31], v[84:87], v[136:139], v[16:31]
  s_waitcnt vmcnt(12)
  ds_read_b64_tr_b16 v[100:101], v165 offset:10240
  ds_read_b64_tr_b16 v[102:103], v165 offset:11520
  ds_read_b64_tr_b16 v[104:105], v165 offset:10304
  ds_read_b64_tr_b16 v[106:107], v165 offset:11584
  v_mfma_f32_32x32x16_bf16 v[32:47], v[88:91], v[136:139], v[32:47]
  ds_read_b64_tr_b16 v[108:109], v165 offset:10368
  ds_read_b64_tr_b16 v[110:111], v165 offset:11648
  ds_read_b64_tr_b16 v[112:113], v165 offset:10432
  v_mfma_f32_32x32x16_bf16 v[48:63], v[92:95], v[136:139], v[48:63]
  ds_read_b64_tr_b16 v[114:115], v165 offset:11712
  ds_read_b64_tr_b16 v[116:117], v165 offset:10496
  ds_read_b64_tr_b16 v[118:119], v165 offset:11776
  v_mfma_f32_32x32x16_bf16 v[64:79], v[96:99], v[136:139], v[64:79]
  buffer_load_dwordx4 v[136:139], v166, s[24:27], s48 offen
  s_add_u32 s48, s48, 0x400
  s_cmp_eq_u32 s48, s50
  s_cselect_b32 s48, s49, s48
  s_waitcnt lgkmcnt(0)
  v_mfma_f32_32x32x16_bf16 v[0:15], v[100:103], v[140:143], v[0:15]
  s_add_u32 m0, s47, 0x2800
  s_nop 0
  buffer_load_dwordx4 v160, s[28:31], s51 offen lds
  s_add_u32 m0, s47, 0x2c00
  s_nop 0
  buffer_load_dwordx4 v161, s[28:31], s51 offen lds
  s_add_u32 m0, s47, 0x3000
  s_nop 0
  buffer_load_dwordx4 v162, s[28:31], s51 offen lds
  s_add_u32 m0, s47, 0x3400
  s_nop 0
  buffer_load_dwordx4 v163, s[28:31], s51 offen lds
  s_add_u32 m0, s47, 0x3800
  s_nop 0
  buffer_load_dwordx4 v164, s[28:31], s51 offen lds
  s_add_u32 s51, s51, 0x5000
  s_cmp_eq_u32 s51, s53
  s_cselect_b32 s51, s52, s51
  v_mfma_f32_32x32x16_bf16 v[16:31], v[104:107], v[140:143], v[16:31]
  s_waitcnt vmcnt(12)
  ds_read_b64_tr_b16 v[80:81], v165 offset:0
  ds_read_b64_tr_b16 v[82:83], v165 offset:1280
  ds_read_b64_tr_b16 v[84:85], v165 offset:64
  ds_read_b64_tr_b16 v[86:87], v165 offset:1344
  v_mfma_f32_32x32x16_bf16 v[32:47], v[108:111], v[140:143], v[32:47]
  ds_read_b64_tr_b16 v[88:89], v165 offset:128
  ds_read_b64_tr_b16 v[90:91], v165 offset:1408
  ds_read_b64_tr_b16 v[92:93], v165 offset:192
  v_mfma_f32_32x32x16_bf16 v[48:63], v[112:115], v[140:143], v[48:63]
  ds_read_b64_tr_b16 v[94:95], v165 offset:1472
  ds_read_b64_tr_b16 v[96:97], v165 offset:256
  ds_read_b64_tr_b16 v[98:99], v165 offset:1536
  v_mfma_f32_32x32x16_bf16 v[64:79], v[116:119], v[140:143], v[64:79]
  buffer_load_dwordx4 v[140:143], v166, s[24:27], s48 offen
  s_add_u32 s48, s48, 0x400
  s_cmp_eq_u32 s48, s50
  s_cselect_b32 s48, s49, s48
  s_waitcnt lgkmcnt(0)
  v_mfma_f32_32x32x16_bf16 v[0:15], v[80:83], v[120:123], v[0:15]
  s_add_u32 m0, s47, 0
  s_nop 0
  buffer_load_dwordx4 v160, s[28:31], s51 offen lds
  s_add_u32 m0, s47, 0x400
  s_nop 0
  buffer_load_dwordx4 v161, s[28:31], s51 offen lds
  s_add_u32 m0, s47, 0x800
  s_nop 0
  buffer_load_dwordx4 v162, s[28:31], s51 offen lds
  s_add_u32 m0, s47, 0xc00
  s_nop 0
  buffer_load_dwordx4 v163, s[28:31], s51 offen lds
  s_add_u32 m0, s47, 0x1000
  s_nop 0
  buffer_load_dwordx4 v164, s[28:31], s51 offen lds
  s_add_u32 s51, s51, 0x5000
  s_cmp_eq_u32 s51, s53
  s_cselect_b32 s51, s52, s51
  v_mfma_f32_32x32x16_bf16 v[16:31], v[84:87], v[120:123], v[16:31]
  s_waitcnt vmcnt(12)
  ds_read_b64_tr_b16 v[100:101], v165 offset:5120
  ds_read_b64_tr_b16 v[102:103], v165 offset:6400
  ds_read_b64_tr_b16 v[104:105], v165 offset:5184
  ds_read_b64_tr_b16 v[106:107], v165 offset:6464
  v_mfma_f32_32x32x16_bf16 v[32:47], v[88:91], v[120:123], v[32:47]
  ds_read_b64_tr_b16 v[108:109], v165 offset:5248
  ds_read_b64_tr_b16 v[110:111], v165 offset:6528
  ds_read_b64_tr_b16 v[112:113], v165 offset:5312
  v_mfma_f32_32x32x16_bf16 v[48:63], v[92:95], v[120:123], v[48:63]
  ds_read_b64_tr_b16 v[114:115], v165 offset:6592
  ds_read_b64_tr_b16 v[116:117], v165 offset:5376
  ds_read_b64_tr_b16 v[118:119], v165 offset:6656
  v_mfma_f32_32x32x16_bf16 v[64:79], v[96:99], v[120:123], v[64:79]
  buffer_load_dwordx4 v[120:123], v166, s[24:27], s48 offen
  s_add_u32 s48, s48, 0x400
  s_cmp_eq_u32 s48, s50
  s_cselect_b32 s48, s49, s48
  s_waitcnt lgkmcnt(0)
  v_mfma_f32_32x32x16_bf16 v[0:15], v[100:103], v[124:127], v[0:15]
  s_add_u32 m0, s47, 0x1400
  s_nop 0
  buffer_load_dwordx4 v160, s[28:31], s51 offen lds
  s_add_u32 m0, s47, 0x1800
  s_nop 0
  buffer_load_dwordx4 v161, s[28:31], s51 offen lds
  s_add_u32 m0, s47, 0x1c00
  s_nop 0
  buffer_load_dwordx4 v162, s[28:31], s51 offen lds
  s_add_u32 m0, s47, 0x2000
  s_nop 0
  buffer_load_dwordx4 v163, s[28:31], s51 offen lds
  s_add_u32 m0, s47, 0x2400
  s_nop 0
  buffer_load_dwordx4 v164, s[28:31], s51 offen lds
  s_add_u32 s51, s51, 0x5000
  s_cmp_eq_u32 s51, s53
  s_cselect_b32 s51, s52, s51
  v_mfma_f32_32x32x16_bf16 v[16:31], v[104:107], v[124:127], v[16:31]
  s_waitcnt vmcnt(12)
  ds_read_b64_tr_b16 v[80:81], v165 offset:10240
  ds_read_b64_tr_b16 v[82:83], v165 offset:11520
  ds_read_b64_tr_b16 v[84:85], v165 offset:10304
  ds_read_b64_tr_b16 v[86:87], v165 offset:11584
  v_mfma_f32_32x32x16_bf16 v[32:47], v[108:111], v[124:127], v[32:47]
  ds_read_b64_tr_b16 v[88:89], v165 offset:10368
  ds_read_b64_tr_b16 v[90:91], v165 offset:11648
  ds_read_b64_tr_b16 v[92:93], v165 offset:10432
  v_mfma_f32_32x32x16_bf16 v[48:63], v[112:115], v[124:127], v[48:63]
  ds_read_b64_tr_b16 v[94:95], v165 offset:11712
  ds_read_b64_tr_b16 v[96:97], v165 offset:10496
  ds_read_b64_tr_b16 v[98:99], v165 offset:11776
  v_mfma_f32_32x32x16_bf16 v[64:79], v[116:119], v[124:127], v[64:79]
  buffer_load_dwordx4 v[124:127], v166, s[24:27], s48 offen
  s_add_u32 s48, s48, 0x400
  s_cmp_eq_u32 s48, s50
  s_cselect_b32 s48, s49, s48
  s_waitcnt lgkmcnt(0)
  v_mfma_f32_32x32x16_bf16 v[0:15], v[80:83], v[128:131], v[0:15]
  s_add_u32 m0, s47, 0x2800
  s_nop 0
  buffer_load_dwordx4 v160, s[28:31], s51 offen lds
  s_add_u32 m0, s47, 0x2c00
  s_nop 0
  buffer_load_dwordx4 v161, s[28:31], s51 offen lds
  s_add_u32 m0, s47, 0x3000
  s_nop 0
  buffer_load_dwordx4 v162, s[28:31], s51 offen lds
  s_add_u32 m0, s47, 0x3400
  s_nop 0
  buffer_load_dwordx4 v163, s[28:31], s51 offen lds
  s_add_u32 m0, s47, 0x3800
  s_nop 0
  buffer_load_dwordx4 v164, s[28:31], s51 offen lds
  s_add_u32 s51, s51, 0x5000
  s_cmp_eq_u32 s51, s53
  s_cselect_b32 s51, s52, s51
  v_mfma_f32_32x32x16_bf16 v[16:31], v[84:87], v[128:131], v[16:31]
  s_waitcnt vmcnt(12)
  ds_read_b64_tr_b16 v[100:101], v165 offset:0
  ds_read_b64_tr_b16 v[102:103], v165 offset:1280
  ds_read_b64_tr_b16 v[104:105], v165 offset:64
  ds_read_b64_tr_b16 v[106:107], v165 offset:1344
  v_mfma_f32_32x32x16_bf16 v[32:47], v[88:91], v[128:131], v[32:47]
  ds_read_b64_tr_b16 v[108:109], v165 offset:128
  ds_read_b64_tr_b16 v[110:111], v165 offset:1408
  ds_read_b64_tr_b16 v[112:113], v165 offset:192
  v_mfma_f32_32x32x16_bf16 v[48:63], v[92:95], v[128:131], v[48:63]
  ds_read_b64_tr_b16 v[114:115], v165 offset:1472
  ds_read_b64_tr_b16 v[116:117], v165 offset:256
  ds_read_b64_tr_b16 v[118:119], v165 offset:1536
  v_mfma_f32_32x32x16_bf16 v[64:79], v[96:99], v[128:131], v[64:79]
  buffer_load_dwordx4 v[128:131], v166, s[24:27], s48 offen
  s_add_u32 s48, s48, 0x400
  s_cmp_eq_u32 s48, s50
  s_cselect_b32 s48, s49, s48
  s_waitcnt lgkmcnt(0)
  v_mfma_f32_32x32x16_bf16 v[0:15], v[100:103], v[132:135], v[0:15]
  s_add_u32 m0, s47, 0
  s_nop 0
  buffer_load_dwordx4 v160, s[28:31], s51 offen lds
  s_add_u32 m0, s47, 0x400
  s_nop 0
  buffer_load_dwordx4 v161, s[28:31], s51 offen lds
  s_add_u32 m0, s47, 0x800
  s_nop 0
  buffer_load_dwordx4 v162, s[28:31], s51 offen lds
  s_add_u32 m0, s47, 0xc00
  s_nop 0
  buffer_load_dwordx4 v163, s[28:31], s51 offen lds
  s_add_u32 m0, s47, 0x1000
  s_nop 0
  buffer_load_dwordx4 v164, s[28:31], s51 offen lds
  s_add_u32 s51, s51, 0x5000
  s_cmp_eq_u32 s51, s53
  s_cselect_b32 s51, s52, s51
  v_mfma_f32_32x32x16_bf16 v[16:31], v[104:107], v[132:135], v[16:31]
  s_waitcnt vmcnt(12)
  ds_read_b64_tr_b16 v[80:81], v165 offset:5120
  ds_read_b64_tr_b16 v[82:83], v165 offset:6400
  ds_read_b64_tr_b16 v[84:85], v165 offset:5184
  ds_read_b64_tr_b16 v[86:87], v165 offset:6464
  v_mfma_f32_32x32x16_bf16 v[32:47], v[108:111], v[132:135], v[32:47]
  ds_read_b64_tr_b16 v[88:89], v165 offset:5248
  ds_read_b64_tr_b16 v[90:91], v165 offset:6528
  ds_read_b64_tr_b16 v[92:93], v165 offset:5312
  v_mfma_f32_32x32x16_bf16 v[48:63], v[112:115], v[132:135], v[48:63]
  ds_read_b64_tr_b16 v[94:95], v165 offset:6592
  ds_read_b64_tr_b16 v[96:97], v165 offset:5376
  ds_read_b64_tr_b16 v[98:99], v165 offset:6656
  v_mfma_f32_32x32x16_bf16 v[64:79], v[116:119], v[132:135], v[64:79]
  buffer_load_dwordx4 v[132:135], v166, s[24:27], s48 offen
  s_add_u32 s48, s48, 0x400
  s_cmp_eq_u32 s48, s50
  s_cselect_b32 s48, s49, s48
  s_waitcnt lgkmcnt(0)
  v_mfma_f32_32x32x16_bf16 v[0:15], v[80:83], v[136:139], v[0:15]
  s_add_u32 m0, s47, 0x1400
  s_nop 0
  buffer_load_dwordx4 v160, s[28:31], s51 offen lds
  s_add_u32 m0, s47, 0x1800
  s_nop 0
  buffer_load_dwordx4 v161, s[28:31], s51 offen lds
  s_add_u32 m0, s47, 0x1c00
  s_nop 0
  buffer_load_dwordx4 v162, s[28:31], s51 offen lds
  s_add_u32 m0, s47, 0x2000
  s_nop 0
  buffer_load_dwordx4 v163, s[28:31], s51 offen lds
  s_add_u32 m0, s47, 0x2400
  s_nop 0
  buffer_load_dwordx4 v164, s[28:31], s51 offen lds
  s_add_u32 s51, s51, 0x5000
  s_cmp_eq_u32 s51, s53
  s_cselect_b32 s51, s52, s51
  v_mfma_f32_32x32x16_bf16 v[16:31], v[84:87], v[136:139], v[16:31]
  s_waitcnt vmcnt(12)
  ds_read_b64_tr_b16 v[100:101], v165 offset:10240
  ds_read_b64_tr_b16 v[102:103], v165 offset:11520
  ds_read_b64_tr_b16 v[104:105], v165 offset:10304
  ds_read_b64_tr_b16 v[106:107], v165 offset:11584
  v_mfma_f32_32x32x16_bf16 v[32:47], v[88:91], v[136:139], v[32:47]
  ds_read_b64_tr_b16 v[108:109], v165 offset:10368
  ds_read_b64_tr_b16 v[110:111], v165 offset:11648
  ds_read_b64_tr_b16 v[112:113], v165 offset:10432
  v_mfma_f32_32x32x16_bf16 v[48:63], v[92:95], v[136:139], v[48:63]
  ds_read_b64_tr_b16 v[114:115], v165 offset:11712
  ds_read_b64_tr_b16 v[116:117], v165 offset:10496
  ds_read_b64_tr_b16 v[118:119], v165 offset:11776
  v_mfma_f32_32x32x16_bf16 v[64:79], v[96:99], v[136:139], v[64:79]
  buffer_load_dwordx4 v[136:139], v166, s[24:27], s48 offen
  s_add_u32 s48, s48, 0x400
  s_cmp_eq_u32 s48, s50
  s_cselect_b32 s48, s49, s48
  s_waitcnt lgkmcnt(0)
  v_mfma_f32_32x32x16_bf16 v[0:15], v[100:103], v[140:143], v[0:15]
  s_add_u32 m0, s47, 0x2800
  s_nop 0
  buffer_load_dwordx4 v160, s[28:31], s51 offen lds
  s_add_u32 m0, s47, 0x2c00
  s_nop 0
  buffer_load_dwordx4 v161, s[28:31], s51 offen lds
  s_add_u32 m0, s47, 0x3000
  s_nop 0
  buffer_load_dwordx4 v162, s[28:31], s51 offen lds
  s_add_u32 m0, s47, 0x3400
  s_nop 0
  buffer_load_dwordx4 v163, s[28:31], s51 offen lds
  s_add_u32 m0, s47, 0x3800
  s_nop 0
  buffer_load_dwordx4 v164, s[28:31], s51 offen lds
  s_add_u32 s51, s51, 0x5000
  s_cmp_eq_u32 s51, s53
  s_cselect_b32 s51, s52, s51
  v_mfma_f32_32x32x16_bf16 v[16:31], v[104:107], v[140:143], v[16:31]
  s_waitcnt vmcnt(12)
  ds_read_b64_tr_b16 v[80:81], v165 offset:0
  ds_read_b64_tr_b16 v[82:83], v165 offset:1280
  ds_read_b64_tr_b16 v[84:85], v165 offset:64
  ds_read_b64_tr_b16 v[86:87], v165 offset:1344
  v_mfma_f32_32x32x16_bf16 v[32:47], v[108:111], v[140:143], v[32:47]
  ds_read_b64_tr_b16 v[88:89], v165 offset:128
  ds_read_b64_tr_b16 v[90:91], v165 offset:1408
  ds_read_b64_tr_b16 v[92:93], v165 offset:192
  v_mfma_f32_32x32x16_bf16 v[48:63], v[112:115], v[140:143], v[48:63]
  ds_read_b64_tr_b16 v[94:95], v165 offset:1472
  ds_read_b64_tr_b16 v[96:97], v165 offset:256
  ds_read_b64_tr_b16 v[98:99], v165 offset:1536
  v_mfma_f32_32x32x16_bf16 v[64:79], v[116:119], v[140:143], v[64:79]
  buffer_load_dwordx4 v[140:143], v166, s[24:27], s48 offen
  s_add_u32 s48, s48, 0x400
  s_cmp_eq_u32 s48, s50
  s_cselect_b32 s48, s49, s48
  s_waitcnt lgkmcnt(0)
  v_mfma_f32_32x32x16_bf16 v[0:15], v[80:83], v[120:123], v[0:15]
  s_add_u32 m0, s47, 0
  s_nop 0
  buffer_load_dwordx4 v160, s[28:31], s51 offen lds
  s_add_u32 m0, s47, 0x400
  s_nop 0
  buffer_load_dwordx4 v161, s[28:31], s51 offen lds
  s_add_u32 m0, s47, 0x800
  s_nop 0
  buffer_load_dwordx4 v162, s[28:31], s51 offen lds
  s_add_u32 m0, s47, 0xc00
  s_nop 0
  buffer_load_dwordx4 v163, s[28:31], s51 offen lds
  s_add_u32 m0, s47, 0x1000
  s_nop 0
  buffer_load_dwordx4 v164, s[28:31], s51 offen lds
  s_add_u32 s51, s51, 0x5000
  s_cmp_eq_u32 s51, s53
  s_cselect_b32 s51, s52, s51
  v_mfma_f32_32x32x16_bf16 v[16:31], v[84:87], v[120:123], v[16:31]
  s_waitcnt vmcnt(12)
  ds_read_b64_tr_b16 v[100:101], v165 offset:5120
  ds_read_b64_tr_b16 v[102:103], v165 offset:6400
  ds_read_b64_tr_b16 v[104:105], v165 offset:5184
  ds_read_b64_tr_b16 v[106:107], v165 offset:6464
  v_mfma_f32_32x32x16_bf16 v[32:47], v[88:91], v[120:123], v[32:47]
  ds_read_b64_tr_b16 v[108:109], v165 offset:5248
  ds_read_b64_tr_b16 v[110:111], v165 offset:6528
  ds_read_b64_tr_b16 v[112:113], v165 offset:5312
  v_mfma_f32_32x32x16_bf16 v[48:63], v[92:95], v[120:123], v[48:63]
  ds_read_b64_tr_b16 v[114:115], v165 offset:6592
  ds_read_b64_tr_b16 v[116:117], v165 offset:5376
  ds_read_b64_tr_b16 v[118:119], v165 offset:6656
  v_mfma_f32_32x32x16_bf16 v[64:79], v[96:99], v[120:123], v[64:79]
  buffer_load_dwordx4 v[120:123], v166, s[24:27], s48 offen
  s_add_u32 s48, s48, 0x400
  s_cmp_eq_u32 s48, s50
  s_cselect_b32 s48, s49, s48
  s_waitcnt lgkmcnt(0)
  v_mfma_f32_32x32x16_bf16 v[0:15], v[100:103], v[124:127], v[0:15]
  s_add_u32 m0, s47, 0x1400
  s_nop 0
  buffer_load_dwordx4 v160, s[28:31], s51 offen lds
  s_add_u32 m0, s47, 0x1800
  s_nop 0
  buffer_load_dwordx4 v161, s[28:31], s51 offen lds
  s_add_u32 m0, s47, 0x1c00
  s_nop 0
  buffer_load_dwordx4 v162, s[28:31], s51 offen lds
  s_add_u32 m0, s47, 0x2000
  s_nop 0
  buffer_load_dwordx4 v163, s[28:31], s51 offen lds
  s_add_u32 m0, s47, 0x2400
  s_nop 0
  buffer_load_dwordx4 v164, s[28:31], s51 offen lds
  s_add_u32 s51, s51, 0x5000
  s_cmp_eq_u32 s51, s53
  s_cselect_b32 s51, s52, s51
  v_mfma_f32_32x32x16_bf16 v[16:31], v[104:107], v[124:127], v[16:31]
  s_waitcnt vmcnt(12)
  ds_read_b64_tr_b16 v[80:81], v165 offset:10240
  ds_read_b64_tr_b16 v[82:83], v165 offset:11520
  ds_read_b64_tr_b16 v[84:85], v165 offset:10304
  ds_read_b64_tr_b16 v[86:87], v165 offset:11584
  v_mfma_f32_32x32x16_bf16 v[32:47], v[108:111], v[124:127], v[32:47]
  ds_read_b64_tr_b16 v[88:89], v165 offset:10368
  ds_read_b64_tr_b16 v[90:91], v165 offset:11648
  ds_read_b64_tr_b16 v[92:93], v165 offset:10432
  v_mfma_f32_32x32x16_bf16 v[48:63], v[112:115], v[124:127], v[48:63]
  ds_read_b64_tr_b16 v[94:95], v165 offset:11712
  ds_read_b64_tr_b16 v[96:97], v165 offset:10496
  ds_read_b64_tr_b16 v[98:99], v165 offset:11776
  v_mfma_f32_32x32x16_bf16 v[64:79], v[116:119], v[124:127], v[64:79]
  buffer_load_dwordx4 v[124:127], v166, s[24:27], s48 offen
  s_add_u32 s48, s48, 0x400
  s_cmp_eq_u32 s48, s50
  s_cselect_b32 s48, s49, s48
  s_waitcnt lgkmcnt(0)
  v_mfma_f32_32x32x16_bf16 v[0:15], v[80:83], v[128:131], v[0:15]
  s_add_u32 m0, s47, 0x2800
  s_nop 0
  buffer_load_dwordx4 v160, s[28:31], s51 offen lds
  s_add_u32 m0, s47, 0x2c00
  s_nop 0
  buffer_load_dwordx4 v161, s[28:31], s51 offen lds
  s_add_u32 m0, s47, 0x3000
  s_nop 0
  buffer_load_dwordx4 v162, s[28:31], s51 offen lds
  s_add_u32 m0, s47, 0x3400
  s_nop 0
  buffer_load_dwordx4 v163, s[28:31], s51 offen lds
  s_add_u32 m0, s47, 0x3800
  s_nop 0
  buffer_load_dwordx4 v164, s[28:31], s51 offen lds
  s_add_u32 s51, s51, 0x5000
  s_cmp_eq_u32 s51, s53
  s_cselect_b32 s51, s52, s51
  v_mfma_f32_32x32x16_bf16 v[16:31], v[84:87], v[128:131], v[16:31]
  s_waitcnt vmcnt(12)
  ds_read_b64_tr_b16 v[100:101], v165 offset:0
  ds_read_b64_tr_b16 v[102:103], v165 offset:1280
  ds_read_b64_tr_b16 v[104:105], v165 offset:64
  ds_read_b64_tr_b16 v[106:107], v165 offset:1344
  v_mfma_f32_32x32x16_bf16 v[32:47], v[88:91], v[128:131], v[32:47]
  ds_read_b64_tr_b16 v[108:109], v165 offset:128
  ds_read_b64_tr_b16 v[110:111], v165 offset:1408
  ds_read_b64_tr_b16 v[112:113], v165 offset:192
  v_mfma_f32_32x32x16_bf16 v[48:63], v[92:95], v[128:131], v[48:63]
  ds_read_b64_tr_b16 v[114:115], v165 offset:1472
  ds_read_b64_tr_b16 v[116:117], v165 offset:256
  ds_read_b64_tr_b16 v[118:119], v165 offset:1536
  v_mfma_f32_32x32x16_bf16 v[64:79], v[96:99], v[128:131], v[64:79]
  buffer_load_dwordx4 v[128:131], v166, s[24:27], s48 offen
  s_add_u32 s48, s48, 0x400
  s_cmp_eq_u32 s48, s50
  s_cselect_b32 s48, s49, s48
  s_waitcnt lgkmcnt(0)
  v_mfma_f32_32x32x16_bf16 v[0:15], v[100:103], v[132:135], v[0:15]
  s_add_u32 m0, s47, 0
  s_nop 0
  buffer_load_dwordx4 v160, s[28:31], s51 offen lds
  s_add_u32 m0, s47, 0x400
  s_nop 0
  buffer_load_dwordx4 v161, s[28:31], s51 offen lds
  s_add_u32 m0, s47, 0x800
  s_nop 0
  buffer_load_dwordx4 v162, s[28:31], s51 offen lds
  s_add_u32 m0, s47, 0xc00
  s_nop 0
  buffer_load_dwordx4 v163, s[28:31], s51 offen lds
  s_add_u32 m0, s47, 0x1000
  s_nop 0
  buffer_load_dwordx4 v164, s[28:31], s51 offen lds
  s_add_u32 s51, s51, 0x5000
  s_cmp_eq_u32 s51, s53
  s_cselect_b32 s51, s52, s51
  v_mfma_f32_32x32x16_bf16 v[16:31], v[104:107], v[132:135], v[16:31]
  s_waitcnt vmcnt(12)
  ds_read_b64_tr_b16 v[80:81], v165 offset:5120
  ds_read_b64_tr_b16 v[82:83], v165 offset:6400
  ds_read_b64_tr_b16 v[84:85], v165 offset:5184
  ds_read_b64_tr_b16 v[86:87], v165 offset:6464
  v_mfma_f32_32x32x16_bf16 v[32:47], v[108:111], v[132:135], v[32:47]
  ds_read_b64_tr_b16 v[88:89], v165 offset:5248
  ds_read_b64_tr_b16 v[90:91], v165 offset:6528
  ds_read_b64_tr_b16 v[92:93], v165 offset:5312
  v_mfma_f32_32x32x16_bf16 v[48:63], v[112:115], v[132:135], v[48:63]
  ds_read_b64_tr_b16 v[94:95], v165 offset:6592
  ds_read_b64_tr_b16 v[96:97], v165 offset:5376
  ds_read_b64_tr_b16 v[98:99], v165 offset:6656
  v_mfma_f32_32x32x16_bf16 v[64:79], v[116:119], v[132:135], v[64:79]
  s_waitcnt lgkmcnt(0)
  v_mfma_f32_32x32x16_bf16 v[0:15], v[80:83], v[136:139], v[0:15]
  s_add_u32 m0, s47, 0x1400
  s_nop 0
  buffer_load_dwordx4 v160, s[28:31], s51 offen lds
  s_add_u32 m0, s47, 0x1800
  s_nop 0
  buffer_load_dwordx4 v161, s[28:31], s51 offen lds
  s_add_u32 m0, s47, 0x1c00
  s_nop 0
  buffer_load_dwordx4 v162, s[28:31], s51 offen lds
  s_add_u32 m0, s47, 0x2000
  s_nop 0
  buffer_load_dwordx4 v163, s[28:31], s51 offen lds
  s_add_u32 m0, s47, 0x2400
  s_nop 0
  buffer_load_dwordx4 v164, s[28:31], s51 offen lds
  s_add_u32 s51, s51, 0x5000
  s_cmp_eq_u32 s51, s53
  s_cselect_b32 s51, s52, s51
  v_mfma_f32_32x32x16_bf16 v[16:31], v[84:87], v[136:139], v[16:31]
  s_waitcnt vmcnt(11)
  ds_read_b64_tr_b16 v[100:101], v165 offset:10240
  ds_read_b64_tr_b16 v[102:103], v165 offset:11520
  ds_read_b64_tr_b16 v[104:105], v165 offset:10304
  ds_read_b64_tr_b16 v[106:107], v165 offset:11584
  v_mfma_f32_32x32x16_bf16 v[32:47], v[88:91], v[136:139], v[32:47]
  ds_read_b64_tr_b16 v[108:109], v165 offset:10368
  ds_read_b64_tr_b16 v[110:111], v165 offset:11648
  ds_read_b64_tr_b16 v[112:113], v165 offset:10432
  v_mfma_f32_32x32x16_bf16 v[48:63], v[92:95], v[136:139], v[48:63]
  ds_read_b64_tr_b16 v[114:115], v165 offset:11712
  ds_read_b64_tr_b16 v[116:117], v165 offset:10496
  ds_read_b64_tr_b16 v[118:119], v165 offset:11776
  v_mfma_f32_32x32x16_bf16 v[64:79], v[96:99], v[136:139], v[64:79]
  s_waitcnt lgkmcnt(0)
  v_mfma_f32_32x32x16_bf16 v[0:15], v[100:103], v[140:143], v[0:15]
  s_add_u32 m0, s47, 0x2800
  s_nop 0
  buffer_load_dwordx4 v160, s[28:31], s51 offen lds
  s_add_u32 m0, s47, 0x2c00
  s_nop 0
  buffer_load_dwordx4 v161, s[28:31], s51 offen lds
  s_add_u32 m0, s47, 0x3000
  s_nop 0
  buffer_load_dwordx4 v162, s[28:31], s51 offen lds
  s_add_u32 m0, s47, 0x3400
  s_nop 0
  buffer_load_dwordx4 v163, s[28:31], s51 offen lds
  s_add_u32 m0, s47, 0x3800
  s_nop 0
  buffer_load_dwordx4 v164, s[28:31], s51 offen lds
  s_add_u32 s51, s51, 0x5000
  s_cmp_eq_u32 s51, s53
  s_cselect_b32 s51, s52, s51
  v_mfma_f32_32x32x16_bf16 v[16:31], v[104:107], v[140:143], v[16:31]
  s_waitcnt vmcnt(10)
  ds_read_b64_tr_b16 v[80:81], v165 offset:0
  ds_read_b64_tr_b16 v[82:83], v165 offset:1280
  ds_read_b64_tr_b16 v[84:85], v165 offset:64
  ds_read_b64_tr_b16 v[86:87], v165 offset:1344
  v_mfma_f32_32x32x16_bf16 v[32:47], v[108:111], v[140:143], v[32:47]
  ds_read_b64_tr_b16 v[88:89], v165 offset:128
  ds_read_b64_tr_b16 v[90:91], v165 offset:1408
  ds_read_b64_tr_b16 v[92:93], v165 offset:192
  v_mfma_f32_32x32x16_bf16 v[48:63], v[112:115], v[140:143], v[48:63]
  ds_read_b64_tr_b16 v[94:95], v165 offset:1472
  ds_read_b64_tr_b16 v[96:97], v165 offset:256
  ds_read_b64_tr_b16 v[98:99], v165 offset:1536
  v_mfma_f32_32x32x16_bf16 v[64:79], v[116:119], v[140:143], v[64:79]
  s_waitcnt lgkmcnt(0)
  v_mfma_f32_32x32x16_bf16 v[0:15], v[80:83], v[120:123], v[0:15]
  s_add_u32 m0, s47, 0
  s_add_u32 s65, s58, 0
  s_add_u32 s65, s65, s71
  buffer_load_dwordx4 v166, s[24:27], s65 offen lds
  s_add_u32 m0, s47, 0x400
  s_add_u32 s65, s58, 0x1400
  s_add_u32 s65, s65, s71
  buffer_load_dwordx4 v166, s[24:27], s65 offen lds
  s_add_u32 m0, s47, 0x800
  s_add_u32 s65, s58, 0x2800
  s_add_u32 s65, s65, s71
  buffer_load_dwordx4 v166, s[24:27], s65 offen lds
  s_add_u32 m0, s47, 0xc00
  s_add_u32 s65, s58, 0x3c00
  s_add_u32 s65, s65, s71
  buffer_load_dwordx4 v166, s[24:27], s65 offen lds
  s_add_u32 m0, s47, 0x1000
  s_add_u32 s65, s58, 0x5000
  s_add_u32 s65, s65, s71
  buffer_load_dwordx4 v166, s[24:27], s65 offen lds
  v_mfma_f32_32x32x16_bf16 v[16:31], v[84:87], v[120:123], v[16:31]
  s_waitcnt vmcnt(10)
  ds_read_b64_tr_b16 v[100:101], v165 offset:5120
  ds_read_b64_tr_b16 v[102:103], v165 offset:6400
  ds_read_b64_tr_b16 v[104:105], v165 offset:5184
  ds_read_b64_tr_b16 v[106:107], v165 offset:6464
  v_mfma_f32_32x32x16_bf16 v[32:47], v[88:91], v[120:123], v[32:47]
  ds_read_b64_tr_b16 v[108:109], v165 offset:5248
  ds_read_b64_tr_b16 v[110:111], v165 offset:6528
  ds_read_b64_tr_b16 v[112:113], v165 offset:5312
  v_mfma_f32_32x32x16_bf16 v[48:63], v[92:95], v[120:123], v[48:63]
  ds_read_b64_tr_b16 v[114:115], v165 offset:6592
  ds_read_b64_tr_b16 v[116:117], v165 offset:5376
  ds_read_b64_tr_b16 v[118:119], v165 offset:6656
  v_mfma_f32_32x32x16_bf16 v[64:79], v[96:99], v[120:123], v[64:79]
  s_waitcnt lgkmcnt(0)
  v_mfma_f32_32x32x16_bf16 v[0:15], v[100:103], v[124:127], v[0:15]
  s_add_u32 m0, s47, 0x1400
  s_add_u32 s65, s58, 0x6400
  s_add_u32 s65, s65, s71
  buffer_load_dwordx4 v166, s[24:27], s65 offen lds
  s_add_u32 m0, s47, 0x1800
  s_add_u32 s65, s58, 0x7800
  s_add_u32 s65, s65, s71
  buffer_load_dwordx4 v166, s[24:27], s65 offen lds
  s_add_u32 m0, s47, 0x1c00
  s_add_u32 s65, s58, 0x8c00
  s_add_u32 s65, s65, s71
  buffer_load_dwordx4 v166, s[24:27], s65 offen lds
  s_add_u32 m0, s47, 0x2000
  s_add_u32 s65, s59, 0
  s_add_u32 s65, s65, s71
  buffer_load_dwordx4 v166, s[24:27], s65 offen lds
  s_add_u32 m0, s47, 0x2400
  s_add_u32 s65, s59, 0x1400
  s_add_u32 s65, s65, s71
  buffer_load_dwordx4 v166, s[24:27], s65 offen lds
  v_mfma_f32_32x32x16_bf16 v[16:31], v[104:107], v[124:127], v[16:31]
  s_waitcnt vmcnt(10)
  ds_read_b64_tr_b16 v[80:81], v165 offset:10240
  ds_read_b64_tr_b16 v[82:83], v165 offset:11520
  ds_read_b64_tr_b16 v[84:85], v165 offset:10304
  ds_read_b64_tr_b16 v[86:87], v165 offset:11584
  v_mfma_f32_32x32x16_bf16 v[32:47], v[108:111], v[124:127], v[32:47]
  ds_read_b64_tr_b16 v[88:89], v165 offset:10368
  ds_read_b64_tr_b16 v[90:91], v165 offset:11648
  ds_read_b64_tr_b16 v[92:93], v165 offset:10432
  v_mfma_f32_32x32x16_bf16 v[48:63], v[112:115], v[124:127], v[48:63]
  ds_read_b64_tr_b16 v[94:95], v165 offset:11712
  ds_read_b64_tr_b16 v[96:97], v165 offset:10496
  ds_read_b64_tr_b16 v[98:99], v165 offset:11776
  v_mfma_f32_32x32x16_bf16 v[64:79], v[116:119], v[124:127], v[64:79]
  s_waitcnt lgkmcnt(0)
  v_mfma_f32_32x32x16_bf16 v[0:15], v[80:83], v[128:131], v[0:15]
  s_add_u32 m0, s47, 0x2800
  s_add_u32 s65, s58, 0
  s_add_u32 s65, s65, s73
  buffer_load_dwordx4 v166, s[24:27], s65 offen lds
  s_add_u32 m0, s47, 0x2c00
  s_add_u32 s65, s58, 0x1400
  s_add_u32 s65, s65, s73
  buffer_load_dwordx4 v166, s[24:27], s65 offen lds
  s_add_u32 m0, s47, 0x3000
  s_add_u32 s65, s58, 0x2800
  s_add_u32 s65, s65, s73
  buffer_load_dwordx4 v166, s[24:27], s65 offen lds
  s_add_u32 m0, s47, 0x3400
  s_add_u32 s65, s58, 0x3c00
  s_add_u32 s65, s65, s73
  buffer_load_dwordx4 v166, s[24:27], s65 offen lds
  s_add_u32 m0, s47, 0x3800
  s_add_u32 s65, s58, 0x5000
  s_add_u32 s65, s65, s73
  buffer_load_dwordx4 v166, s[24:27], s65 offen lds
  v_mfma_f32_32x32x16_bf16 v[16:31], v[84:87], v[128:131], v[16:31]
  v_mfma_f32_32x32x16_bf16 v[32:47], v[88:91], v[128:131], v[32:47]
  v_mfma_f32_32x32x16_bf16 v[48:63], v[92:95], v[128:131], v[48:63]
  v_mfma_f32_32x32x16_bf16 v[64:79], v[96:99], v[128:131], v[64:79]
  s_setprio 3
  s_add_u32 s65, s58, 0
  s_add_u32 s65, s65, s75
  buffer_load_dwordx4 v[80:83], v166, s[24:27], s65 offen
  s_add_u32 s65, s58, 0x1400
  s_add_u32 s65, s65, s75
  buffer_load_dwordx4 v[84:87], v166, s[24:27], s65 offen
  s_add_u32 s65, s58, 0x2800
  s_add_u32 s65, s65, s75
  buffer_load_dwordx4 v[88:91], v166, s[24:27], s65 offen
  s_add_u32 s65, s58, 0x3c00
  s_add_u32 s65, s65, s75
  buffer_load_dwordx4 v[92:95], v166, s[24:27], s65 offen
  s_add_u32 s65, s58, 0x5000
  s_add_u32 s65, s65, s75
  buffer_load_dwordx4 v[96:99], v166, s[24:27], s65 offen
  s_add_u32 s65, s58, 0x6400
  s_add_u32 s65, s65, s75
  buffer_load_dwordx4 v[100:103], v166, s[24:27], s65 offen
  s_add_u32 s65, s58, 0x7800
  s_add_u32 s65, s65, s75
  buffer_load_dwordx4 v[104:107], v166, s[24:27], s65 offen
  s_add_u32 s65, s58, 0x8c00
  s_add_u32 s65, s65, s75
  buffer_load_dwordx4 v[108:111], v166, s[24:27], s65 offen
  s_add_u32 s65, s59, 0
  s_add_u32 s65, s65, s75
  buffer_load_dwordx4 v[112:115], v166, s[24:27], s65 offen
  s_add_u32 s65, s59, 0x1400
  s_add_u32 s65, s65, s75
  buffer_load_dwordx4 v[116:119], v166, s[24:27], s65 offen
  s_add_u32 s65, s59, 0x1400
  s_add_u32 s65, s65, s74
  buffer_load_dwordx4 v[160:163], v166, s[24:27], s65 offen
  v_add_u32 v165, s47, v166
  v_add_u32 v164, s56, v166
  v_and_b32 v144, 31, v167
  v_mul_u32_u24 v144, 0x500, v144
  v_lshrrev_b32 v145, 5, v167
  v_lshl_add_u32 v148, v145, 4, v144
  s_lshl_b32 s62, s44, 6
  s_add_u32 s62, s62, s57
  buffer_load_dwordx4 v[120:123], v148, s[36:39], s62 offen offset:0
  buffer_load_dwordx4 v[128:131], v148, s[8:11], s57 offen offset:256
  buffer_load_dwordx4 v[124:127], v148, s[36:39], s62 offen offset:32
  buffer_load_dwordx4 v[132:135], v148, s[8:11], s57 offen offset:288
  s_waitcnt vmcnt(3)
  v_lshlrev_b32 v144, 16, v120
  v_and_b32 v145, 0xffff0000, v120
  v_add_f32 v48, v48, v144
  v_add_f32 v49, v49, v145
  v_lshlrev_b32 v144, 16, v121
  v_and_b32 v145, 0xffff0000, v121
  v_add_f32 v50, v50, v144
  v_add_f32 v51, v51, v145
  v_lshlrev_b32 v144, 16, v122
  v_and_b32 v145, 0xffff0000, v122
  v_add_f32 v52, v52, v144
  v_add_f32 v53, v53, v145
  v_lshlrev_b32 v144, 16, v123
  v_and_b32 v145, 0xffff0000, v123
  v_add_f32 v54, v54, v144
  v_add_f32 v55, v55, v145
  s_waitcnt vmcnt(1)
  v_lshlrev_b32 v144, 16, v124
  v_and_b32 v145, 0xffff0000, v124
  v_add_f32 v56, v56, v144
  v_add_f32 v57, v57, v145
  v_lshlrev_b32 v144, 16, v125
  v_and_b32 v145, 0xffff0000, v125
  v_add_f32 v58, v58, v144
  v_add_f32 v59, v59, v145
  v_lshlrev_b32 v144, 16, v126
  v_and_b32 v145, 0xffff0000, v126
  v_add_f32 v60, v60, v144
  v_add_f32 v61, v61, v145
  v_lshlrev_b32 v144, 16, v127
  v_and_b32 v145, 0xffff0000, v127
  v_add_f32 v62, v62, v144
  v_add_f32 v63, v63, v145
  v_lshlrev_b32 v144, 16, v128
  v_and_b32 v145, 0xffff0000, v128
  v_add_f32 v64, v64, v144
  v_add_f32 v65, v65, v145
  v_lshlrev_b32 v144, 16, v129
  v_and_b32 v145, 0xffff0000, v129
  v_add_f32 v66, v66, v144
  v_add_f32 v67, v67, v145
  v_lshlrev_b32 v144, 16, v130
  v_and_b32 v145, 0xffff0000, v130
  v_add_f32 v68, v68, v144
  v_add_f32 v69, v69, v145
  v_lshlrev_b32 v144, 16, v131
  v_and_b32 v145, 0xffff0000, v131
  v_add_f32 v70, v70, v144
  v_add_f32 v71, v71, v145
  s_waitcnt vmcnt(0)
  v_lshlrev_b32 v144, 16, v132
  v_and_b32 v145, 0xffff0000, v132
  v_add_f32 v72, v72, v144
  v_add_f32 v73, v73, v145
  v_lshlrev_b32 v144, 16, v133
  v_and_b32 v145, 0xffff0000, v133
  v_add_f32 v74, v74, v144
  v_add_f32 v75, v75, v145
  v_lshlrev_b32 v144, 16, v134
  v_and_b32 v145, 0xffff0000, v134
  v_add_f32 v76, v76, v144
  v_add_f32 v77, v77, v145
  v_lshlrev_b32 v144, 16, v135
  v_and_b32 v145, 0xffff0000, v135
  v_add_f32 v78, v78, v144
  v_add_f32 v79, v79, v145
  s_mov_b32 s69, 0x40000
  s_branch k2_gw1e
k2_gw1:
  s_sleep 16
k2_gw1e:
  v_mov_b32 v167, 0x18000
  ds_read_b32 v167, v167
  s_waitcnt lgkmcnt(0)
  s_nop 0
  s_waitcnt lgkmcnt(0)
  v_readfirstlane_b32 s67, v167
  s_sub_u32 s69, s69, 1
  s_cbranch_scc1 k2_gw1d
  s_cmp_lt_u32 s67, 56
  s_cbranch_scc1 k2_gw1
k2_gw1d:
  s_add_u32 m0, s56, 0
  s_add_u32 s65, s58, 0
  s_add_u32 s65, s65, s72
  buffer_load_dwordx4 v166, s[24:27], s65 offen lds
  s_add_u32 m0, s56, 0x400
  s_add_u32 s65, s58, 0x1400
  s_add_u32 s65, s65, s72
  buffer_load_dwordx4 v166, s[24:27], s65 offen lds
  s_add_u32 m0, s56, 0x800
  s_add_u32 s65, s58, 0x2800
  s_add_u32 s65, s65, s72
  buffer_load_dwordx4 v166, s[24:27], s65 offen lds
  s_add_u32 m0, s56, 0xc00
  s_add_u32 s65, s58, 0x3c00
  s_add_u32 s65, s65, s72
  buffer_load_dwordx4 v166, s[24:27], s65 offen lds
  s_add_u32 m0, s56, 0x1000
  s_add_u32 s65, s58, 0x5000
  s_add_u32 s65, s65, s72
  buffer_load_dwordx4 v166, s[24:27], s65 offen lds
  s_add_u32 m0, s56, 0x1400
  s_add_u32 s65, s58, 0x6400
  s_add_u32 s65, s65, s72
  buffer_load_dwordx4 v166, s[24:27], s65 offen lds
  s_add_u32 m0, s56, 0x1800
  s_add_u32 s65, s58, 0x7800
  s_add_u32 s65, s65, s72
  buffer_load_dwordx4 v166, s[24:27], s65 offen lds
  s_add_u32 m0, s56, 0x1c00
  s_add_u32 s65, s58, 0x8c00
  s_add_u32 s65, s65, s72
  buffer_load_dwordx4 v166, s[24:27], s65 offen lds
  s_add_u32 m0, s56, 0x2000
  s_add_u32 s65, s59, 0
  s_add_u32 s65, s65, s72
  buffer_load_dwordx4 v166, s[24:27], s65 offen lds
  s_add_u32 m0, s56, 0x2400
  s_add_u32 s65, s59, 0x1400
  s_add_u32 s65, s65, s72
  buffer_load_dwordx4 v166, s[24:27], s65 offen lds
  s_add_u32 m0, s56, 0x2800
  s_add_u32 s65, s58, 0x6400
  s_add_u32 s65, s65, s73
  buffer_load_dwordx4 v166, s[24:27], s65 offen lds
  s_add_u32 m0, s56, 0x2c00
  s_add_u32 s65, s58, 0x7800
  s_add_u32 s65, s65, s73
  buffer_load_dwordx4 v166, s[24:27], s65 offen lds
  s_sub_u32 s28, s44, 1
  s_and_b32 s28, s28, 3
  s_mul_i32 s28, s28, 0x3c00
  s_add_u32 s28, s28, 0x1a000
  s_sub_u32 s29, s44, 2
  s_and_b32 s29, s29, 3
  s_mul_i32 s29, s29, 0x3000
  s_add_u32 s29, s29, 0
  s_sub_u32 s30, s44, 3
  s_and_b32 s30, s30, 3
  s_mul_i32 s30, s30, 0x3000
  s_add_u32 s30, s30, 0x1000
  s_lshl_b32 s31, s44, 10
  s_add_u32 s31, s31, 0x19000
  s_lshl_b32 s32, s44, 6
  s_add_u32 s32, s32, s57
  s_lshr_b32 s33, s44, 1
  s_lshl_b32 s33, s33, 5
  s_and_b32 s64, s44, 1
  s_lshl_b32 s64, s64, 3
  s_add_u32 s33, s33, s64
  s_add_u32 s33, s33, s57
  s_lshl_b32 s49, s44, 2
  s_add_u32 s49, s49, 0x18010
  s_mov_b32 s69, 0x40000
  s_branch k2_gw2e
k2_gw2:
  s_sleep 8
k2_gw2e:
  v_mov_b32 v167, 0x18000
  ds_read_b32 v167, v167
  s_waitcnt lgkmcnt(0)
  s_nop 0
  s_waitcnt lgkmcnt(0)
  v_readfirstlane_b32 s67, v167
  s_sub_u32 s69, s69, 1
  s_cbranch_scc1 k2_gw2d
  s_cmp_lt_u32 s67, 64
  s_cbranch_scc1 k2_gw2
k2_gw2d:
  s_mov_b32 s69, 0x40000
  s_sleep 16
  s_branch k2_gw3e
k2_gw3:
  s_sleep 2
k2_gw3e:
  v_mov_b32 v167, 0x18004
  ds_read_b32 v167, v167
  s_waitcnt lgkmcnt(0)
  s_nop 0
  s_waitcnt lgkmcnt(0)
  v_readfirstlane_b32 s67, v167
  s_sub_u32 s69, s69, 1
  s_cbranch_scc1 k2_gw3d
  s_cmp_lt_u32 s67, 8
  s_cbranch_scc1 k2_gw3
k2_gw3d:
  s_mov_b32 s69, 0x10000
  s_mov_b32 s68, 0
  s_sleep 5
  s_add_u32 s60, s54, 0
  buffer_load_dwordx4 v[120:123], v166, s[24:27], s60 offen sc1
  s_add_u32 s60, s54, 0x400
  buffer_load_dwordx4 v[124:127], v166, s[24:27], s60 offen sc1
  s_add_u32 s60, s54, 0x800
  buffer_load_dwordx4 v[128:131], v166, s[24:27], s60 offen sc1
  s_add_u32 s60, s54, 0xc00
  buffer_load_dwordx4 v[132:135], v166, s[24:27], s60 offen sc1
  s_add_u32 s60, s55, 0
  buffer_load_dwordx4 v[152:155], v166, s[24:27], s60 offen sc1
  s_add_u32 s60, s54, 0x1000
  buffer_load_dwordx4 v[136:139], v166, s[24:27], s60 offen sc1
  s_add_u32 s60, s54, 0x1400
  buffer_load_dwordx4 v[140:143], v166, s[24:27], s60 offen sc1
  s_add_u32 s60, s54, 0x1800
  buffer_load_dwordx4 v[144:147], v166, s[24:27], s60 offen sc1
  s_add_u32 s60, s54, 0x1c00
  buffer_load_dwordx4 v[148:151], v166, s[24:27], s60 offen sc1
  s_add_u32 s60, s55, 0x400
  buffer_load_dwordx4 v[156:159], v166, s[24:27], s60 offen sc1
  s_mov_b32 s68, 0x10f
  s_waitcnt vmcnt(5)
  v_max3_u32 v167, v120, v121, v122
  v_max3_u32 v167, v167, v123, v124
  v_max3_u32 v167, v167, v125, v126
  v_max3_u32 v167, v167, v127, v128
  v_max3_u32 v167, v167, v129, v130
  v_max3_u32 v167, v167, v131, v132
  v_max3_u32 v167, v167, v133, v134
  v_max3_u32 v167, v167, v135, v152
  v_max3_u32 v167, v167, v153, v154
  v_max_u32 v167, v167, v155
  v_cmp_eq_u32 vcc, -1, v167
  s_nop 0
  s_cmp_eq_u64 vcc, 0
  s_cbranch_scc1 k2_opd
  s_mov_b32 s68, 0
k2_op:
  s_waitcnt vmcnt(0)
  v_max3_u32 v167, v120, v121, v122
  v_max_u32 v167, v167, v123
  v_cmp_eq_u32 s[4:5], -1, v167
  v_max3_u32 v167, v124, v125, v126
  v_max_u32 v167, v167, v127
  v_cmp_eq_u32 s[6:7], -1, v167
  v_max3_u32 v167, v128, v129, v130
  v_max_u32 v167, v167, v131
  v_cmp_eq_u32 s[12:13], -1, v167
  v_max3_u32 v167, v132, v133, v134
  v_max_u32 v167, v167, v135
  v_cmp_eq_u32 s[14:15], -1, v167
  v_max3_u32 v167, v136, v137, v138
  v_max_u32 v167, v167, v139
  v_cmp_eq_u32 s[16:17], -1, v167
  v_max3_u32 v167, v140, v141, v142
  v_max_u32 v167, v167, v143
  v_cmp_eq_u32 s[18:19], -1, v167
  v_max3_u32 v167, v144, v145, v146
  v_max_u32 v167, v167, v147
  v_cmp_eq_u32 s[20:21], -1, v167
  v_max3_u32 v167, v148, v149, v150
  v_max_u32 v167, v167, v151
  v_cmp_eq_u32 s[78:79], -1, v167
  v_max3_u32 v167, v152, v153, v154
  v_max_u32 v167, v167, v155
  v_cmp_eq_u32 s[34:35], -1, v167
  v_max3_u32 v167, v156, v157, v158
  v_max_u32 v167, v167, v159
  v_cmp_eq_u32 s[76:77], -1, v167
  s_cmp_eq_u64 s[4:5], 0
  s_cbranch_scc1 k2_op0
  s_add_u32 s60, s54, 0
  buffer_load_dwordx4 v[120:123], v166, s[24:27], s60 offen sc1
k2_op0:
  s_cmp_eq_u64 s[6:7], 0
  s_cbranch_scc1 k2_op1
  s_add_u32 s60, s54, 0x400
  buffer_load_dwordx4 v[124:127], v166, s[24:27], s60 offen sc1
k2_op1:
  s_cmp_eq_u64 s[12:13], 0
  s_cbranch_scc1 k2_op2
  s_add_u32 s60, s54, 0x800
  buffer_load_dwordx4 v[128:131], v166, s[24:27], s60 offen sc1
k2_op2:
  s_cmp_eq_u64 s[14:15], 0
  s_cbranch_scc1 k2_op3
  s_add_u32 s60, s54, 0xc00
  buffer_load_dwordx4 v[132:135], v166, s[24:27], s60 offen sc1
k2_op3:
  s_cmp_eq_u64 s[16:17], 0
  s_cbranch_scc1 k2_op4
  s_add_u32 s60, s54, 0x1000
  buffer_load_dwordx4 v[136:139], v166, s[24:27], s60 offen sc1
k2_op4:
  s_cmp_eq_u64 s[18:19], 0
  s_cbranch_scc1 k2_op5
  s_add_u32 s60, s54, 0x1400
  buffer_load_dwordx4 v[140:143], v166, s[24:27], s60 offen sc1
k2_op5:
  s_cmp_eq_u64 s[20:21], 0
  s_cbranch_scc1 k2_op6
  s_add_u32 s60, s54, 0x1800
  buffer_load_dwordx4 v[144:147], v166, s[24:27], s60 offen sc1
k2_op6:
  s_cmp_eq_u64 s[78:79], 0
  s_cbranch_scc1 k2_op7
  s_add_u32 s60, s54, 0x1c00
  buffer_load_dwordx4 v[148:151], v166, s[24:27], s60 offen sc1
k2_op7:
  s_cmp_eq_u64 s[34:35], 0
  s_cbranch_scc1 k2_op8
  s_add_u32 s60, s55, 0
  buffer_load_dwordx4 v[152:155], v166, s[24:27], s60 offen sc1
k2_op8:
  s_cmp_eq_u64 s[76:77], 0
  s_cbranch_scc1 k2_op9
  s_add_u32 s60, s55, 0x400
  buffer_load_dwordx4 v[156:159], v166, s[24:27], s60 offen sc1
k2_op9:
  s_sub_u32 s69, s69, 1
  s_cbranch_scc1 k2_opd
  s_or_b64 s[4:5], s[4:5], s[6:7]
  s_or_b64 s[12:13], s[12:13], s[14:15]
  s_or_b64 s[4:5], s[4:5], s[34:35]
  s_or_b64 s[4:5], s[4:5], s[12:13]
  s_cbranch_scc0 k2_opd
  s_or_b64 s[16:17], s[16:17], s[18:19]
  s_or_b64 s[20:21], s[20:21], s[78:79]
  s_or_b64 s[16:17], s[16:17], s[76:77]
  s_or_b64 s[16:17], s[16:17], s[20:21]
  s_cbranch_scc0 k2_wo1
  s_sleep 2
  s_branch k2_op
k2_opd:
k2_wo0:
  v_mfma_f32_32x32x16_bf16 v[64:79], v[80:83], v[120:123], v[64:79]
  ds_read_b128 v[80:83], v165 offset:0
  v_mfma_f32_32x32x16_bf16 v[64:79], v[84:87], v[124:127], v[64:79]
  ds_read_b128 v[84:87], v165 offset:1024
  v_mfma_f32_32x32x16_bf16 v[64:79], v[88:91], v[128:131], v[64:79]
  ds_read_b128 v[88:91], v165 offset:2048
  v_mfma_f32_32x32x16_bf16 v[64:79], v[92:95], v[132:135], v[64:79]
  ds_read_b128 v[92:95], v165 offset:3072
  v_mfma_f32_32x32x16_bf16 v[64:79], v[112:115], v[152:155], v[64:79]
  ds_read_b128 v[112:115], v165 offset:8192
  s_waitcnt lgkmcnt(4)
  v_mfma_f32_32x32x16_bf16 v[0:15], v[80:83], v[120:123], v[0:15]
  ds_read_b128 v[80:83], v164 offset:0
  s_waitcnt lgkmcnt(4)
  v_mfma_f32_32x32x16_bf16 v[0:15], v[84:87], v[124:127], v[0:15]
  ds_read_b128 v[84:87], v164 offset:1024
  s_waitcnt lgkmcnt(4)
  v_mfma_f32_32x32x16_bf16 v[0:15], v[88:91], v[128:131], v[0:15]
  ds_read_b128 v[88:91], v164 offset:2048
  s_waitcnt lgkmcnt(4)
  v_mfma_f32_32x32x16_bf16 v[0:15], v[92:95], v[132:135], v[0:15]
  ds_read_b128 v[92:95], v164 offset:3072
  s_waitcnt lgkmcnt(4)
  v_mfma_f32_32x32x16_bf16 v[0:15], v[112:115], v[152:155], v[0:15]
  ds_read_b128 v[112:115], v164 offset:8192
  s_waitcnt lgkmcnt(4)
  v_mfma_f32_32x32x16_bf16 v[16:31], v[80:83], v[120:123], v[16:31]
  ds_read_b128 v[80:83], v165 offset:10240
  s_waitcnt lgkmcnt(4)
  v_mfma_f32_32x32x16_bf16 v[16:31], v[84:87], v[124:127], v[16:31]
  v_mov_b32 v167, s49
  ds_read_b128 v[84:87], v165 offset:11264
  s_waitcnt lgkmcnt(4)
  v_mfma_f32_32x32x16_bf16 v[16:31], v[88:91], v[128:131], v[16:31]
  ds_read_b32 v167, v167
  ds_read_b128 v[88:91], v165 offset:12288
  s_waitcnt lgkmcnt(5)
  v_mfma_f32_32x32x16_bf16 v[16:31], v[92:95], v[132:135], v[16:31]
  ds_read_b128 v[92:95], v165 offset:13312
  s_waitcnt lgkmcnt(5)
  v_mfma_f32_32x32x16_bf16 v[16:31], v[112:115], v[152:155], v[16:31]
  s_waitcnt lgkmcnt(2)
  v_readfirstlane_b32 s60, v167
  s_nop 0
  s_cmp_lt_u32 s60, 2
  s_cbranch_scc1 k2_ws0
k2_ws0d:
  ds_read_b128 v[112:115], v164 offset:50176
  v_mfma_f32_32x32x16_bf16 v[32:47], v[80:83], v[120:123], v[32:47]
  s_waitcnt vmcnt(0)
  v_max3_u32 v167, v136, v137, v138
  ds_read_b128 v[80:83], v164 offset:52224
  v_mfma_f32_32x32x16_bf16 v[32:47], v[84:87], v[124:127], v[32:47]
  v_max3_u32 v167, v167, v139, v140
  ds_read_b128 v[84:87], v164 offset:54272
  s_waitcnt lgkmcnt(4)
  v_mfma_f32_32x32x16_bf16 v[32:47], v[88:91], v[128:131], v[32:47]
  v_max3_u32 v167, v167, v141, v142
  ds_read_b128 v[88:91], v164 offset:56320
  s_waitcnt lgkmcnt(4)
  v_mfma_f32_32x32x16_bf16 v[32:47], v[92:95], v[132:135], v[32:47]
  v_max3_u32 v167, v167, v143, v144
  ds_read_b128 v[92:95], v164 offset:58368
  s_waitcnt lgkmcnt(4)
  v_mfma_f32_32x32x16_bf16 v[32:47], v[112:115], v[152:155], v[32:47]
  v_max3_u32 v167, v167, v145, v146
  ds_read_b128 v[112:115], v164 offset:60416
  s_waitcnt lgkmcnt(4)
  v_mfma_f32_32x32x16_bf16 v[48:63], v[80:83], v[120:123], v[48:63]
  v_max3_u32 v167, v167, v147, v148
  ds_read_b128 v[80:83], v165 offset:4096
  s_waitcnt lgkmcnt(4)
  v_mfma_f32_32x32x16_bf16 v[48:63], v[84:87], v[124:127], v[48:63]
  v_max3_u32 v167, v167, v149, v150
  ds_read_b128 v[84:87], v165 offset:5120
  s_waitcnt lgkmcnt(4)
  v_mfma_f32_32x32x16_bf16 v[48:63], v[88:91], v[128:131], v[48:63]
  v_max3_u32 v167, v167, v151, v156
  ds_read_b128 v[88:91], v165 offset:6144
  s_waitcnt lgkmcnt(4)
  v_mfma_f32_32x32x16_bf16 v[48:63], v[92:95], v[132:135], v[48:63]
  v_max3_u32 v167, v167, v157, v158
  ds_read_b128 v[92:95], v165 offset:7168
  s_waitcnt lgkmcnt(4)
  v_mfma_f32_32x32x16_bf16 v[48:63], v[112:115], v[152:155], v[48:63]
  v_max_u32 v167, v167, v159
  ds_read_b128 v[112:115], v165 offset:9216
  v_cmp_eq_u32 vcc, -1, v167
  s_nop 0
  s_cmp_eq_u64 vcc, 0
  s_cbranch_scc1 k2_q0d
k2_q0:
  s_waitcnt vmcnt(0)
  v_max3_u32 v167, v136, v137, v138
  v_max_u32 v167, v167, v139
  v_cmp_eq_u32 s[16:17], -1, v167
  v_max3_u32 v167, v140, v141, v142
  v_max_u32 v167, v167, v143
  v_cmp_eq_u32 s[18:19], -1, v167
  v_max3_u32 v167, v144, v145, v146
  v_max_u32 v167, v167, v147
  v_cmp_eq_u32 s[20:21], -1, v167
  v_max3_u32 v167, v148, v149, v150
  v_max_u32 v167, v167, v151
  v_cmp_eq_u32 s[78:79], -1, v167
  v_max3_u32 v167, v156, v157, v158
  v_max_u32 v167, v167, v159
  v_cmp_eq_u32 s[76:77], -1, v167
  s_cmp_eq_u64 s[16:17], 0
  s_cbranch_scc1 k2_q04
  s_add_u32 s60, s54, 0x1000
  buffer_load_dwordx4 v[136:139], v166, s[24:27], s60 offen sc1
k2_q04:
  s_cmp_eq_u64 s[18:19], 0
  s_cbranch_scc1 k2_q05
  s_add_u32 s60, s54, 0x1400
  buffer_load_dwordx4 v[140:143], v166, s[24:27], s60 offen sc1
k2_q05:
  s_cmp_eq_u64 s[20:21], 0
  s_cbranch_scc1 k2_q06
  s_add_u32 s60, s54, 0x1800
  buffer_load_dwordx4 v[144:147], v166, s[24:27], s60 offen sc1
k2_q06:
  s_cmp_eq_u64 s[78:79], 0
  s_cbranch_scc1 k2_q07
  s_add_u32 s60, s54, 0x1c00
  buffer_load_dwordx4 v[148:151], v166, s[24:27], s60 offen sc1
k2_q07:
  s_cmp_eq_u64 s[76:77], 0
  s_cbranch_scc1 k2_q09
  s_add_u32 s60, s55, 0x400
  buffer_load_dwordx4 v[156:159], v166, s[24:27], s60 offen sc1
k2_q09:
  s_sub_u32 s69, s69, 1
  s_cbranch_scc1 k2_q0d
  s_or_b64 s[16:17], s[16:17], s[18:19]
  s_or_b64 s[20:21], s[20:21], s[78:79]
  s_or_b64 s[16:17], s[16:17], s[76:77]
  s_or_b64 s[16:17], s[16:17], s[20:21]
  s_cbranch_scc0 k2_q0d
  s_sleep 2
  s_branch k2_q0
k2_q0d:
  v_mfma_f32_32x32x16_bf16 v[64:79], v[96:99], v[136:139], v[64:79]
  ds_read_b128 v[96:99], v164 offset:4096
  v_mfma_f32_32x32x16_bf16 v[64:79], v[100:103], v[140:143], v[64:79]
  ds_read_b128 v[100:103], v164 offset:5120
  v_bfe_u32 v167, v166, 4, 5
  v_mul_u32_u24 v167, 0x50, v167
  v_mfma_f32_32x32x16_bf16 v[64:79], v[104:107], v[144:147], v[64:79]
  ds_read_b128 v[104:107], v164 offset:6144
  v_lshlrev_b32 v167, 4, v167
  v_cmp_lt_u32 vcc, 0x1ff, v166
  v_mfma_f32_32x32x16_bf16 v[64:79], v[108:111], v[148:151], v[64:79]
  ds_read_b128 v[108:111], v164 offset:7168
  v_mfma_f32_32x32x16_bf16 v[64:79], v[116:119], v[156:159], v[64:79]
  ds_read_b128 v[116:119], v164 offset:9216
  s_mov_b64 exec, vcc
  v_add_u32 v167, 16, v167
  s_mov_b64 exec, -1
  s_waitcnt lgkmcnt(9)
  v_mfma_f32_32x32x16_bf16 v[0:15], v[80:83], v[136:139], v[0:15]
  ds_read_b128 v[80:83], v165 offset:14336
  s_waitcnt lgkmcnt(9)
  v_mfma_f32_32x32x16_bf16 v[0:15], v[84:87], v[140:143], v[0:15]
  ds_read_b128 v[84:87], v164 offset:10240
  s_waitcnt lgkmcnt(9)
  v_mfma_f32_32x32x16_bf16 v[0:15], v[88:91], v[144:147], v[0:15]
  ds_read_b128 v[88:91], v164 offset:11264
  ds_write_b128 v165, v[64:67] offset:0
  ds_write_b128 v165, v[68:71] offset:1024
  ds_write_b128 v165, v[72:75] offset:2048
  ds_write_b128 v165, v[76:79] offset:3072
  s_waitcnt lgkmcnt(13)
  v_mfma_f32_32x32x16_bf16 v[0:15], v[92:95], v[148:151], v[0:15]
  ds_read_b128 v[92:95], v164 offset:49152
  s_waitcnt lgkmcnt(13)
  v_mfma_f32_32x32x16_bf16 v[0:15], v[112:115], v[156:159], v[0:15]
  ds_read_b128 v[112:115], v164 offset:51200
  s_waitcnt lgkmcnt(13)
  v_mfma_f32_32x32x16_bf16 v[16:31], v[96:99], v[136:139], v[16:31]
  ds_read_b128 v[96:99], v164 offset:53248
  s_waitcnt lgkmcnt(13)
  v_mfma_f32_32x32x16_bf16 v[16:31], v[100:103], v[140:143], v[16:31]
  ds_read_b128 v[100:103], v164 offset:55296
  s_waitcnt lgkmcnt(13)
  v_mfma_f32_32x32x16_bf16 v[16:31], v[104:107], v[144:147], v[16:31]
  ds_read_b128 v[104:107], v164 offset:57344
  s_nop 1
  ds_write_b128 v165, v[0:3] offset:4096
  ds_write_b128 v165, v[4:7] offset:5120
  ds_write_b128 v165, v[8:11] offset:6144
  ds_write_b128 v165, v[12:15] offset:7168
  s_waitcnt lgkmcnt(15)
  v_mfma_f32_32x32x16_bf16 v[16:31], v[108:111], v[148:151], v[16:31]
  ds_read_b128 v[108:111], v164 offset:59392
  v_mfma_f32_32x32x16_bf16 v[16:31], v[116:119], v[156:159], v[16:31]
  s_waitcnt lgkmcnt(0)
  v_add_u32 v79, s31, v166
  v_add_u32 v15, s28, v166
  s_barrier
  v_mfma_f32_32x32x16_bf16 v[32:47], v[80:83], v[136:139], v[32:47]
  ds_read_b128 v[64:67], v79 offset:0
  ds_read_b128 v[68:71], v79 offset:15360
  ds_read_b128 v[72:75], v79 offset:30720
  ds_read_b128 v[76:79], v79 offset:46080
  v_mfma_f32_32x32x16_bf16 v[32:47], v[84:87], v[140:143], v[32:47]
  ds_read_b128 v[0:3], v15 offset:0
  ds_read_b128 v[4:7], v15 offset:1024
  ds_read_b128 v[8:11], v15 offset:2048
  ds_read_b128 v[12:15], v15 offset:3072
  v_mfma_f32_32x32x16_bf16 v[32:47], v[88:91], v[144:147], v[32:47]
  ds_write_b128 v164, v[16:19] offset:0
  ds_write_b128 v164, v[20:23] offset:1024
  ds_write_b128 v164, v[24:27] offset:2048
  ds_write_b128 v164, v[28:31] offset:3072
  v_mfma_f32_32x32x16_bf16 v[32:47], v[92:95], v[148:151], v[32:47]
  v_mfma_f32_32x32x16_bf16 v[32:47], v[112:115], v[156:159], v[32:47]
  s_waitcnt lgkmcnt(10)
  v_add_f32 v64, v64, v68
  v_add_f32 v65, v65, v69
  v_add_f32 v66, v66, v70
  v_add_f32 v67, v67, v71
  s_waitcnt lgkmcnt(8)
  v_add_f32 v72, v72, v76
  v_add_f32 v73, v73, v77
  v_add_f32 v74, v74, v78
  v_add_f32 v75, v75, v79
  v_mfma_f32_32x32x16_bf16 v[48:63], v[96:99], v[136:139], v[48:63]
  v_add_f32 v64, v64, v72
  v_add_f32 v65, v65, v73
  v_add_f32 v66, v66, v74
  v_add_f32 v67, v67, v75
  v_cvt_pk_bf16_f32 v64, v64, v65
  v_cvt_pk_bf16_f32 v65, v66, v67
  buffer_store_dwordx2 v[64:65], v167, s[40:43], s33 offen offset:256
  v_mfma_f32_32x32x16_bf16 v[48:63], v[100:103], v[140:143], v[48:63]
  v_mfma_f32_32x32x16_bf16 v[48:63], v[104:107], v[144:147], v[48:63]
  ds_write_b128 v164, v[32:35] offset:4096
  ds_write_b128 v164, v[36:39] offset:5120
  ds_write_b128 v164, v[40:43] offset:6144
  ds_write_b128 v164, v[44:47] offset:7168
  v_mfma_f32_32x32x16_bf16 v[48:63], v[108:111], v[148:151], v[48:63]
  s_waitcnt lgkmcnt(0)
  v_add_u32 v31, s29, v166
  v_add_u32 v47, s30, v166
  s_barrier
  ds_read_b128 v[16:19], v31 offset:0
  ds_read_b128 v[20:23], v31 offset:1024
  ds_read_b128 v[24:27], v31 offset:2048
  ds_read_b128 v[28:31], v31 offset:3072
  ds_read_b128 v[32:35], v47 offset:0
  ds_read_b128 v[36:39], v47 offset:1024
  ds_read_b128 v[40:43], v47 offset:2048
  ds_read_b128 v[44:47], v47 offset:3072
  v_mfma_f32_32x32x16_bf16 v[48:63], v[160:163], v[156:159], v[48:63]
  s_nop 11
  v_pk_add_f32 v[0:1], v[0:1], v[48:49]
  v_pk_add_f32 v[2:3], v[2:3], v[50:51]
  v_pk_add_f32 v[4:5], v[4:5], v[52:53]
  v_pk_add_f32 v[6:7], v[6:7], v[54:55]
  v_pk_add_f32 v[8:9], v[8:9], v[56:57]
  v_pk_add_f32 v[10:11], v[10:11], v[58:59]
  v_pk_add_f32 v[12:13], v[12:13], v[60:61]
  v_pk_add_f32 v[14:15], v[14:15], v[62:63]
  s_waitcnt lgkmcnt(7)
  v_pk_add_f32 v[0:1], v[0:1], v[16:17]
  v_pk_add_f32 v[2:3], v[2:3], v[18:19]
  s_waitcnt lgkmcnt(6)
  v_pk_add_f32 v[4:5], v[4:5], v[20:21]
  v_pk_add_f32 v[6:7], v[6:7], v[22:23]
  s_waitcnt lgkmcnt(5)
  v_pk_add_f32 v[8:9], v[8:9], v[24:25]
  v_pk_add_f32 v[10:11], v[10:11], v[26:27]
  s_waitcnt lgkmcnt(4)
  v_pk_add_f32 v[12:13], v[12:13], v[28:29]
  v_pk_add_f32 v[14:15], v[14:15], v[30:31]
  s_waitcnt lgkmcnt(3)
  v_pk_add_f32 v[0:1], v[0:1], v[32:33]
  v_pk_add_f32 v[2:3], v[2:3], v[34:35]
  s_waitcnt lgkmcnt(2)
  v_pk_add_f32 v[4:5], v[4:5], v[36:37]
  v_pk_add_f32 v[6:7], v[6:7], v[38:39]
  v_cvt_pk_bf16_f32 v0, v0, v1
  v_cvt_pk_bf16_f32 v1, v2, v3
  v_cvt_pk_bf16_f32 v2, v4, v5
  v_cvt_pk_bf16_f32 v3, v6, v7
  buffer_store_dwordx4 v[0:3], v167, s[40:43], s32 offen offset:0
  s_waitcnt lgkmcnt(1)
  v_pk_add_f32 v[8:9], v[8:9], v[40:41]
  v_pk_add_f32 v[10:11], v[10:11], v[42:43]
  s_waitcnt lgkmcnt(0)
  v_pk_add_f32 v[12:13], v[12:13], v[44:45]
  v_pk_add_f32 v[14:15], v[14:15], v[46:47]
  v_cvt_pk_bf16_f32 v8, v8, v9
  v_cvt_pk_bf16_f32 v9, v10, v11
  v_cvt_pk_bf16_f32 v10, v12, v13
  v_cvt_pk_bf16_f32 v11, v14, v15
  buffer_store_dwordx4 v[8:11], v167, s[40:43], s32 offen offset:32
  s_endpgm
k2_ws0:
  s_mov_b32 s61, 0x400000
k2_ws0_l:
  v_mov_b32 v167, s49
  ds_read_b32 v167, v167
  s_waitcnt lgkmcnt(0)
  s_nop 0
  v_readfirstlane_b32 s60, v167
  s_sub_u32 s61, s61, 1
  s_cbranch_scc1 k2_ws0d
  s_cmp_lt_u32 s60, 2
  s_cbranch_scc1 k2_ws0_l
  s_branch k2_ws0d
k2_wo1:
  v_mfma_f32_32x32x16_bf16 v[64:79], v[96:99], v[136:139], v[64:79]
  ds_read_b128 v[96:99], v165 offset:4096
  v_mfma_f32_32x32x16_bf16 v[64:79], v[100:103], v[140:143], v[64:79]
  ds_read_b128 v[100:103], v165 offset:5120
  v_mfma_f32_32x32x16_bf16 v[64:79], v[104:107], v[144:147], v[64:79]
  ds_read_b128 v[104:107], v165 offset:6144
  v_mfma_f32_32x32x16_bf16 v[64:79], v[108:111], v[148:151], v[64:79]
  ds_read_b128 v[108:111], v165 offset:7168
  v_mfma_f32_32x32x16_bf16 v[64:79], v[116:119], v[156:159], v[64:79]
  ds_read_b128 v[116:119], v165 offset:9216
  s_waitcnt lgkmcnt(4)
  v_mfma_f32_32x32x16_bf16 v[0:15], v[96:99], v[136:139], v[0:15]
  ds_read_b128 v[96:99], v164 offset:4096
  s_waitcnt lgkmcnt(4)
  v_mfma_f32_32x32x16_bf16 v[0:15], v[100:103], v[140:143], v[0:15]
  ds_read_b128 v[100:103], v164 offset:5120
  s_waitcnt lgkmcnt(4)
  v_mfma_f32_32x32x16_bf16 v[0:15], v[104:107], v[144:147], v[0:15]
  ds_read_b128 v[104:107], v164 offset:6144
  s_waitcnt lgkmcnt(4)
  v_mfma_f32_32x32x16_bf16 v[0:15], v[108:111], v[148:151], v[0:15]
  ds_read_b128 v[108:111], v164 offset:7168
  s_waitcnt lgkmcnt(4)
  v_mfma_f32_32x32x16_bf16 v[0:15], v[116:119], v[156:159], v[0:15]
  ds_read_b128 v[116:119], v164 offset:9216
  s_waitcnt lgkmcnt(4)
  v_mfma_f32_32x32x16_bf16 v[16:31], v[96:99], v[136:139], v[16:31]
  v_mov_b32 v167, s49
  ds_read_b128 v[96:99], v165 offset:14336
  s_waitcnt lgkmcnt(4)
  v_mfma_f32_32x32x16_bf16 v[16:31], v[100:103], v[140:143], v[16:31]
  ds_read_b32 v167, v167
  ds_read_b128 v[100:103], v164 offset:10240
  s_waitcnt lgkmcnt(5)
  v_mfma_f32_32x32x16_bf16 v[16:31], v[104:107], v[144:147], v[16:31]
  ds_read_b128 v[104:107], v164 offset:11264
  s_waitcnt lgkmcnt(5)
  v_mfma_f32_32x32x16_bf16 v[16:31], v[108:111], v[148:151], v[16:31]
  s_waitcnt lgkmcnt(2)
  v_readfirstlane_b32 s60, v167
  s_nop 0
  s_cmp_lt_u32 s60, 2
  s_cbranch_scc1 k2_ws1
k2_ws1d:
  ds_read_b128 v[108:111], v164 offset:49152
  v_mfma_f32_32x32x16_bf16 v[16:31], v[116:119], v[156:159], v[16:31]
  ds_read_b128 v[116:119], v164 offset:51200
  v_mfma_f32_32x32x16_bf16 v[32:47], v[96:99], v[136:139], v[32:47]
  s_waitcnt vmcnt(0)
  v_max3_u32 v167, v120, v121, v122
  ds_read_b128 v[96:99], v164 offset:53248
  s_waitcnt lgkmcnt(4)
  v_mfma_f32_32x32x16_bf16 v[32:47], v[100:103], v[140:143], v[32:47]
  v_max3_u32 v167, v167, v123, v124
  ds_read_b128 v[100:103], v164 offset:55296
  s_waitcnt lgkmcnt(4)
  v_mfma_f32_32x32x16_bf16 v[32:47], v[104:107], v[144:147], v[32:47]
  v_max3_u32 v167, v167, v125, v126
  ds_read_b128 v[104:107], v164 offset:57344
  s_waitcnt lgkmcnt(4)
  v_mfma_f32_32x32x16_bf16 v[32:47], v[108:111], v[148:151], v[32:47]
  v_max3_u32 v167, v167, v127, v128
  ds_read_b128 v[108:111], v164 offset:59392
  s_waitcnt lgkmcnt(4)
  v_mfma_f32_32x32x16_bf16 v[32:47], v[116:119], v[156:159], v[32:47]
  v_max3_u32 v167, v167, v129, v130
  s_waitcnt lgkmcnt(3)
  v_mfma_f32_32x32x16_bf16 v[48:63], v[96:99], v[136:139], v[48:63]
  v_max3_u32 v167, v167, v131, v132
  ds_read_b128 v[96:99], v165 offset:0
  s_waitcnt lgkmcnt(3)
  v_mfma_f32_32x32x16_bf16 v[48:63], v[100:103], v[140:143], v[48:63]
  v_max3_u32 v167, v167, v133, v134
  ds_read_b128 v[100:103], v165 offset:1024
  s_waitcnt lgkmcnt(3)
  v_mfma_f32_32x32x16_bf16 v[48:63], v[104:107], v[144:147], v[48:63]
  v_max3_u32 v167, v167, v135, v152
  ds_read_b128 v[104:107], v165 offset:2048
  s_waitcnt lgkmcnt(3)
  v_mfma_f32_32x32x16_bf16 v[48:63], v[108:111], v[148:151], v[48:63]
  v_max3_u32 v167, v167, v153, v154
  ds_read_b128 v[108:111], v165 offset:3072
  v_mfma_f32_32x32x16_bf16 v[48:63], v[160:163], v[156:159], v[48:63]
  v_max_u32 v167, v167, v155
  ds_read_b128 v[116:119], v165 offset:8192
  v_cmp_eq_u32 vcc, -1, v167
  s_nop 0
  s_cmp_eq_u64 vcc, 0
  s_cbranch_scc1 k2_q1d
k2_q1:
  s_waitcnt vmcnt(0)
  v_max3_u32 v167, v120, v121, v122
  v_max_u32 v167, v167, v123
  v_cmp_eq_u32 s[4:5], -1, v167
  v_max3_u32 v167, v124, v125, v126
  v_max_u32 v167, v167, v127
  v_cmp_eq_u32 s[6:7], -1, v167
  v_max3_u32 v167, v128, v129, v130
  v_max_u32 v167, v167, v131
  v_cmp_eq_u32 s[12:13], -1, v167
  v_max3_u32 v167, v132, v133, v134
  v_max_u32 v167, v167, v135
  v_cmp_eq_u32 s[14:15], -1, v167
  v_max3_u32 v167, v152, v153, v154
  v_max_u32 v167, v167, v155
  v_cmp_eq_u32 s[34:35], -1, v167
  s_cmp_eq_u64 s[4:5], 0
  s_cbranch_scc1 k2_q10
  s_add_u32 s60, s54, 0
  buffer_load_dwordx4 v[120:123], v166, s[24:27], s60 offen sc1
k2_q10:
  s_cmp_eq_u64 s[6:7], 0
  s_cbranch_scc1 k2_q11
  s_add_u32 s60, s54, 0x400
  buffer_load_dwordx4 v[124:127], v166, s[24:27], s60 offen sc1
k2_q11:
  s_cmp_eq_u64 s[12:13], 0
  s_cbranch_scc1 k2_q12
  s_add_u32 s60, s54, 0x800
  buffer_load_dwordx4 v[128:131], v166, s[24:27], s60 offen sc1
k2_q12:
  s_cmp_eq_u64 s[14:15], 0
  s_cbranch_scc1 k2_q13
  s_add_u32 s60, s54, 0xc00
  buffer_load_dwordx4 v[132:135], v166, s[24:27], s60 offen sc1
k2_q13:
  s_cmp_eq_u64 s[34:35], 0
  s_cbranch_scc1 k2_q18
  s_add_u32 s60, s55, 0
  buffer_load_dwordx4 v[152:155], v166, s[24:27], s60 offen sc1
k2_q18:
  s_sub_u32 s69, s69, 1
  s_cbranch_scc1 k2_q1d
  s_or_b64 s[4:5], s[4:5], s[6:7]
  s_or_b64 s[12:13], s[12:13], s[14:15]
  s_or_b64 s[4:5], s[4:5], s[34:35]
  s_or_b64 s[4:5], s[4:5], s[12:13]
  s_cbranch_scc0 k2_q1d
  s_sleep 2
  s_branch k2_q1
k2_q1d:
  v_mfma_f32_32x32x16_bf16 v[64:79], v[80:83], v[120:123], v[64:79]
  ds_read_b128 v[80:83], v164 offset:0
  v_mfma_f32_32x32x16_bf16 v[64:79], v[84:87], v[124:127], v[64:79]
  ds_read_b128 v[84:87], v164 offset:1024
  v_bfe_u32 v167, v166, 4, 5
  v_mul_u32_u24 v167, 0x50, v167
  v_mfma_f32_32x32x16_bf16 v[64:79], v[88:91], v[128:131], v[64:79]
  ds_read_b128 v[88:91], v164 offset:2048
  v_lshlrev_b32 v167, 4, v167
  v_cmp_lt_u32 vcc, 0x1ff, v166
  v_mfma_f32_32x32x16_bf16 v[64:79], v[92:95], v[132:135], v[64:79]
  ds_read_b128 v[92:95], v164 offset:3072
  v_mfma_f32_32x32x16_bf16 v[64:79], v[112:115], v[152:155], v[64:79]
  ds_read_b128 v[112:115], v164 offset:8192
  s_mov_b64 exec, vcc
  v_add_u32 v167, 16, v167
  s_mov_b64 exec, -1
  s_waitcnt lgkmcnt(9)
  v_mfma_f32_32x32x16_bf16 v[0:15], v[96:99], v[120:123], v[0:15]
  ds_read_b128 v[96:99], v165 offset:10240
  s_waitcnt lgkmcnt(9)
  v_mfma_f32_32x32x16_bf16 v[0:15], v[100:103], v[124:127], v[0:15]
  ds_read_b128 v[100:103], v165 offset:11264
  s_waitcnt lgkmcnt(9)
  v_mfma_f32_32x32x16_bf16 v[0:15], v[104:107], v[128:131], v[0:15]
  ds_read_b128 v[104:107], v165 offset:12288
  ds_write_b128 v165, v[64:67] offset:0
  ds_write_b128 v165, v[68:71] offset:1024
  ds_write_b128 v165, v[72:75] offset:2048
  ds_write_b128 v165, v[76:79] offset:3072
  s_waitcnt lgkmcnt(13)
  v_mfma_f32_32x32x16_bf16 v[0:15], v[108:111], v[132:135], v[0:15]
  ds_read_b128 v[108:111], v165 offset:13312
  s_waitcnt lgkmcnt(13)
  v_mfma_f32_32x32x16_bf16 v[0:15], v[116:119], v[152:155], v[0:15]
  ds_read_b128 v[116:119], v164 offset:50176
  s_waitcnt lgkmcnt(13)
  v_mfma_f32_32x32x16_bf16 v[16:31], v[80:83], v[120:123], v[16:31]
  ds_read_b128 v[80:83], v164 offset:52224
  s_waitcnt lgkmcnt(13)
  v_mfma_f32_32x32x16_bf16 v[16:31], v[84:87], v[124:127], v[16:31]
  ds_read_b128 v[84:87], v164 offset:54272
  s_waitcnt lgkmcnt(13)
  v_mfma_f32_32x32x16_bf16 v[16:31], v[88:91], v[128:131], v[16:31]
  ds_read_b128 v[88:91], v164 offset:56320
  s_nop 1
  ds_write_b128 v165, v[0:3] offset:4096
  ds_write_b128 v165, v[4:7] offset:5120
  ds_write_b128 v165, v[8:11] offset:6144
  ds_write_b128 v165, v[12:15] offset:7168
  s_waitcnt lgkmcnt(15)
  v_mfma_f32_32x32x16_bf16 v[16:31], v[92:95], v[132:135], v[16:31]
  ds_read_b128 v[92:95], v164 offset:58368
  v_mfma_f32_32x32x16_bf16 v[16:31], v[112:115], v[152:155], v[16:31]
  ds_read_b128 v[112:115], v164 offset:60416
  s_waitcnt lgkmcnt(0)
  v_add_u32 v79, s31, v166
  v_add_u32 v15, s28, v166
  s_barrier
  v_mfma_f32_32x32x16_bf16 v[32:47], v[96:99], v[120:123], v[32:47]
  ds_read_b128 v[64:67], v79 offset:0
  ds_read_b128 v[68:71], v79 offset:15360
  ds_read_b128 v[72:75], v79 offset:30720
  ds_read_b128 v[76:79], v79 offset:46080
  v_mfma_f32_32x32x16_bf16 v[32:47], v[100:103], v[124:127], v[32:47]
  ds_read_b128 v[0:3], v15 offset:0
  ds_read_b128 v[4:7], v15 offset:1024
  ds_read_b128 v[8:11], v15 offset:2048
  ds_read_b128 v[12:15], v15 offset:3072
  v_mfma_f32_32x32x16_bf16 v[32:47], v[104:107], v[128:131], v[32:47]
  ds_write_b128 v164, v[16:19] offset:0
  ds_write_b128 v164, v[20:23] offset:1024
  ds_write_b128 v164, v[24:27] offset:2048
  ds_write_b128 v164, v[28:31] offset:3072
  v_mfma_f32_32x32x16_bf16 v[32:47], v[108:111], v[132:135], v[32:47]
  v_mfma_f32_32x32x16_bf16 v[32:47], v[116:119], v[152:155], v[32:47]
  s_waitcnt lgkmcnt(10)
  v_add_f32 v64, v64, v68
  v_add_f32 v65, v65, v69
  v_add_f32 v66, v66, v70
  v_add_f32 v67, v67, v71
  s_waitcnt lgkmcnt(8)
  v_add_f32 v72, v72, v76
  v_add_f32 v73, v73, v77
  v_add_f32 v74, v74, v78
  v_add_f32 v75, v75, v79
  v_mfma_f32_32x32x16_bf16 v[48:63], v[80:83], v[120:123], v[48:63]
  v_add_f32 v64, v64, v72
  v_add_f32 v65, v65, v73
  v_add_f32 v66, v66, v74
  v_add_f32 v67, v67, v75
  v_cvt_pk_bf16_f32 v64, v64, v65
  v_cvt_pk_bf16_f32 v65, v66, v67
  buffer_store_dwordx2 v[64:65], v167, s[40:43], s33 offen offset:256
  v_mfma_f32_32x32x16_bf16 v[48:63], v[84:87], v[124:127], v[48:63]
  v_mfma_f32_32x32x16_bf16 v[48:63], v[88:91], v[128:131], v[48:63]
  ds_write_b128 v164, v[32:35] offset:4096
  ds_write_b128 v164, v[36:39] offset:5120
  ds_write_b128 v164, v[40:43] offset:6144
  ds_write_b128 v164, v[44:47] offset:7168
  v_mfma_f32_32x32x16_bf16 v[48:63], v[92:95], v[132:135], v[48:63]
  s_waitcnt lgkmcnt(0)
  v_add_u32 v31, s29, v166
  v_add_u32 v47, s30, v166
  s_barrier
  ds_read_b128 v[16:19], v31 offset:0
  ds_read_b128 v[20:23], v31 offset:1024
  ds_read_b128 v[24:27], v31 offset:2048
  ds_read_b128 v[28:31], v31 offset:3072
  ds_read_b128 v[32:35], v47 offset:0
  ds_read_b128 v[36:39], v47 offset:1024
  ds_read_b128 v[40:43], v47 offset:2048
  ds_read_b128 v[44:47], v47 offset:3072
  v_mfma_f32_32x32x16_bf16 v[48:63], v[112:115], v[152:155], v[48:63]
  s_nop 11
  v_pk_add_f32 v[0:1], v[0:1], v[48:49]
  v_pk_add_f32 v[2:3], v[2:3], v[50:51]
  v_pk_add_f32 v[4:5], v[4:5], v[52:53]
  v_pk_add_f32 v[6:7], v[6:7], v[54:55]
  v_pk_add_f32 v[8:9], v[8:9], v[56:57]
  v_pk_add_f32 v[10:11], v[10:11], v[58:59]
  v_pk_add_f32 v[12:13], v[12:13], v[60:61]
  v_pk_add_f32 v[14:15], v[14:15], v[62:63]
  s_waitcnt lgkmcnt(7)
  v_pk_add_f32 v[0:1], v[0:1], v[16:17]
  v_pk_add_f32 v[2:3], v[2:3], v[18:19]
  s_waitcnt lgkmcnt(6)
  v_pk_add_f32 v[4:5], v[4:5], v[20:21]
  v_pk_add_f32 v[6:7], v[6:7], v[22:23]
  s_waitcnt lgkmcnt(5)
  v_pk_add_f32 v[8:9], v[8:9], v[24:25]
  v_pk_add_f32 v[10:11], v[10:11], v[26:27]
  s_waitcnt lgkmcnt(4)
  v_pk_add_f32 v[12:13], v[12:13], v[28:29]
  v_pk_add_f32 v[14:15], v[14:15], v[30:31]
  s_waitcnt lgkmcnt(3)
  v_pk_add_f32 v[0:1], v[0:1], v[32:33]
  v_pk_add_f32 v[2:3], v[2:3], v[34:35]
  s_waitcnt lgkmcnt(2)
  v_pk_add_f32 v[4:5], v[4:5], v[36:37]
  v_pk_add_f32 v[6:7], v[6:7], v[38:39]
  v_cvt_pk_bf16_f32 v0, v0, v1
  v_cvt_pk_bf16_f32 v1, v2, v3
  v_cvt_pk_bf16_f32 v2, v4, v5
  v_cvt_pk_bf16_f32 v3, v6, v7
  buffer_store_dwordx4 v[0:3], v167, s[40:43], s32 offen offset:0
  s_waitcnt lgkmcnt(1)
  v_pk_add_f32 v[8:9], v[8:9], v[40:41]
  v_pk_add_f32 v[10:11], v[10:11], v[42:43]
  s_waitcnt lgkmcnt(0)
  v_pk_add_f32 v[12:13], v[12:13], v[44:45]
  v_pk_add_f32 v[14:15], v[14:15], v[46:47]
  v_cvt_pk_bf16_f32 v8, v8, v9
  v_cvt_pk_bf16_f32 v9, v10, v11
  v_cvt_pk_bf16_f32 v10, v12, v13
  v_cvt_pk_bf16_f32 v11, v14, v15
  buffer_store_dwordx4 v[8:11], v167, s[40:43], s32 offen offset:32
  s_endpgm
k2_ws1:
  s_mov_b32 s61, 0x400000
k2_ws1_l:
  v_mov_b32 v167, s49
  ds_read_b32 v167, v167
  s_waitcnt lgkmcnt(0)
  s_nop 0
  v_readfirstlane_b32 s60, v167
  s_sub_u32 s61, s61, 1
  s_cbranch_scc1 k2_ws1d
  s_cmp_lt_u32 s60, 2
  s_cbranch_scc1 k2_ws1_l
  s_branch k2_ws1d
k2_slow:
  v_cndmask_b32 v102, v102, 0, s[50:51]
  s_lshl_b32 s52, s63, 9
  v_add_u32 v104, s52, v128
  s_lshl_b32 s52, s63, 1
  s_sub_u32 s52, 2, s52
  s_lshl_b32 s52, s52, 9
  s_lshl_b32 s53, s63, 3
  s_add_u32 s52, s52, s53
  v_and_b32 v123, 0x1ff, v128
  v_add_u32 v105, s52, v123
  v_and_b32 v120, 31, v129
  v_and_b32 v121, 3, v120
  v_bfe_u32 v122, v120, 2, 1
  v_lshl_add_u32 v121, v122, 3, v121
  v_bfe_u32 v122, v120, 3, 1
  v_lshl_add_u32 v121, v122, 2, v121
  v_cmp_gt_u32 vcc, 16, v120
  v_cmp_le_u32 s[36:37], 20, v120
  v_min_u32 v120, 19, v120
  v_cndmask_b32 v121, v120, v121, vcc
  v_lshrrev_b32 v122, 5, v129
  v_mul_u32_u24 v122, 0x2800, v122
  v_lshl_add_u32 v106, v121, 4, v122
  v_add_u32 v109, 0x5000, v106
  v_mov_b32 v119, 0x3f803f80
  v_mov_b32 v113, 0xff800000
  s_add_u32 s57, s62, 0x50
  s_lshl_b32 s57, s57, 9
  s_add_u32 s57, s57, 0x2000
  s_mul_i32 s58, s29, 0x140
  s_add_u32 s58, s58, 0x502000
  s_mov_b32 s59, 64
k2_sl1:
  buffer_load_dwordx4 v[72:75], v104, s[24:27], s57 offen
  buffer_load_dwordx2 v[76:77], v105, s[24:27], s57 offen
  s_add_u32 s57, s57, 0x14000
  s_add_u32 s58, s58, 0xa000
  s_waitcnt vmcnt(0)
  v_cndmask_b32 v76, v76, 0, s[50:51]
  v_cndmask_b32 v77, v77, 0, s[50:51]
  v_mfma_f32_32x32x16_bf16 v[0:15], v[72:75], v[96:99], 0
  s_nop 0
  v_mfma_f32_32x32x8_bf16 v[0:15], v[76:77], v[102:103], v[0:15]
  s_nop 11
  v_max3_f32 v113, v113, v0, v1
  v_max3_f32 v113, v113, v2, v3
  v_max3_f32 v113, v113, v4, v5
  v_max3_f32 v113, v113, v6, v7
  v_max3_f32 v113, v113, v8, v9
  v_max3_f32 v113, v113, v10, v11
  v_max3_f32 v113, v113, v12, v13
  v_max3_f32 v113, v113, v14, v15
  s_nop 15
  s_sub_u32 s59, s59, 1
  s_cmp_lg_u32 s59, 0
  s_cbranch_scc1 k2_sl1
  v_mov_b32 v121, v113
  s_nop 1
  v_permlane32_swap_b32 v113, v121
  v_max_f32 v113, v113, v121
  v_mov_b32 v48, 0
  v_mov_b32 v49, 0
  v_mov_b32 v50, 0
  v_mov_b32 v51, 0
  v_mov_b32 v52, 0
  v_mov_b32 v53, 0
  v_mov_b32 v54, 0
  v_mov_b32 v55, 0
  v_mov_b32 v56, 0
  v_mov_b32 v57, 0
  v_mov_b32 v58, 0
  v_mov_b32 v59, 0
  v_mov_b32 v60, 0
  v_mov_b32 v61, 0
  v_mov_b32 v62, 0
  v_mov_b32 v63, 0
  s_add_u32 s57, s62, 0x50
  s_lshl_b32 s57, s57, 9
  s_add_u32 s57, s57, 0x2000
  s_mul_i32 s58, s29, 0x140
  s_add_u32 s58, s58, 0x502000
  s_mov_b32 s59, 64
k2_sl2:
  buffer_load_dwordx4 v[72:75], v104, s[24:27], s57 offen
  buffer_load_dwordx2 v[76:77], v105, s[24:27], s57 offen
  buffer_load_dwordx4 v[80:83], v106, s[24:27], s58 offen
  buffer_load_dwordx4 v[88:91], v109, s[24:27], s58 offen
  s_add_u32 s57, s57, 0x14000
  s_add_u32 s58, s58, 0xa000
  s_waitcnt vmcnt(0)
  v_cndmask_b32 v76, v76, 0, s[50:51]
  v_cndmask_b32 v77, v77, 0, s[50:51]
  v_mfma_f32_32x32x16_bf16 v[0:15], v[72:75], v[96:99], 0
  s_nop 0
  v_mfma_f32_32x32x8_bf16 v[0:15], v[76:77], v[102:103], v[0:15]
  v_cndmask_b32 v80, v80, v119, s[36:37]
  v_cndmask_b32 v88, v88, v119, s[36:37]
  v_cndmask_b32 v81, v81, v119, s[36:37]
  v_cndmask_b32 v89, v89, v119, s[36:37]
  v_cndmask_b32 v82, v82, v119, s[36:37]
  v_cndmask_b32 v90, v90, v119, s[36:37]
  v_cndmask_b32 v83, v83, v119, s[36:37]
  v_cndmask_b32 v91, v91, v119, s[36:37]
  s_nop 3
  v_sub_f32 v0, v0, v113
  v_sub_f32 v1, v1, v113
  v_sub_f32 v2, v2, v113
  v_sub_f32 v3, v3, v113
  v_sub_f32 v4, v4, v113
  v_sub_f32 v5, v5, v113
  v_sub_f32 v6, v6, v113
  v_sub_f32 v7, v7, v113
  v_sub_f32 v8, v8, v113
  v_sub_f32 v9, v9, v113
  v_sub_f32 v10, v10, v113
  v_sub_f32 v11, v11, v113
  v_sub_f32 v12, v12, v113
  v_sub_f32 v13, v13, v113
  v_sub_f32 v14, v14, v113
  v_sub_f32 v15, v15, v113
  v_exp_f32 v0, v0
  v_exp_f32 v1, v1
  v_exp_f32 v2, v2
  v_exp_f32 v3, v3
  v_exp_f32 v4, v4
  v_exp_f32 v5, v5
  v_exp_f32 v6, v6
  v_exp_f32 v7, v7
  v_exp_f32 v8, v8
  v_exp_f32 v9, v9
  v_exp_f32 v10, v10
  v_exp_f32 v11, v11
  v_exp_f32 v12, v12
  v_exp_f32 v13, v13
  v_exp_f32 v14, v14
  v_exp_f32 v15, v15
  v_cvt_pk_bf16_f32 v64, v0, v1
  v_cvt_pk_bf16_f32 v65, v2, v3
  v_cvt_pk_bf16_f32 v66, v4, v5
  v_cvt_pk_bf16_f32 v67, v6, v7
  v_cvt_pk_bf16_f32 v68, v8, v9
  v_cvt_pk_bf16_f32 v69, v10, v11
  v_cvt_pk_bf16_f32 v70, v12, v13
  v_cvt_pk_bf16_f32 v71, v14, v15
  v_mfma_f32_32x32x16_bf16 v[48:63], v[80:83], v[64:67], v[48:63]
  s_nop 0
  v_mfma_f32_32x32x16_bf16 v[48:63], v[88:91], v[68:71], v[48:63]
  s_nop 15
  s_sub_u32 s59, s59, 1
  s_cmp_lg_u32 s59, 0
  s_cbranch_scc1 k2_sl2
  v_mov_b32 v120, v56
  v_mov_b32 v121, v56
  s_nop 1
  v_permlane32_swap_b32 v120, v121
  v_rcp_f32 v120, v121
  s_nop 0
  v_mul_f32 v48, v48, v120
  v_mul_f32 v49, v49, v120
  v_mul_f32 v50, v50, v120
  v_mul_f32 v51, v51, v120
  v_mul_f32 v52, v52, v120
  v_mul_f32 v53, v53, v120
  v_mul_f32 v54, v54, v120
  v_mul_f32 v55, v55, v120
  v_mul_f32 v56, v56, v120
  v_mul_f32 v57, v57, v120
  v_mul_f32 v58, v58, v120
  v_mul_f32 v59, v59, v120
  v_cvt_pk_bf16_f32 v48, v48, v49
  v_cvt_pk_bf16_f32 v49, v50, v51
  v_cvt_pk_bf16_f32 v50, v52, v53
  v_cvt_pk_bf16_f32 v51, v54, v55
  v_cvt_pk_bf16_f32 v52, v56, v57
  v_cvt_pk_bf16_f32 v53, v58, v59
  v_min_u32 v48, -2, v48
  v_min_u32 v49, -2, v49
  v_min_u32 v50, -2, v50
  v_min_u32 v51, -2, v51
  v_min_u32 v52, -2, v52
  v_min_u32 v53, -2, v53
  s_branch k2_store
code_end:
.section .rodata,"a"
.p2align 6
.amdhsa_kernel k1_kernel
  .amdhsa_next_free_vgpr 512
  .amdhsa_next_free_sgpr 102
  .amdhsa_accum_offset 256
  .amdhsa_group_segment_fixed_size 0
  .amdhsa_kernarg_size 80
  .amdhsa_user_sgpr_count 2
  .amdhsa_user_sgpr_kernarg_segment_ptr 1
  .amdhsa_system_sgpr_workgroup_id_x 1
.end_amdhsa_kernel
.section .rodata,"a"
.p2align 6
.amdhsa_kernel k2_kernel
  .amdhsa_next_free_vgpr 168
  .amdhsa_next_free_sgpr 102
  .amdhsa_accum_offset 168
  .amdhsa_group_segment_fixed_size 0
  .amdhsa_kernarg_size 80
  .amdhsa_user_sgpr_count 2
  .amdhsa_user_sgpr_kernarg_segment_ptr 1
  .amdhsa_system_sgpr_workgroup_id_x 1
.end_amdhsa_kernel
```
